```python
import torch

def _softmax(x, axis=-1):
    return torch.softmax(x, dim=axis)

def _gelu(x):
    return torch.nn.functional.gelu(x, approximate='tanh')

def _silu(x):
    return torch.nn.functional.silu(x)

def _sigmoid(x):
    return torch.sigmoid(x)

def _layernorm(x, axis=-1, eps=1e-05):
    m = x.mean(dim=axis, keepdim=True)
    v = x.var(dim=axis, keepdim=True, unbiased=False)
    return (x - m) / torch.sqrt(v + eps)

def _scatter_add(tgt, idx, src, axis=0):
    return tgt.clone().index_add_(axis, idx, src)

def _segment_sum(src, seg, n):
    out = torch.zeros((n,) + src.shape[1:], dtype=src.dtype)
    return out.index_add_(0, seg, src)

def _pad(x, pw):
    flat = tuple((v for pair in reversed(pw) for v in pair))
    return torch.nn.functional.pad(x, flat)
kernel_name = 'sequential_preLN__memory_aug_recurrent_mem_tr__mixer_s_mlp__prompt'

def setup_inputs():

    _w = lambda a: (lambda t: t.to(torch.bfloat16) if t.is_floating_point() else t)(torch.as_tensor(a))

    def _A_setup():
        B, S, Dm = (1, 2048, 640)
        H, Dh = (32, 128)
        M, seg = (8, 32)
        seg = min(seg, S)
        S = S // seg * seg
        return {'x': _w((lambda *s: torch.randn(*s, dtype=torch.bfloat16) * 0.05)(B, S, Dm)), 'mem0': _w((lambda *s: torch.randn(*s, dtype=torch.bfloat16) * 0.2)(B, M, Dm)), 'Wq': _w((lambda *s: torch.randn(*s, dtype=torch.bfloat16) * 1.6)(Dm, H, Dh) * Dm ** (-0.5)), 'Wk': _w((lambda *s: torch.randn(*s, dtype=torch.bfloat16) * 1.6)(Dm, H, Dh) * Dm ** (-0.5)), 'Wv': _w((lambda *s: torch.randn(*s, dtype=torch.bfloat16) * 0.2)(Dm, H, Dh) * Dm ** (-0.5)), 'Wo': _w((lambda *s: torch.randn(*s, dtype=torch.bfloat16) * 0.2)(H, Dh, Dm) * (H * Dh) ** (-0.5)), 'seg_len': seg}
    _A_in = _A_setup()

    def _B_setup():
        B, S, D, F = (1, 2048, 640, 1728)
        return {'x': _w((lambda *s: torch.randn(*s, dtype=torch.bfloat16) * 0.05)(B, S, D)), 'w1': _w((lambda *s: torch.randn(*s, dtype=torch.bfloat16) * 0.8)(D, D) * D ** (-0.5)), 'w2': _w((lambda *s: torch.randn(*s, dtype=torch.bfloat16) * 0.8)(D, D) * D ** (-0.5)), 'w3': _w((lambda *s: torch.randn(*s, dtype=torch.bfloat16) * 0.8)(D, F) * D ** (-0.5)), 'w4': _w((lambda *s: torch.randn(*s, dtype=torch.bfloat16) * 0.8)(F, D) * F ** (-0.5))}
    _B_in = _B_setup()
    return {'A_x': _A_in['x'], 'A_mem0': _A_in['mem0'], 'A_Wq': _A_in['Wq'], 'A_Wk': _A_in['Wk'], 'A_Wv': _A_in['Wv'], 'A_Wo': _A_in['Wo'], 'A_seg_len': _A_in['seg_len'], 'B_x': _B_in['x'], 'B_w1': _B_in['w1'], 'B_w2': _B_in['w2'], 'B_w3': _B_in['w3'], 'B_w4': _B_in['w4']}

def reference(A_x, A_mem0, A_Wq, A_Wk, A_Wv, A_Wo, A_seg_len, B_x, B_w1, B_w2, B_w3, B_w4):

    def _A_ref(x, mem0, Wq, Wk, Wv, Wo, seg_len):
        B, S, Dm = x.shape
        H, Dh = (Wq.shape[1], Wq.shape[2])
        M = mem0.shape[1]
        scale = Dh ** (-0.5)
        n_seg = S // seg_len
        L = M + seg_len
        idx = torch.arange(L)
        mask = (idx[:, None] < M) | (idx[:, None] >= idx[None, :])
        mem = mem0
        outs = []
        for s in range(n_seg):
            xs = x[:, s * seg_len:(s + 1) * seg_len, :].clone()
            h = torch.concatenate([mem, xs], axis=1)
            q = torch.einsum('btd,dhe->bhte', h, Wq)
            k = torch.einsum('btd,dhe->bhte', h, Wk)
            v = torch.einsum('btd,dhe->bhte', h, Wv)
            scores = torch.einsum('bhqe,bhke->bhqk', q, k) * scale
            scores = torch.where(mask[None, None], scores, -1000000000.0)
            p = _softmax(scores, axis=-1)
            o = torch.einsum('bhqk,bhke->bhqe', p, v)
            o = torch.einsum('bhte,hed->btd', o, Wo)
            mem = o[:, :M, :].clone()
            outs.append(o[:, M:, :])
        return torch.concatenate(outs, axis=1)

    def _B_ref(x, w1, w2, w3, w4):
        B, S, D = x.shape
        h = _gelu(_layernorm(x, axis=-1) @ w1)
        c = D // 4
        g0 = _pad(h[:, :, 0 * c:1 * c], ((0, 0), (1, 0), (0, 0)))[:, :S, :]
        g1 = _pad(h[:, :, 1 * c:2 * c], ((0, 0), (0, 1), (0, 0)))[:, 1:, :]
        g2 = _pad(h[:, :, 2 * c:3 * c], ((0, 0), (2, 0), (0, 0)))[:, :S, :]
        g3 = _pad(h[:, :, 3 * c:], ((0, 0), (0, 2), (0, 0)))[:, 2:, :]
        hs = torch.concatenate([g0, g1, g2, g3], axis=-1) @ w2
        x1 = x + hs
        h2 = _gelu(_layernorm(x1, axis=-1) @ w3) @ w4
        return x1 + h2
    x = A_x
    h = x + _A_ref(_layernorm(x, axis=-1), A_mem0, A_Wq, A_Wk, A_Wv, A_Wo, A_seg_len)
    h2 = h + _B_ref(_layernorm(h, axis=-1), B_w1, B_w2, B_w3, B_w4)
    return h2
```

```asm
; @launch grid=(256,1,1) block=(256,1,1) lds=163840
.amdgcn_target "amdgcn-amd-amdhsa--gfx950"
.text
.globl sequential_preLN__memory_aug_recurrent_mem_tr__mixer_s_mlp__prompt_kernel
.p2align 8
.type sequential_preLN__memory_aug_recurrent_mem_tr__mixer_s_mlp__prompt_kernel,@function
sequential_preLN__memory_aug_recurrent_mem_tr__mixer_s_mlp__prompt_kernel:
    s_cmp_ge_u32 s2, 256
    s_cbranch_scc1 k_exit
    s_load_dwordx2 s[4:5], s[0:1], 112
    s_load_dwordx2 s[6:7], s[0:1], 104
    s_getreg_b32 s8, hwreg(HW_REG_XCC_ID)
    s_and_b32 s8, s8, 7
    v_mov_b32 v3, 6144
    v_cmp_eq_u32 vcc, 0, v0
    s_waitcnt lgkmcnt(0)
    s_and_saveexec_b64 s[12:13], vcc
    s_cbranch_execz k_tk
    s_lshl_b32 s14, s8, 2
    v_mov_b32 v1, s14
    v_mov_b32 v2, 1
    global_atomic_add v2, v1, v2, s[6:7] sc0
    s_waitcnt vmcnt(0)
    ds_write_b32 v3, v2
    s_waitcnt lgkmcnt(0)
k_tk:
    s_mov_b64 exec, s[12:13]
    s_barrier
    ds_read_b32 v2, v3
    s_waitcnt lgkmcnt(0)
    v_readfirstlane_b32 s9, v2
    s_barrier
    s_cmp_ge_u32 s9, 32
    s_cbranch_scc1 k_end
    s_cmp_ge_u32 s8, 2
    s_cbranch_scc1 k_bulk
    v_lshrrev_b32 v9, 6, v0
    v_and_b32 v10, 63, v0
    v_readfirstlane_b32 s10, v9
    v_lshlrev_b32 v0, 4, v10
    v_lshlrev_b32 v1, 3, v10
    s_load_dwordx2 s[12:13], s[0:1], 16
    s_load_dwordx2 s[16:17], s[0:1], 24
    s_load_dwordx2 s[20:21], s[0:1], 32
    s_load_dwordx2 s[24:25], s[0:1], 40
    s_load_dwordx2 s[28:29], s[0:1], 8
    s_mov_b32 s32, s4
    s_mov_b32 s33, s5
    s_mov_b32 s34, 0x10000000
    s_mov_b32 s35, 0x20000
    s_mul_i32 s36, s10, 40960
    s_cmp_eq_u32 s10, 3
    s_cselect_b32 s36, 114688, s36
    s_add_u32 s36, s36, 16384
    v_add_u32 v2, s36, v0
    v_mov_b32 v3, 0x4444
    v_mov_b32 v11, 0xeeee
    v_and_b32 v9, 8, v10
    v_cmp_ne_u32 vcc, 0, v9
    s_mov_b32 s44, 0x00ff00ff
    s_mov_b32 s45, 0x00ff00ff
    v_cndmask_b32 v3, v3, v11, vcc
    s_mov_b32 s46, 0
    s_mov_b32 s47, -1
    s_mov_b32 s48, 0x3e0293ee
    s_mov_b32 s49, 0x3e0293ee
    s_mov_b32 s50, 0
    s_mov_b32 s51, 0
    s_mov_b32 s11, 0
    s_mov_b32 s88, 1048576
    v_and_b32 v9, 15, v10
    v_bfe_u32 v11, v10, 5, 1
    v_lshl_add_u32 v4, v11, 4, v9
    v_lshlrev_b32 v4, 5, v4
    v_bfe_u32 v11, v10, 4, 1
    v_lshrrev_b32 v9, 2, v9
    v_xor_b32 v11, v11, v9
    v_lshl_add_u32 v4, v11, 3, v4
    s_lshl_b32 s36, s10, 10
    v_add_u32 v4, s36, v4
    v_lshrrev_b32 v11, 4, v10
    v_lshlrev_b32 v6, 7, v11
    v_and_b32 v11, 7, v10
    v_lshl_add_u32 v6, v11, 4, v6
    s_lshl_b32 s36, s10, 9
    s_add_u32 s36, s36, 4096
    v_add_u32 v5, s36, v6
    v_bfe_u32 v11, v10, 5, 1
    v_lshlrev_b32 v7, 2, v11
    v_bfe_u32 v11, v10, 2, 2
    v_add_u32 v7, v7, v11
    v_mul_u32_u24 v7, 4352, v7
    v_bfe_u32 v11, v10, 4, 1
    v_lshl_add_u32 v7, v11, 6, v7
    v_and_b32 v11, 3, v10
    v_lshl_add_u32 v7, v11, 4, v7
    s_lshl_b32 s36, s9, 7
    v_add_u32 v7, s36, v7
    s_lshl_b32 s37, s10, 3
    s_add_u32 s37, s37, 139264
    v_add_u32 v8, s37, v7
    s_xor_b32 s36, s10, 2
    s_mul_i32 s36, s36, 34816
    v_add_u32 v7, s36, v7
    s_waitcnt lgkmcnt(0)
    s_mov_b32 s14, 5242880
    s_mov_b32 s15, 0x20000
    s_mov_b32 s18, 5242880
    s_mov_b32 s19, 0x20000
    s_mov_b32 s22, 5242880
    s_mov_b32 s23, 0x20000
    s_mov_b32 s26, 5242880
    s_mov_b32 s27, 0x20000
    s_cmp_ge_u32 s10, 2
    s_cbranch_scc1 cB_entry
cA_entry:
    v_lshrrev_b32 v9, 4, v0
    v_bfe_u32 v10, v9, 5, 1
    v_lshlrev_b32 v16, 3, v10
    v_bfe_u32 v10, v9, 4, 1
    v_add_u32 v16, v16, v10
    v_lshlrev_b32 v16, 13, v16
    v_bfe_u32 v10, v9, 1, 3
    v_lshrrev_b32 v11, 4, v9
    v_xor_b32 v10, v10, v11
    v_lshl_add_u32 v16, v10, 5, v16
    v_and_b32 v10, 1, v9
    v_lshl_add_u32 v16, v10, 4, v16
    v_xor_b32 v17, 128, v16
    v_bfe_u32 v10, v9, 4, 1
    v_lshlrev_b32 v18, 4, v10
    v_bfe_u32 v10, v9, 5, 1
    v_lshl_add_u32 v18, v10, 2, v18
    v_bfe_u32 v10, v9, 2, 1
    v_add_u32 v18, v18, v10
    v_mul_u32_u24 v18, 1280, v18
    v_bfe_u32 v10, v9, 3, 1
    v_lshl_add_u32 v18, v10, 6, v18
    v_and_b32 v10, 3, v9
    v_lshl_add_u32 v18, v10, 4, v18
    v_lshrrev_b32 v11, 2, v9
    v_lshlrev_b32 v19, 8, v11
    v_lshl_add_u32 v19, v10, 3, v19
    v_and_b32 v11, 7, v11
    s_lshl_b32 s36, s10, 1
    v_xor_b32 v11, s36, v11
    v_lshl_add_u32 v19, v11, 5, v19
    v_xor_b32 v20, 32, v19
    s_mul_i32 s40, s8, 2621440
    s_sub_u32 s41, 2621440, s40
    s_lshl_b32 s36, s9, 8
    s_lshr_b32 s37, s10, 1
    s_lshl_b32 s37, s37, 18
    s_add_u32 s36, s36, s37
    s_and_b32 s37, s10, 1
    s_lshl_b32 s37, s37, 14
    s_add_u32 s36, s36, s37
    s_add_u32 s40, s40, s36
    s_add_u32 s41, s41, s36
    s_mul_i32 s38, s9, 163840
    s_mul_i32 s36, s8, 640
    s_add_u32 s38, s38, s36
    s_xor_b32 s36, s10, 2
    s_lshl_b32 s36, s36, 7
    s_add_u32 s39, s38, s36
    s_add_u32 s38, s38, 512
    v_readfirstlane_b32 s3, v2
    s_lshl_b32 s42, s10, 12
    s_lshl_b32 s36, s10, 3
    v_add_u32 v23, s36, v2
    s_add_u32 m0, s42, 0
    s_add_u32 s36, s41, 0
    buffer_load_dwordx4 v16, s[12:15], s36 offen lds
    s_add_u32 m0, s42, 1024
    s_add_u32 s36, s41, 32768
    buffer_load_dwordx4 v17, s[12:15], s36 offen lds
    s_add_u32 m0, s42, 2048
    s_add_u32 s36, s41, 131072
    buffer_load_dwordx4 v16, s[12:15], s36 offen lds
    s_add_u32 m0, s42, 3072
    s_add_u32 s36, s41, 163840
    buffer_load_dwordx4 v17, s[12:15], s36 offen lds
    s_add_u32 m0, s42, 40960
    s_add_u32 s36, s41, 0
    buffer_load_dwordx4 v16, s[16:19], s36 offen lds
    s_add_u32 m0, s42, 41984
    s_add_u32 s36, s41, 32768
    buffer_load_dwordx4 v17, s[16:19], s36 offen lds
    s_add_u32 m0, s42, 43008
    s_add_u32 s36, s41, 131072
    buffer_load_dwordx4 v16, s[16:19], s36 offen lds
    s_add_u32 m0, s42, 44032
    s_add_u32 s36, s41, 163840
    buffer_load_dwordx4 v17, s[16:19], s36 offen lds
    s_add_u32 m0, s42, 81920
    s_add_u32 s36, s41, 524288
    buffer_load_dwordx4 v16, s[12:15], s36 offen lds
    s_add_u32 m0, s42, 82944
    s_add_u32 s36, s41, 557056
    buffer_load_dwordx4 v17, s[12:15], s36 offen lds
    s_add_u32 m0, s42, 83968
    s_add_u32 s36, s41, 655360
    buffer_load_dwordx4 v16, s[12:15], s36 offen lds
    s_add_u32 m0, s42, 84992
    s_add_u32 s36, s41, 688128
    buffer_load_dwordx4 v17, s[12:15], s36 offen lds
    s_add_u32 m0, s42, 114688
    s_add_u32 s36, s41, 524288
    buffer_load_dwordx4 v16, s[16:19], s36 offen lds
    s_add_u32 m0, s42, 115712
    s_add_u32 s36, s41, 557056
    buffer_load_dwordx4 v17, s[16:19], s36 offen lds
    s_add_u32 m0, s42, 116736
    s_add_u32 s36, s41, 655360
    buffer_load_dwordx4 v16, s[16:19], s36 offen lds
    s_add_u32 m0, s42, 117760
    s_add_u32 s36, s41, 688128
    buffer_load_dwordx4 v17, s[16:19], s36 offen lds
    s_add_u32 m0, s3, 0
    s_add_u32 s36, s39, 0
    buffer_load_dwordx4 v18, s[24:27], s36 offen lds
    s_add_u32 m0, s3, 1024
    s_add_u32 s36, s39, 2560
    buffer_load_dwordx4 v18, s[24:27], s36 offen lds
    s_add_u32 m0, s3, 2048
    s_add_u32 s36, s39, 10240
    buffer_load_dwordx4 v18, s[24:27], s36 offen lds
    s_add_u32 m0, s3, 3072
    s_add_u32 s36, s39, 12800
    buffer_load_dwordx4 v18, s[24:27], s36 offen lds
    s_add_u32 m0, s3, 4096
    s_add_u32 s36, s39, 40960
    buffer_load_dwordx4 v18, s[24:27], s36 offen lds
    s_add_u32 m0, s3, 5120
    s_add_u32 s36, s39, 43520
    buffer_load_dwordx4 v18, s[24:27], s36 offen lds
    s_add_u32 m0, s3, 6144
    s_add_u32 s36, s39, 51200
    buffer_load_dwordx4 v18, s[24:27], s36 offen lds
    s_add_u32 m0, s3, 7168
    s_add_u32 s36, s39, 53760
    buffer_load_dwordx4 v18, s[24:27], s36 offen lds
    s_add_u32 m0, s3, 8192
    s_add_u32 s36, s39, 81920
    buffer_load_dwordx4 v18, s[24:27], s36 offen lds
    s_add_u32 m0, s3, 9216
    s_add_u32 s36, s39, 84480
    buffer_load_dwordx4 v18, s[24:27], s36 offen lds
    s_add_u32 m0, s3, 10240
    s_add_u32 s36, s39, 92160
    buffer_load_dwordx4 v18, s[24:27], s36 offen lds
    s_add_u32 m0, s3, 11264
    s_add_u32 s36, s39, 94720
    buffer_load_dwordx4 v18, s[24:27], s36 offen lds
    s_add_u32 m0, s3, 12288
    s_add_u32 s36, s39, 122880
    buffer_load_dwordx4 v18, s[24:27], s36 offen lds
    s_add_u32 m0, s3, 13312
    s_add_u32 s36, s39, 125440
    buffer_load_dwordx4 v18, s[24:27], s36 offen lds
    s_add_u32 m0, s3, 14336
    s_add_u32 s36, s39, 133120
    buffer_load_dwordx4 v18, s[24:27], s36 offen lds
    s_add_u32 m0, s3, 15360
    s_add_u32 s36, s39, 135680
    buffer_load_dwordx4 v18, s[24:27], s36 offen lds
    s_waitcnt vmcnt(28)
    s_barrier
    s_add_u32 m0, s42, 147456
    s_add_u32 s36, s41, 1048576
    buffer_load_dwordx4 v16, s[12:15], s36 offen lds
    s_add_u32 m0, s42, 148480
    s_add_u32 s36, s41, 1081344
    buffer_load_dwordx4 v17, s[12:15], s36 offen lds
    s_add_u32 m0, s42, 149504
    s_add_u32 s36, s41, 1179648
    buffer_load_dwordx4 v16, s[12:15], s36 offen lds
    s_add_u32 m0, s42, 150528
    s_add_u32 s36, s41, 1212416
    buffer_load_dwordx4 v17, s[12:15], s36 offen lds
    v_add_u32 v21, 0, v19
    v_add_u32 v22, 0, v20
    ds_read_b64_tr_b16 a[0:1], v21 offset:0
    ds_read_b64_tr_b16 a[2:3], v21 offset:4096
    ds_read_b64_tr_b16 a[4:5], v21 offset:8192
    ds_read_b64_tr_b16 a[6:7], v21 offset:12288
    ds_read_b64_tr_b16 a[8:9], v22 offset:0
    ds_read_b64_tr_b16 a[10:11], v22 offset:4096
    ds_read_b64_tr_b16 a[12:13], v22 offset:8192
    ds_read_b64_tr_b16 a[14:15], v22 offset:12288
    s_waitcnt lgkmcnt(0)
    s_waitcnt vmcnt(28)
    s_barrier
    s_add_u32 m0, s42, 0
    s_add_u32 s36, s41, 1048576
    buffer_load_dwordx4 v16, s[16:19], s36 offen lds
    s_add_u32 m0, s42, 1024
    s_add_u32 s36, s41, 1081344
    buffer_load_dwordx4 v17, s[16:19], s36 offen lds
    s_add_u32 m0, s42, 2048
    s_add_u32 s36, s41, 1179648
    buffer_load_dwordx4 v16, s[16:19], s36 offen lds
    s_add_u32 m0, s42, 3072
    s_add_u32 s36, s41, 1212416
    buffer_load_dwordx4 v17, s[16:19], s36 offen lds
    v_add_u32 v21, 40960, v19
    v_add_u32 v22, 40960, v20
    ds_read_b64_tr_b16 a[16:17], v21 offset:0
    ds_read_b64_tr_b16 a[18:19], v21 offset:4096
    ds_read_b64_tr_b16 a[20:21], v21 offset:8192
    ds_read_b64_tr_b16 a[22:23], v21 offset:12288
    ds_read_b64_tr_b16 a[24:25], v22 offset:0
    ds_read_b64_tr_b16 a[26:27], v22 offset:4096
    ds_read_b64_tr_b16 a[28:29], v22 offset:8192
    ds_read_b64_tr_b16 a[30:31], v22 offset:12288
    s_waitcnt lgkmcnt(0)
    s_waitcnt vmcnt(28)
    s_barrier
    s_add_u32 m0, s42, 40960
    s_add_u32 s36, s41, 1048576
    buffer_load_dwordx4 v16, s[20:23], s36 offen lds
    s_add_u32 m0, s42, 41984
    s_add_u32 s36, s41, 1081344
    buffer_load_dwordx4 v17, s[20:23], s36 offen lds
    s_add_u32 m0, s42, 43008
    s_add_u32 s36, s41, 1179648
    buffer_load_dwordx4 v16, s[20:23], s36 offen lds
    s_add_u32 m0, s42, 44032
    s_add_u32 s36, s41, 1212416
    buffer_load_dwordx4 v17, s[20:23], s36 offen lds
    v_add_u32 v21, 81920, v19
    v_add_u32 v22, 81920, v20
    ds_read_b64_tr_b16 a[32:33], v21 offset:0
    ds_read_b64_tr_b16 a[34:35], v21 offset:4096
    ds_read_b64_tr_b16 a[36:37], v21 offset:8192
    ds_read_b64_tr_b16 a[38:39], v21 offset:12288
    ds_read_b64_tr_b16 a[40:41], v22 offset:0
    ds_read_b64_tr_b16 a[42:43], v22 offset:4096
    ds_read_b64_tr_b16 a[44:45], v22 offset:8192
    ds_read_b64_tr_b16 a[46:47], v22 offset:12288
    s_waitcnt lgkmcnt(0)
    s_waitcnt vmcnt(28)
    s_barrier
    s_add_u32 m0, s42, 81920
    s_add_u32 s36, s41, 1572864
    buffer_load_dwordx4 v16, s[12:15], s36 offen lds
    s_add_u32 m0, s42, 82944
    s_add_u32 s36, s41, 1605632
    buffer_load_dwordx4 v17, s[12:15], s36 offen lds
    s_add_u32 m0, s42, 83968
    s_add_u32 s36, s41, 1703936
    buffer_load_dwordx4 v16, s[12:15], s36 offen lds
    s_add_u32 m0, s42, 84992
    s_add_u32 s36, s41, 1736704
    buffer_load_dwordx4 v17, s[12:15], s36 offen lds
    v_add_u32 v21, 114688, v19
    v_add_u32 v22, 114688, v20
    ds_read_b64_tr_b16 a[48:49], v21 offset:0
    ds_read_b64_tr_b16 a[50:51], v21 offset:4096
    ds_read_b64_tr_b16 a[52:53], v21 offset:8192
    ds_read_b64_tr_b16 a[54:55], v21 offset:12288
    ds_read_b64_tr_b16 a[56:57], v22 offset:0
    ds_read_b64_tr_b16 a[58:59], v22 offset:4096
    ds_read_b64_tr_b16 a[60:61], v22 offset:8192
    ds_read_b64_tr_b16 a[62:63], v22 offset:12288
    s_waitcnt lgkmcnt(0)
    s_waitcnt vmcnt(16)
    ds_read_b64_tr_b16 a[208:209], v2 offset:0
    ds_read_b64_tr_b16 a[210:211], v2 offset:1024
    ds_read_b64_tr_b16 a[212:213], v2 offset:2048
    ds_read_b64_tr_b16 a[214:215], v2 offset:3072
    ds_read_b64_tr_b16 a[240:241], v2 offset:8
    ds_read_b64_tr_b16 a[242:243], v2 offset:1032
    ds_read_b64_tr_b16 a[244:245], v2 offset:2056
    ds_read_b64_tr_b16 a[246:247], v2 offset:3080
    ds_read_b64_tr_b16 a[216:217], v2 offset:4096
    ds_read_b64_tr_b16 a[218:219], v2 offset:5120
    ds_read_b64_tr_b16 a[220:221], v2 offset:6144
    ds_read_b64_tr_b16 a[222:223], v2 offset:7168
    ds_read_b64_tr_b16 a[248:249], v2 offset:4104
    ds_read_b64_tr_b16 a[250:251], v2 offset:5128
    ds_read_b64_tr_b16 a[252:253], v2 offset:6152
    ds_read_b64_tr_b16 a[254:255], v2 offset:7176
    ds_read_b64_tr_b16 a[224:225], v2 offset:8192
    ds_read_b64_tr_b16 a[226:227], v2 offset:9216
    ds_read_b64_tr_b16 a[228:229], v2 offset:10240
    ds_read_b64_tr_b16 a[230:231], v2 offset:11264
    ds_read_b64_tr_b16 v[96:97], v2 offset:8200
    ds_read_b64_tr_b16 v[98:99], v2 offset:9224
    ds_read_b64_tr_b16 v[100:101], v2 offset:10248
    ds_read_b64_tr_b16 v[102:103], v2 offset:11272
    ds_read_b64_tr_b16 a[232:233], v2 offset:12288
    ds_read_b64_tr_b16 a[234:235], v2 offset:13312
    ds_read_b64_tr_b16 a[236:237], v2 offset:14336
    ds_read_b64_tr_b16 a[238:239], v2 offset:15360
    ds_read_b64_tr_b16 v[104:105], v2 offset:12296
    ds_read_b64_tr_b16 v[106:107], v2 offset:13320
    ds_read_b64_tr_b16 v[108:109], v2 offset:14344
    ds_read_b64_tr_b16 v[110:111], v2 offset:15368
    s_waitcnt lgkmcnt(0)
    s_add_u32 m0, s3, 0
    s_add_u32 s36, s38, 0
    buffer_load_dwordx4 v18, s[24:27], s36 offen lds
    s_add_u32 m0, s3, 1024
    s_add_u32 s36, s38, 2560
    buffer_load_dwordx4 v18, s[24:27], s36 offen lds
    s_add_u32 m0, s3, 2048
    s_add_u32 s36, s38, 10240
    buffer_load_dwordx4 v18, s[24:27], s36 offen lds
    s_add_u32 m0, s3, 3072
    s_add_u32 s36, s38, 12800
    buffer_load_dwordx4 v18, s[24:27], s36 offen lds
    s_add_u32 m0, s3, 4096
    s_add_u32 s36, s38, 40960
    buffer_load_dwordx4 v18, s[24:27], s36 offen lds
    s_add_u32 m0, s3, 5120
    s_add_u32 s36, s38, 43520
    buffer_load_dwordx4 v18, s[24:27], s36 offen lds
    s_add_u32 m0, s3, 6144
    s_add_u32 s36, s38, 51200
    buffer_load_dwordx4 v18, s[24:27], s36 offen lds
    s_add_u32 m0, s3, 7168
    s_add_u32 s36, s38, 53760
    buffer_load_dwordx4 v18, s[24:27], s36 offen lds
    s_add_u32 m0, s3, 8192
    s_add_u32 s36, s38, 81920
    buffer_load_dwordx4 v18, s[24:27], s36 offen lds
    s_add_u32 m0, s3, 9216
    s_add_u32 s36, s38, 84480
    buffer_load_dwordx4 v18, s[24:27], s36 offen lds
    s_add_u32 m0, s3, 10240
    s_add_u32 s36, s38, 92160
    buffer_load_dwordx4 v18, s[24:27], s36 offen lds
    s_add_u32 m0, s3, 11264
    s_add_u32 s36, s38, 94720
    buffer_load_dwordx4 v18, s[24:27], s36 offen lds
    s_add_u32 m0, s3, 12288
    s_add_u32 s36, s38, 122880
    buffer_load_dwordx4 v18, s[24:27], s36 offen lds
    s_add_u32 m0, s3, 13312
    s_add_u32 s36, s38, 125440
    buffer_load_dwordx4 v18, s[24:27], s36 offen lds
    s_add_u32 m0, s3, 14336
    s_add_u32 s36, s38, 133120
    buffer_load_dwordx4 v18, s[24:27], s36 offen lds
    s_add_u32 m0, s3, 15360
    s_add_u32 s36, s38, 135680
    buffer_load_dwordx4 v18, s[24:27], s36 offen lds
    s_waitcnt vmcnt(28)
    s_barrier
    s_add_u32 m0, s42, 114688
    s_add_u32 s36, s41, 1572864
    buffer_load_dwordx4 v16, s[16:19], s36 offen lds
    s_add_u32 m0, s42, 115712
    s_add_u32 s36, s41, 1605632
    buffer_load_dwordx4 v17, s[16:19], s36 offen lds
    s_add_u32 m0, s42, 116736
    s_add_u32 s36, s41, 1703936
    buffer_load_dwordx4 v16, s[16:19], s36 offen lds
    s_add_u32 m0, s42, 117760
    s_add_u32 s36, s41, 1736704
    buffer_load_dwordx4 v17, s[16:19], s36 offen lds
    v_add_u32 v21, 147456, v19
    v_add_u32 v22, 147456, v20
    ds_read_b64_tr_b16 a[64:65], v21 offset:0
    ds_read_b64_tr_b16 a[66:67], v21 offset:4096
    ds_read_b64_tr_b16 a[68:69], v21 offset:8192
    ds_read_b64_tr_b16 a[70:71], v21 offset:12288
    ds_read_b64_tr_b16 a[72:73], v22 offset:0
    ds_read_b64_tr_b16 a[74:75], v22 offset:4096
    ds_read_b64_tr_b16 a[76:77], v22 offset:8192
    ds_read_b64_tr_b16 a[78:79], v22 offset:12288
    s_waitcnt lgkmcnt(0)
    s_waitcnt vmcnt(28)
    s_barrier
    s_add_u32 m0, s42, 147456
    s_add_u32 s36, s41, 1572864
    buffer_load_dwordx4 v16, s[20:23], s36 offen lds
    s_add_u32 m0, s42, 148480
    s_add_u32 s36, s41, 1605632
    buffer_load_dwordx4 v17, s[20:23], s36 offen lds
    s_add_u32 m0, s42, 149504
    s_add_u32 s36, s41, 1703936
    buffer_load_dwordx4 v16, s[20:23], s36 offen lds
    s_add_u32 m0, s42, 150528
    s_add_u32 s36, s41, 1736704
    buffer_load_dwordx4 v17, s[20:23], s36 offen lds
    v_add_u32 v21, 0, v19
    v_add_u32 v22, 0, v20
    ds_read_b64_tr_b16 a[80:81], v21 offset:0
    ds_read_b64_tr_b16 a[82:83], v21 offset:4096
    ds_read_b64_tr_b16 a[84:85], v21 offset:8192
    ds_read_b64_tr_b16 a[86:87], v21 offset:12288
    ds_read_b64_tr_b16 a[88:89], v22 offset:0
    ds_read_b64_tr_b16 a[90:91], v22 offset:4096
    ds_read_b64_tr_b16 a[92:93], v22 offset:8192
    ds_read_b64_tr_b16 a[94:95], v22 offset:12288
    s_waitcnt lgkmcnt(0)
    s_waitcnt vmcnt(28)
    s_barrier
    s_add_u32 m0, s42, 0
    s_add_u32 s36, s41, 2097152
    buffer_load_dwordx4 v16, s[12:15], s36 offen lds
    s_add_u32 m0, s42, 1024
    s_add_u32 s36, s41, 2129920
    buffer_load_dwordx4 v17, s[12:15], s36 offen lds
    s_add_u32 m0, s42, 2048
    s_add_u32 s36, s41, 2228224
    buffer_load_dwordx4 v16, s[12:15], s36 offen lds
    s_add_u32 m0, s42, 3072
    s_add_u32 s36, s41, 2260992
    buffer_load_dwordx4 v17, s[12:15], s36 offen lds
    v_add_u32 v21, 40960, v19
    v_add_u32 v22, 40960, v20
    ds_read_b64_tr_b16 a[96:97], v21 offset:0
    ds_read_b64_tr_b16 a[98:99], v21 offset:4096
    ds_read_b64_tr_b16 a[100:101], v21 offset:8192
    ds_read_b64_tr_b16 a[102:103], v21 offset:12288
    ds_read_b64_tr_b16 a[104:105], v22 offset:0
    ds_read_b64_tr_b16 a[106:107], v22 offset:4096
    ds_read_b64_tr_b16 a[108:109], v22 offset:8192
    ds_read_b64_tr_b16 a[110:111], v22 offset:12288
    s_waitcnt lgkmcnt(0)
    s_waitcnt vmcnt(28)
    s_barrier
    s_add_u32 m0, s42, 40960
    s_add_u32 s36, s41, 2097152
    buffer_load_dwordx4 v16, s[16:19], s36 offen lds
    s_add_u32 m0, s42, 41984
    s_add_u32 s36, s41, 2129920
    buffer_load_dwordx4 v17, s[16:19], s36 offen lds
    s_add_u32 m0, s42, 43008
    s_add_u32 s36, s41, 2228224
    buffer_load_dwordx4 v16, s[16:19], s36 offen lds
    s_add_u32 m0, s42, 44032
    s_add_u32 s36, s41, 2260992
    buffer_load_dwordx4 v17, s[16:19], s36 offen lds
    v_add_u32 v21, 81920, v19
    v_add_u32 v22, 81920, v20
    ds_read_b64_tr_b16 a[112:113], v21 offset:0
    ds_read_b64_tr_b16 a[114:115], v21 offset:4096
    ds_read_b64_tr_b16 a[116:117], v21 offset:8192
    ds_read_b64_tr_b16 a[118:119], v21 offset:12288
    ds_read_b64_tr_b16 a[120:121], v22 offset:0
    ds_read_b64_tr_b16 a[122:123], v22 offset:4096
    ds_read_b64_tr_b16 a[124:125], v22 offset:8192
    ds_read_b64_tr_b16 a[126:127], v22 offset:12288
    s_waitcnt lgkmcnt(0)
    s_waitcnt vmcnt(12)
    s_barrier
    s_add_u32 m0, s42, 81920
    s_add_u32 s36, s41, 2097152
    buffer_load_dwordx4 v16, s[20:23], s36 offen lds
    s_add_u32 m0, s42, 82944
    s_add_u32 s36, s41, 2129920
    buffer_load_dwordx4 v17, s[20:23], s36 offen lds
    s_add_u32 m0, s42, 83968
    s_add_u32 s36, s41, 2228224
    buffer_load_dwordx4 v16, s[20:23], s36 offen lds
    s_add_u32 m0, s42, 84992
    s_add_u32 s36, s41, 2260992
    buffer_load_dwordx4 v17, s[20:23], s36 offen lds
    v_add_u32 v21, 114688, v19
    v_add_u32 v22, 114688, v20
    ds_read_b64_tr_b16 a[128:129], v21 offset:0
    ds_read_b64_tr_b16 a[130:131], v21 offset:4096
    ds_read_b64_tr_b16 a[132:133], v21 offset:8192
    ds_read_b64_tr_b16 a[134:135], v21 offset:12288
    ds_read_b64_tr_b16 a[136:137], v22 offset:0
    ds_read_b64_tr_b16 a[138:139], v22 offset:4096
    ds_read_b64_tr_b16 a[140:141], v22 offset:8192
    ds_read_b64_tr_b16 a[142:143], v22 offset:12288
    s_waitcnt lgkmcnt(0)
    s_waitcnt vmcnt(12)
    s_barrier
    s_add_u32 m0, s42, 114688
    s_add_u32 s36, s40, 0
    buffer_load_dwordx4 v16, s[12:15], s36 offen lds
    s_add_u32 m0, s42, 115712
    s_add_u32 s36, s40, 32768
    buffer_load_dwordx4 v17, s[12:15], s36 offen lds
    s_add_u32 m0, s42, 116736
    s_add_u32 s36, s40, 131072
    buffer_load_dwordx4 v16, s[12:15], s36 offen lds
    s_add_u32 m0, s42, 117760
    s_add_u32 s36, s40, 163840
    buffer_load_dwordx4 v17, s[12:15], s36 offen lds
    v_add_u32 v21, 147456, v19
    v_add_u32 v22, 147456, v20
    ds_read_b64_tr_b16 a[144:145], v21 offset:0
    ds_read_b64_tr_b16 a[146:147], v21 offset:4096
    ds_read_b64_tr_b16 a[148:149], v21 offset:8192
    ds_read_b64_tr_b16 a[150:151], v21 offset:12288
    ds_read_b64_tr_b16 a[152:153], v22 offset:0
    ds_read_b64_tr_b16 a[154:155], v22 offset:4096
    ds_read_b64_tr_b16 a[156:157], v22 offset:8192
    ds_read_b64_tr_b16 a[158:159], v22 offset:12288
    s_waitcnt lgkmcnt(0)
    s_waitcnt vmcnt(24)
    ds_read_b64_tr_b16 v[112:113], v23 offset:0
    ds_read_b64_tr_b16 v[114:115], v23 offset:1024
    ds_read_b64_tr_b16 v[116:117], v23 offset:2048
    ds_read_b64_tr_b16 v[118:119], v23 offset:3072
    ds_read_b64_tr_b16 v[120:121], v23 offset:4096
    ds_read_b64_tr_b16 v[122:123], v23 offset:5120
    ds_read_b64_tr_b16 v[124:125], v23 offset:6144
    ds_read_b64_tr_b16 v[126:127], v23 offset:7168
    ds_read_b64_tr_b16 v[128:129], v23 offset:8192
    ds_read_b64_tr_b16 v[130:131], v23 offset:9216
    ds_read_b64_tr_b16 v[132:133], v23 offset:10240
    ds_read_b64_tr_b16 v[134:135], v23 offset:11264
    ds_read_b64_tr_b16 v[136:137], v23 offset:12288
    ds_read_b64_tr_b16 v[138:139], v23 offset:13312
    ds_read_b64_tr_b16 v[140:141], v23 offset:14336
    ds_read_b64_tr_b16 v[142:143], v23 offset:15360
    s_waitcnt lgkmcnt(0)
    s_waitcnt vmcnt(12)
    s_barrier
    s_add_u32 m0, s42, 147456
    s_add_u32 s36, s40, 0
    buffer_load_dwordx4 v16, s[16:19], s36 offen lds
    s_add_u32 m0, s42, 148480
    s_add_u32 s36, s40, 32768
    buffer_load_dwordx4 v17, s[16:19], s36 offen lds
    s_add_u32 m0, s42, 149504
    s_add_u32 s36, s40, 131072
    buffer_load_dwordx4 v16, s[16:19], s36 offen lds
    s_add_u32 m0, s42, 150528
    s_add_u32 s36, s40, 163840
    buffer_load_dwordx4 v17, s[16:19], s36 offen lds
    v_add_u32 v21, 0, v19
    v_add_u32 v22, 0, v20
    ds_read_b64_tr_b16 a[160:161], v21 offset:0
    ds_read_b64_tr_b16 a[162:163], v21 offset:4096
    ds_read_b64_tr_b16 a[164:165], v21 offset:8192
    ds_read_b64_tr_b16 a[166:167], v21 offset:12288
    ds_read_b64_tr_b16 a[168:169], v22 offset:0
    ds_read_b64_tr_b16 a[170:171], v22 offset:4096
    ds_read_b64_tr_b16 a[172:173], v22 offset:8192
    ds_read_b64_tr_b16 a[174:175], v22 offset:12288
    s_waitcnt lgkmcnt(0)
    s_waitcnt vmcnt(12)
    s_barrier
    s_add_u32 m0, s42, 0
    s_add_u32 s36, s40, 0
    buffer_load_dwordx4 v16, s[20:23], s36 offen lds
    s_add_u32 m0, s42, 1024
    s_add_u32 s36, s40, 32768
    buffer_load_dwordx4 v17, s[20:23], s36 offen lds
    s_add_u32 m0, s42, 2048
    s_add_u32 s36, s40, 131072
    buffer_load_dwordx4 v16, s[20:23], s36 offen lds
    s_add_u32 m0, s42, 3072
    s_add_u32 s36, s40, 163840
    buffer_load_dwordx4 v17, s[20:23], s36 offen lds
    v_add_u32 v21, 40960, v19
    v_add_u32 v22, 40960, v20
    ds_read_b64_tr_b16 a[176:177], v21 offset:0
    ds_read_b64_tr_b16 a[178:179], v21 offset:4096
    ds_read_b64_tr_b16 a[180:181], v21 offset:8192
    ds_read_b64_tr_b16 a[182:183], v21 offset:12288
    ds_read_b64_tr_b16 a[184:185], v22 offset:0
    ds_read_b64_tr_b16 a[186:187], v22 offset:4096
    ds_read_b64_tr_b16 a[188:189], v22 offset:8192
    ds_read_b64_tr_b16 a[190:191], v22 offset:12288
    s_waitcnt lgkmcnt(0)
    s_waitcnt vmcnt(12)
    s_barrier
    s_add_u32 m0, s42, 40960
    s_add_u32 s36, s40, 524288
    buffer_load_dwordx4 v16, s[12:15], s36 offen lds
    s_add_u32 m0, s42, 41984
    s_add_u32 s36, s40, 557056
    buffer_load_dwordx4 v17, s[12:15], s36 offen lds
    s_add_u32 m0, s42, 43008
    s_add_u32 s36, s40, 655360
    buffer_load_dwordx4 v16, s[12:15], s36 offen lds
    s_add_u32 m0, s42, 44032
    s_add_u32 s36, s40, 688128
    buffer_load_dwordx4 v17, s[12:15], s36 offen lds
    v_add_u32 v21, 81920, v19
    v_add_u32 v22, 81920, v20
    ds_read_b64_tr_b16 a[192:193], v21 offset:0
    ds_read_b64_tr_b16 a[194:195], v21 offset:4096
    ds_read_b64_tr_b16 a[196:197], v21 offset:8192
    ds_read_b64_tr_b16 a[198:199], v21 offset:12288
    ds_read_b64_tr_b16 a[200:201], v22 offset:0
    ds_read_b64_tr_b16 a[202:203], v22 offset:4096
    ds_read_b64_tr_b16 a[204:205], v22 offset:8192
    ds_read_b64_tr_b16 a[206:207], v22 offset:12288
    s_waitcnt lgkmcnt(0)
    s_waitcnt vmcnt(12)
    s_barrier
    s_add_u32 m0, s42, 81920
    s_add_u32 s36, s40, 524288
    buffer_load_dwordx4 v16, s[16:19], s36 offen lds
    s_add_u32 m0, s42, 82944
    s_add_u32 s36, s40, 557056
    buffer_load_dwordx4 v17, s[16:19], s36 offen lds
    s_add_u32 m0, s42, 83968
    s_add_u32 s36, s40, 655360
    buffer_load_dwordx4 v16, s[16:19], s36 offen lds
    s_add_u32 m0, s42, 84992
    s_add_u32 s36, s40, 688128
    buffer_load_dwordx4 v17, s[16:19], s36 offen lds
    v_add_u32 v21, 114688, v19
    v_add_u32 v22, 114688, v20
    ds_read_b64_tr_b16 v[24:25], v21 offset:0
    ds_read_b64_tr_b16 v[26:27], v21 offset:4096
    ds_read_b64_tr_b16 v[28:29], v21 offset:8192
    ds_read_b64_tr_b16 v[30:31], v21 offset:12288
    ds_read_b64_tr_b16 v[144:145], v22 offset:0
    ds_read_b64_tr_b16 v[146:147], v22 offset:4096
    ds_read_b64_tr_b16 v[148:149], v22 offset:8192
    ds_read_b64_tr_b16 v[150:151], v22 offset:12288
    s_waitcnt lgkmcnt(0)
    ds_write_b128 v2, v[24:27] offset:0
    ds_write_b128 v2, v[28:31] offset:1024
    s_waitcnt vmcnt(12)
    s_barrier
    s_add_u32 m0, s42, 114688
    s_add_u32 s36, s40, 524288
    buffer_load_dwordx4 v16, s[20:23], s36 offen lds
    s_add_u32 m0, s42, 115712
    s_add_u32 s36, s40, 557056
    buffer_load_dwordx4 v17, s[20:23], s36 offen lds
    s_add_u32 m0, s42, 116736
    s_add_u32 s36, s40, 655360
    buffer_load_dwordx4 v16, s[20:23], s36 offen lds
    s_add_u32 m0, s42, 117760
    s_add_u32 s36, s40, 688128
    buffer_load_dwordx4 v17, s[20:23], s36 offen lds
    v_add_u32 v21, 147456, v19
    v_add_u32 v22, 147456, v20
    ds_read_b64_tr_b16 v[24:25], v21 offset:0
    ds_read_b64_tr_b16 v[26:27], v21 offset:4096
    ds_read_b64_tr_b16 v[28:29], v21 offset:8192
    ds_read_b64_tr_b16 v[30:31], v21 offset:12288
    ds_read_b64_tr_b16 v[152:153], v22 offset:0
    ds_read_b64_tr_b16 v[154:155], v22 offset:4096
    ds_read_b64_tr_b16 v[156:157], v22 offset:8192
    ds_read_b64_tr_b16 v[158:159], v22 offset:12288
    s_waitcnt lgkmcnt(0)
    ds_write_b128 v2, v[24:27] offset:2048
    ds_write_b128 v2, v[28:31] offset:3072
    s_waitcnt vmcnt(12)
    s_barrier
    s_add_u32 m0, s42, 147456
    s_add_u32 s36, s40, 1048576
    buffer_load_dwordx4 v16, s[12:15], s36 offen lds
    s_add_u32 m0, s42, 148480
    s_add_u32 s36, s40, 1081344
    buffer_load_dwordx4 v17, s[12:15], s36 offen lds
    s_add_u32 m0, s42, 149504
    s_add_u32 s36, s40, 1179648
    buffer_load_dwordx4 v16, s[12:15], s36 offen lds
    s_add_u32 m0, s42, 150528
    s_add_u32 s36, s40, 1212416
    buffer_load_dwordx4 v17, s[12:15], s36 offen lds
    v_add_u32 v21, 0, v19
    v_add_u32 v22, 0, v20
    ds_read_b64_tr_b16 v[24:25], v21 offset:0
    ds_read_b64_tr_b16 v[26:27], v21 offset:4096
    ds_read_b64_tr_b16 v[28:29], v21 offset:8192
    ds_read_b64_tr_b16 v[30:31], v21 offset:12288
    ds_read_b64_tr_b16 v[160:161], v22 offset:0
    ds_read_b64_tr_b16 v[162:163], v22 offset:4096
    ds_read_b64_tr_b16 v[164:165], v22 offset:8192
    ds_read_b64_tr_b16 v[166:167], v22 offset:12288
    s_waitcnt lgkmcnt(0)
    ds_write_b128 v2, v[24:27] offset:4096
    ds_write_b128 v2, v[28:31] offset:5120
    s_waitcnt vmcnt(12)
    s_barrier
    s_add_u32 m0, s42, 0
    s_add_u32 s36, s40, 1048576
    buffer_load_dwordx4 v16, s[16:19], s36 offen lds
    s_add_u32 m0, s42, 1024
    s_add_u32 s36, s40, 1081344
    buffer_load_dwordx4 v17, s[16:19], s36 offen lds
    s_add_u32 m0, s42, 2048
    s_add_u32 s36, s40, 1179648
    buffer_load_dwordx4 v16, s[16:19], s36 offen lds
    s_add_u32 m0, s42, 3072
    s_add_u32 s36, s40, 1212416
    buffer_load_dwordx4 v17, s[16:19], s36 offen lds
    v_add_u32 v21, 40960, v19
    v_add_u32 v22, 40960, v20
    ds_read_b64_tr_b16 v[24:25], v21 offset:0
    ds_read_b64_tr_b16 v[26:27], v21 offset:4096
    ds_read_b64_tr_b16 v[28:29], v21 offset:8192
    ds_read_b64_tr_b16 v[30:31], v21 offset:12288
    ds_read_b64_tr_b16 v[168:169], v22 offset:0
    ds_read_b64_tr_b16 v[170:171], v22 offset:4096
    ds_read_b64_tr_b16 v[172:173], v22 offset:8192
    ds_read_b64_tr_b16 v[174:175], v22 offset:12288
    s_waitcnt lgkmcnt(0)
    ds_write_b128 v2, v[24:27] offset:6144
    ds_write_b128 v2, v[28:31] offset:7168
    s_waitcnt vmcnt(12)
    s_barrier
    s_add_u32 m0, s42, 40960
    s_add_u32 s36, s40, 1048576
    buffer_load_dwordx4 v16, s[20:23], s36 offen lds
    s_add_u32 m0, s42, 41984
    s_add_u32 s36, s40, 1081344
    buffer_load_dwordx4 v17, s[20:23], s36 offen lds
    s_add_u32 m0, s42, 43008
    s_add_u32 s36, s40, 1179648
    buffer_load_dwordx4 v16, s[20:23], s36 offen lds
    s_add_u32 m0, s42, 44032
    s_add_u32 s36, s40, 1212416
    buffer_load_dwordx4 v17, s[20:23], s36 offen lds
    v_add_u32 v21, 81920, v19
    v_add_u32 v22, 81920, v20
    ds_read_b64_tr_b16 v[24:25], v21 offset:0
    ds_read_b64_tr_b16 v[26:27], v21 offset:4096
    ds_read_b64_tr_b16 v[28:29], v21 offset:8192
    ds_read_b64_tr_b16 v[30:31], v21 offset:12288
    ds_read_b64_tr_b16 v[176:177], v22 offset:0
    ds_read_b64_tr_b16 v[178:179], v22 offset:4096
    ds_read_b64_tr_b16 v[180:181], v22 offset:8192
    ds_read_b64_tr_b16 v[182:183], v22 offset:12288
    s_waitcnt lgkmcnt(0)
    ds_write_b128 v2, v[24:27] offset:8192
    ds_write_b128 v2, v[28:31] offset:9216
    s_waitcnt vmcnt(12)
    s_barrier
    s_add_u32 m0, s42, 81920
    s_add_u32 s36, s40, 1572864
    buffer_load_dwordx4 v16, s[12:15], s36 offen lds
    s_add_u32 m0, s42, 82944
    s_add_u32 s36, s40, 1605632
    buffer_load_dwordx4 v17, s[12:15], s36 offen lds
    s_add_u32 m0, s42, 83968
    s_add_u32 s36, s40, 1703936
    buffer_load_dwordx4 v16, s[12:15], s36 offen lds
    s_add_u32 m0, s42, 84992
    s_add_u32 s36, s40, 1736704
    buffer_load_dwordx4 v17, s[12:15], s36 offen lds
    v_add_u32 v21, 114688, v19
    v_add_u32 v22, 114688, v20
    ds_read_b64_tr_b16 v[24:25], v21 offset:0
    ds_read_b64_tr_b16 v[26:27], v21 offset:4096
    ds_read_b64_tr_b16 v[28:29], v21 offset:8192
    ds_read_b64_tr_b16 v[30:31], v21 offset:12288
    ds_read_b64_tr_b16 v[184:185], v22 offset:0
    ds_read_b64_tr_b16 v[186:187], v22 offset:4096
    ds_read_b64_tr_b16 v[188:189], v22 offset:8192
    ds_read_b64_tr_b16 v[190:191], v22 offset:12288
    s_waitcnt lgkmcnt(0)
    ds_write_b128 v2, v[24:27] offset:10240
    ds_write_b128 v2, v[28:31] offset:11264
    s_waitcnt vmcnt(12)
    s_barrier
    s_add_u32 m0, s42, 114688
    s_add_u32 s36, s40, 1572864
    buffer_load_dwordx4 v16, s[16:19], s36 offen lds
    s_add_u32 m0, s42, 115712
    s_add_u32 s36, s40, 1605632
    buffer_load_dwordx4 v17, s[16:19], s36 offen lds
    s_add_u32 m0, s42, 116736
    s_add_u32 s36, s40, 1703936
    buffer_load_dwordx4 v16, s[16:19], s36 offen lds
    s_add_u32 m0, s42, 117760
    s_add_u32 s36, s40, 1736704
    buffer_load_dwordx4 v17, s[16:19], s36 offen lds
    v_add_u32 v21, 147456, v19
    v_add_u32 v22, 147456, v20
    ds_read_b64_tr_b16 v[24:25], v21 offset:0
    ds_read_b64_tr_b16 v[26:27], v21 offset:4096
    ds_read_b64_tr_b16 v[28:29], v21 offset:8192
    ds_read_b64_tr_b16 v[30:31], v21 offset:12288
    ds_read_b64_tr_b16 v[192:193], v22 offset:0
    ds_read_b64_tr_b16 v[194:195], v22 offset:4096
    ds_read_b64_tr_b16 v[196:197], v22 offset:8192
    ds_read_b64_tr_b16 v[198:199], v22 offset:12288
    s_waitcnt lgkmcnt(0)
    ds_write_b128 v2, v[24:27] offset:12288
    ds_write_b128 v2, v[28:31] offset:13312
    s_waitcnt vmcnt(12)
    s_barrier
    s_add_u32 m0, s42, 147456
    s_add_u32 s36, s40, 1572864
    buffer_load_dwordx4 v16, s[20:23], s36 offen lds
    s_add_u32 m0, s42, 148480
    s_add_u32 s36, s40, 1605632
    buffer_load_dwordx4 v17, s[20:23], s36 offen lds
    s_add_u32 m0, s42, 149504
    s_add_u32 s36, s40, 1703936
    buffer_load_dwordx4 v16, s[20:23], s36 offen lds
    s_add_u32 m0, s42, 150528
    s_add_u32 s36, s40, 1736704
    buffer_load_dwordx4 v17, s[20:23], s36 offen lds
    v_add_u32 v21, 0, v19
    v_add_u32 v22, 0, v20
    ds_read_b64_tr_b16 v[24:25], v21 offset:0
    ds_read_b64_tr_b16 v[26:27], v21 offset:4096
    ds_read_b64_tr_b16 v[28:29], v21 offset:8192
    ds_read_b64_tr_b16 v[30:31], v21 offset:12288
    ds_read_b64_tr_b16 v[200:201], v22 offset:0
    ds_read_b64_tr_b16 v[202:203], v22 offset:4096
    ds_read_b64_tr_b16 v[204:205], v22 offset:8192
    ds_read_b64_tr_b16 v[206:207], v22 offset:12288
    s_waitcnt lgkmcnt(0)
    ds_write_b128 v2, v[24:27] offset:14336
    ds_write_b128 v2, v[28:31] offset:15360
    s_waitcnt vmcnt(12)
    s_barrier
    s_add_u32 m0, s42, 0
    s_add_u32 s36, s40, 2097152
    buffer_load_dwordx4 v16, s[12:15], s36 offen lds
    s_add_u32 m0, s42, 1024
    s_add_u32 s36, s40, 2129920
    buffer_load_dwordx4 v17, s[12:15], s36 offen lds
    s_add_u32 m0, s42, 2048
    s_add_u32 s36, s40, 2228224
    buffer_load_dwordx4 v16, s[12:15], s36 offen lds
    s_add_u32 m0, s42, 3072
    s_add_u32 s36, s40, 2260992
    buffer_load_dwordx4 v17, s[12:15], s36 offen lds
    v_add_u32 v21, 40960, v19
    v_add_u32 v22, 40960, v20
    ds_read_b64_tr_b16 v[24:25], v21 offset:0
    ds_read_b64_tr_b16 v[26:27], v21 offset:4096
    ds_read_b64_tr_b16 v[28:29], v21 offset:8192
    ds_read_b64_tr_b16 v[30:31], v21 offset:12288
    ds_read_b64_tr_b16 v[208:209], v22 offset:0
    ds_read_b64_tr_b16 v[210:211], v22 offset:4096
    ds_read_b64_tr_b16 v[212:213], v22 offset:8192
    ds_read_b64_tr_b16 v[214:215], v22 offset:12288
    s_waitcnt lgkmcnt(0)
    ds_write_b128 v2, v[24:27] offset:16384
    ds_write_b128 v2, v[28:31] offset:17408
    s_waitcnt vmcnt(12)
    s_barrier
    s_add_u32 m0, s42, 40960
    s_add_u32 s36, s40, 2097152
    buffer_load_dwordx4 v16, s[16:19], s36 offen lds
    s_add_u32 m0, s42, 41984
    s_add_u32 s36, s40, 2129920
    buffer_load_dwordx4 v17, s[16:19], s36 offen lds
    s_add_u32 m0, s42, 43008
    s_add_u32 s36, s40, 2228224
    buffer_load_dwordx4 v16, s[16:19], s36 offen lds
    s_add_u32 m0, s42, 44032
    s_add_u32 s36, s40, 2260992
    buffer_load_dwordx4 v17, s[16:19], s36 offen lds
    v_add_u32 v21, 81920, v19
    v_add_u32 v22, 81920, v20
    ds_read_b64_tr_b16 v[24:25], v21 offset:0
    ds_read_b64_tr_b16 v[26:27], v21 offset:4096
    ds_read_b64_tr_b16 v[28:29], v21 offset:8192
    ds_read_b64_tr_b16 v[30:31], v21 offset:12288
    ds_read_b64_tr_b16 v[216:217], v22 offset:0
    ds_read_b64_tr_b16 v[218:219], v22 offset:4096
    ds_read_b64_tr_b16 v[220:221], v22 offset:8192
    ds_read_b64_tr_b16 v[222:223], v22 offset:12288
    s_waitcnt lgkmcnt(0)
    ds_write_b128 v2, v[24:27] offset:18432
    ds_write_b128 v2, v[28:31] offset:19456
    s_waitcnt vmcnt(12)
    s_barrier
    s_add_u32 m0, s42, 81920
    s_add_u32 s36, s40, 2097152
    buffer_load_dwordx4 v16, s[20:23], s36 offen lds
    s_add_u32 m0, s42, 82944
    s_add_u32 s36, s40, 2129920
    buffer_load_dwordx4 v17, s[20:23], s36 offen lds
    s_add_u32 m0, s42, 83968
    s_add_u32 s36, s40, 2228224
    buffer_load_dwordx4 v16, s[20:23], s36 offen lds
    s_add_u32 m0, s42, 84992
    s_add_u32 s36, s40, 2260992
    buffer_load_dwordx4 v17, s[20:23], s36 offen lds
    v_add_u32 v21, 114688, v19
    v_add_u32 v22, 114688, v20
    ds_read_b64_tr_b16 v[24:25], v21 offset:0
    ds_read_b64_tr_b16 v[26:27], v21 offset:4096
    ds_read_b64_tr_b16 v[28:29], v21 offset:8192
    ds_read_b64_tr_b16 v[30:31], v21 offset:12288
    ds_read_b64_tr_b16 v[224:225], v22 offset:0
    ds_read_b64_tr_b16 v[226:227], v22 offset:4096
    ds_read_b64_tr_b16 v[228:229], v22 offset:8192
    ds_read_b64_tr_b16 v[230:231], v22 offset:12288
    s_waitcnt lgkmcnt(0)
    ds_write_b128 v2, v[24:27] offset:20480
    ds_write_b128 v2, v[28:31] offset:21504
    s_waitcnt vmcnt(12)
    s_barrier
    s_add_u32 m0, s42, 114688
    s_add_u32 s36, s41, 0
    buffer_load_dwordx4 v16, s[20:23], s36 offen lds
    s_add_u32 m0, s42, 115712
    s_add_u32 s36, s41, 32768
    buffer_load_dwordx4 v17, s[20:23], s36 offen lds
    s_add_u32 m0, s42, 116736
    s_add_u32 s36, s41, 131072
    buffer_load_dwordx4 v16, s[20:23], s36 offen lds
    s_add_u32 m0, s42, 117760
    s_add_u32 s36, s41, 163840
    buffer_load_dwordx4 v17, s[20:23], s36 offen lds
    v_add_u32 v21, 147456, v19
    v_add_u32 v22, 147456, v20
    ds_read_b64_tr_b16 v[24:25], v21 offset:0
    ds_read_b64_tr_b16 v[26:27], v21 offset:4096
    ds_read_b64_tr_b16 v[28:29], v21 offset:8192
    ds_read_b64_tr_b16 v[30:31], v21 offset:12288
    ds_read_b64_tr_b16 v[232:233], v22 offset:0
    ds_read_b64_tr_b16 v[234:235], v22 offset:4096
    ds_read_b64_tr_b16 v[236:237], v22 offset:8192
    ds_read_b64_tr_b16 v[238:239], v22 offset:12288
    s_waitcnt lgkmcnt(0)
    ds_write_b128 v2, v[24:27] offset:22528
    ds_write_b128 v2, v[28:31] offset:23552
    s_waitcnt vmcnt(12)
    s_barrier
    s_add_u32 m0, s42, 147456
    s_add_u32 s36, s41, 524288
    buffer_load_dwordx4 v16, s[20:23], s36 offen lds
    s_add_u32 m0, s42, 148480
    s_add_u32 s36, s41, 557056
    buffer_load_dwordx4 v17, s[20:23], s36 offen lds
    s_add_u32 m0, s42, 149504
    s_add_u32 s36, s41, 655360
    buffer_load_dwordx4 v16, s[20:23], s36 offen lds
    s_add_u32 m0, s42, 150528
    s_add_u32 s36, s41, 688128
    buffer_load_dwordx4 v17, s[20:23], s36 offen lds
    v_add_u32 v21, 0, v19
    v_add_u32 v22, 0, v20
    ds_read_b64_tr_b16 v[64:65], v21 offset:0
    ds_read_b64_tr_b16 v[66:67], v21 offset:4096
    ds_read_b64_tr_b16 v[68:69], v21 offset:8192
    ds_read_b64_tr_b16 v[70:71], v21 offset:12288
    ds_read_b64_tr_b16 v[240:241], v22 offset:0
    ds_read_b64_tr_b16 v[242:243], v22 offset:4096
    ds_read_b64_tr_b16 v[244:245], v22 offset:8192
    ds_read_b64_tr_b16 v[246:247], v22 offset:12288
    s_waitcnt lgkmcnt(0)
    s_waitcnt vmcnt(12)
    s_barrier
    v_add_u32 v21, 40960, v19
    v_add_u32 v22, 40960, v20
    ds_read_b64_tr_b16 v[72:73], v21 offset:0
    ds_read_b64_tr_b16 v[74:75], v21 offset:4096
    ds_read_b64_tr_b16 v[76:77], v21 offset:8192
    ds_read_b64_tr_b16 v[78:79], v21 offset:12288
    ds_read_b64_tr_b16 v[80:81], v22 offset:0
    ds_read_b64_tr_b16 v[82:83], v22 offset:4096
    ds_read_b64_tr_b16 v[84:85], v22 offset:8192
    ds_read_b64_tr_b16 v[86:87], v22 offset:12288
    s_waitcnt lgkmcnt(0)
    s_waitcnt vmcnt(8)
    s_barrier
    v_add_u32 v21, 81920, v19
    v_add_u32 v22, 81920, v20
    ds_read_b64_tr_b16 v[248:249], v21 offset:0
    ds_read_b64_tr_b16 v[250:251], v21 offset:4096
    ds_read_b64_tr_b16 v[252:253], v21 offset:8192
    ds_read_b64_tr_b16 v[254:255], v21 offset:12288
    ds_read_b64_tr_b16 v[88:89], v22 offset:0
    ds_read_b64_tr_b16 v[90:91], v22 offset:4096
    ds_read_b64_tr_b16 v[92:93], v22 offset:8192
    ds_read_b64_tr_b16 v[94:95], v22 offset:12288
    s_waitcnt lgkmcnt(0)
    s_waitcnt vmcnt(4)
    s_barrier
    v_add_u32 v21, 114688, v19
    v_add_u32 v22, 114688, v20
    ds_read_b64_tr_b16 v[36:37], v21 offset:0
    ds_read_b64_tr_b16 v[38:39], v21 offset:4096
    ds_read_b64_tr_b16 v[40:41], v21 offset:8192
    ds_read_b64_tr_b16 v[42:43], v21 offset:12288
    ds_read_b64_tr_b16 v[44:45], v22 offset:0
    ds_read_b64_tr_b16 v[46:47], v22 offset:4096
    ds_read_b64_tr_b16 v[48:49], v22 offset:8192
    ds_read_b64_tr_b16 v[50:51], v22 offset:12288
    s_waitcnt lgkmcnt(0)
    s_waitcnt vmcnt(0)
    s_barrier
    v_add_u32 v21, 147456, v19
    v_add_u32 v22, 147456, v20
    ds_read_b64_tr_b16 v[52:53], v21 offset:0
    ds_read_b64_tr_b16 v[54:55], v21 offset:4096
    ds_read_b64_tr_b16 v[56:57], v21 offset:8192
    ds_read_b64_tr_b16 v[58:59], v21 offset:12288
    ds_read_b64_tr_b16 v[60:61], v22 offset:0
    ds_read_b64_tr_b16 v[62:63], v22 offset:4096
    ds_read_b64_tr_b16 v[12:13], v22 offset:8192
    ds_read_b64_tr_b16 v[14:15], v22 offset:12288
    s_waitcnt lgkmcnt(0)
    s_barrier
    ds_write_b128 v2, v[64:67] offset:24576
    ds_write_b128 v2, v[68:71] offset:25600
    ds_write_b128 v2, v[72:75] offset:26624
    ds_write_b128 v2, v[76:79] offset:27648
    ds_write_b128 v2, v[80:83] offset:28672
    ds_write_b128 v2, v[84:87] offset:29696
    ds_write_b128 v2, v[88:91] offset:30720
    ds_write_b128 v2, v[92:95] offset:31744
    ds_write_b128 v2, v[36:39] offset:32768
    ds_write_b128 v2, v[40:43] offset:33792
    ds_write_b128 v2, v[44:47] offset:34816
    ds_write_b128 v2, v[48:51] offset:35840
    ds_write_b128 v2, v[52:55] offset:36864
    ds_write_b128 v2, v[56:59] offset:37888
    ds_write_b128 v2, v[60:63] offset:38912
    ds_write_b128 v2, v[12:15] offset:39936
    s_waitcnt lgkmcnt(0)
    s_lshl_b32 s36, s9, 13
    s_lshl_b32 s37, s10, 12
    s_add_u32 m0, s37, 8192
    s_add_u32 s25, s36, s37
    s_add_u32 s25, s25, 0
    v_mov_b32 v10, 40
cin_1:
    s_sub_u32 s88, s88, 1
    s_cbranch_scc1 k_end
    global_load_dword v9, v10, s[6:7] sc1
    s_waitcnt vmcnt(0)
    v_cmp_eq_u32 vcc, 0, v9
    s_cbranch_vccnz cin_1
    s_lshl_b32 s36, s9, 2
    s_add_u32 s37, s36, 69730560
    s_add_u32 s30, s4, s37
    s_addc_u32 s31, s5, 0
    s_lshl_b32 s37, s8, 7
    s_add_u32 s93, s36, s37
    s_add_u32 s93, s93, 69731328
    s_cmp_eq_u32 s10, 0
    s_cselect_b32 s74, 1, 0
    s_mov_b32 s75, 0
    s_mov_b32 s92, 0
    s_add_u32 s39, s11, 2
    s_min_u32 s39, s39, 64
cpj_2:
    s_cmp_ge_u32 s92, s39
    s_cbranch_scc1 cpk_3
    s_sub_u32 s88, s88, 1
    s_cbranch_scc1 k_end
    s_load_dword s70, s[30:31], 0 glc
    s_load_dword s71, s[30:31], 128 glc
    s_load_dword s72, s[30:31], 384 glc
    s_load_dword s73, s[30:31], 512 glc
    s_waitcnt lgkmcnt(0)
    s_min_u32 s70, s70, s71
    s_min_u32 s72, s72, s73
    s_lshl_b32 s70, s70, 1
    s_lshl_b32 s72, s72, 1
    s_add_u32 s72, s72, 1
    s_min_u32 s92, s70, s72
    s_branch cpj_2
cpk_3:
    buffer_load_dwordx4 v0, s[32:35], s25 offen offset:0 sc1 lds
    buffer_load_dwordx4 v0, s[32:35], s25 offen offset:1024 sc1 lds
    buffer_load_dwordx4 v0, s[32:35], s25 offen offset:2048 sc1 lds
    buffer_load_dwordx4 v0, s[32:35], s25 offen offset:3072 sc1 lds
    s_waitcnt vmcnt(0)
    s_barrier
    s_cmp_eq_u32 s10, 0
    s_cbranch_scc0 carr_4
    v_mov_b32 v9, 32
    v_mov_b32 v10, 1
    s_mov_b64 exec, 1
    global_atomic_add v9, v10, s[6:7]
    s_mov_b64 exec, -1
carr_4:
    v_mov_b32 v9, 32
cwait_5:
    s_sub_u32 s88, s88, 1
    s_cbranch_scc1 k_end
    global_load_dwordx2 v[12:13], v9, s[6:7] sc1
    s_waitcnt vmcnt(0)
    v_readfirstlane_b32 s36, v12
    v_readfirstlane_b32 s37, v13
    s_cmp_lt_u32 s36, 64
    s_cbranch_scc1 cwait_5
    s_cmp_eq_u32 s37, 0
    s_cbranch_scc1 cwait_5
    s_and_b32 s42, s37, 2
    s_lshl_b32 s42, s42, 12
    v_lshrrev_b32 v11, 7, v0
    v_lshlrev_b32 v11, 8, v11
    v_and_b32 v9, 0x70, v0
    v_add_u32 v11, v11, v9
    s_memtime s[82:83]
    s_memrealtime s[84:85]
    s_waitcnt lgkmcnt(0)
    v_lshrrev_b32 v9, 7, v1
    v_lshlrev_b32 v9, 3, v9
    v_xor_b32 v1, v1, v9
    ds_read_b128 v[64:67], v2 offset:0
    ds_read_b128 v[68:71], v2 offset:1024
    ds_read_b128 v[72:75], v2 offset:2048
    ds_read_b128 v[76:79], v2 offset:3072
    ds_read_b128 v[80:83], v2 offset:4096
    ds_read_b128 v[84:87], v2 offset:5120
    ds_read_b128 v[88:91], v2 offset:6144
    ds_read_b128 v[92:95], v2 offset:7168
    v_mov_b64 v[12:13], 0
    v_mov_b64 v[14:15], 0
    v_mov_b64 v[16:17], 0
    v_mov_b64 v[18:19], 0
    v_mov_b64 v[20:21], 0
    v_mov_b64 v[22:23], 0
    v_mov_b64 v[24:25], 0
    v_mov_b64 v[26:27], 0
    v_mov_b64 v[28:29], 0
    v_mov_b64 v[30:31], 0
    v_mov_b64 v[32:33], 0
    v_mov_b64 v[34:35], 0
    s_lshl_b32 s36, s8, 17
    s_add_u32 s12, s36, 69206016
    s_add_u32 s13, s12, 0x4000
    s_add_u32 s14, s12, 0x8000
    s_and_b32 s29, s9, 1
    s_mul_i32 s29, s29, 10240
    s_add_u32 s18, s12, s29
    s_xor_b32 s28, s18, 2048
    s_add_u32 s15, s18, 4096
    s_lshl_b32 s36, s8, 20
    s_add_u32 s36, s36, s42
    s_add_u32 s16, s36, 67108864
    s_xor_b32 s19, s16, 0x100000
    s_add_u32 s20, s19, 4096
    s_lshl_b32 s36, s8, 19
    s_add_u32 s21, s36, 70254592
    s_mul_i32 s37, s3, 4352
    s_add_u32 s22, s21, s37
    s_mov_b32 s26, 0
    s_mov_b32 s17, 0
    s_mov_b32 s27, 0x10000
    s_lshl_b32 s36, s9, 13
    s_lshl_b32 s37, s10, 11
    s_add_u32 s23, s36, s37
    s_add_u32 s23, s23, 16777216
    s_lshl_b32 s37, s10, 12
    s_add_u32 s25, s36, s37
    s_add_u32 s25, s25, 262144
    s_lshr_b32 s36, s9, 1
    s_lshl_b32 s36, s36, 14
    s_and_b32 s37, s9, 1
    s_lshl_b32 s37, s37, 12
    s_add_u32 s24, s36, s37
    s_lshl_b32 s37, s8, 11
    s_add_u32 s24, s24, s37
    s_lshl_b32 s37, s10, 9
    s_add_u32 s24, s24, s37
    s_add_u32 s24, s24, s42
    s_add_u32 s24, s24, 50331648
    s_sub_u32 s100, 0, s8
    s_mov_b32 s101, s100
cA_top:
    s_barrier
    s_nop 15
    s_nop 15
    s_nop 15
    s_nop 6
    buffer_load_dwordx4 v[36:39], v11, s[32:35], s18 offen offset:0 sc1
    s_nop 11
    buffer_load_dwordx4 v[40:43], v11, s[32:35], s28 offen offset:0 sc1
    s_nop 11
    buffer_load_dwordx4 v[44:47], v11, s[32:35], s18 offen offset:128 sc1
    s_nop 11
    buffer_load_dwordx4 v[48:51], v11, s[32:35], s28 offen offset:128 sc1
    s_nop 11
    buffer_load_dwordx4 v[52:55], v11, s[32:35], s15 offen offset:0 sc1
    s_waitcnt vmcnt(4)
    v_max3_u32 v9, v36, v37, v38
    v_max_u32 v9, v9, v39
    v_cmp_eq_u32 vcc, -1, v9
    s_cbranch_vccnz cA_slowL0
cA_backL0:
    s_waitcnt lgkmcnt(6)
    v_smfmac_f32_16x16x64_bf16 v[12:15], v[36:39], v[64:71], v3
    ds_read_b128 v[64:67], v2 offset:8192
    ds_read_b128 v[68:71], v2 offset:9216
    v_smfmac_f32_16x16x64_bf16 v[16:19], v[36:39], v[144:151], v3
    s_waitcnt vmcnt(3)
    v_max3_u32 v9, v40, v41, v42
    s_waitcnt lgkmcnt(6)
    v_smfmac_f32_16x16x64_bf16 v[20:23], v[36:39], v[72:79], v3
    ds_read_b128 v[72:75], v2 offset:10240
    ds_read_b128 v[76:79], v2 offset:11264
    v_max_u32 v9, v9, v43
    v_smfmac_f32_16x16x64_bf16 v[24:27], v[36:39], v[152:159], v3
    v_cmp_eq_u32 vcc, -1, v9
    s_waitcnt lgkmcnt(6)
    v_smfmac_f32_16x16x64_bf16 v[28:31], v[36:39], v[80:87], v3
    ds_read_b128 v[80:83], v2 offset:12288
    ds_read_b128 v[84:87], v2 offset:13312
    v_smfmac_f32_16x16x64_bf16 v[32:35], v[36:39], v[160:167], v3
    s_cbranch_vccnz cA_slowL1
cA_backL1:
    buffer_load_dwordx4 v[56:59], v11, s[32:35], s19 offen offset:0 sc1
    buffer_load_dwordx4 v[60:63], v11, s[32:35], s19 offen offset:2048 sc1
    s_waitcnt lgkmcnt(6)
    v_smfmac_f32_16x16x64_bf16 v[12:15], v[40:43], v[88:95], v3
    ds_read_b128 v[88:91], v2 offset:14336
    ds_read_b128 v[92:95], v2 offset:15360
    v_smfmac_f32_16x16x64_bf16 v[16:19], v[40:43], v[168:175], v3
    s_waitcnt vmcnt(4)
    v_max3_u32 v9, v44, v45, v46
    s_waitcnt lgkmcnt(6)
    v_smfmac_f32_16x16x64_bf16 v[20:23], v[40:43], v[64:71], v3
    ds_read_b128 v[64:67], v2 offset:16384
    ds_read_b128 v[68:71], v2 offset:17408
    v_max_u32 v9, v9, v47
    v_smfmac_f32_16x16x64_bf16 v[24:27], v[40:43], v[176:183], v3
    v_cmp_eq_u32 vcc, -1, v9
    s_waitcnt lgkmcnt(6)
    v_smfmac_f32_16x16x64_bf16 v[28:31], v[40:43], v[72:79], v3
    ds_read_b128 v[72:75], v2 offset:18432
    ds_read_b128 v[76:79], v2 offset:19456
    v_smfmac_f32_16x16x64_bf16 v[32:35], v[40:43], v[184:191], v3
    s_cbranch_vccnz cA_slowL2
cA_backL2:
    buffer_load_dwordx4 v[36:39], v11, s[32:35], s19 offen offset:128 sc1
    buffer_load_dwordx4 v[40:43], v11, s[32:35], s19 offen offset:2176 sc1
    s_waitcnt lgkmcnt(6)
    v_smfmac_f32_16x16x64_bf16 v[12:15], v[44:47], v[80:87], v3
    ds_read_b128 v[80:83], v2 offset:20480
    ds_read_b128 v[84:87], v2 offset:21504
    v_smfmac_f32_16x16x64_bf16 v[16:19], v[44:47], v[192:199], v3
    s_waitcnt vmcnt(5)
    v_max3_u32 v9, v48, v49, v50
    s_waitcnt lgkmcnt(6)
    v_smfmac_f32_16x16x64_bf16 v[20:23], v[44:47], v[88:95], v3
    ds_read_b128 v[88:91], v2 offset:22528
    ds_read_b128 v[92:95], v2 offset:23552
    v_max_u32 v9, v9, v51
    v_smfmac_f32_16x16x64_bf16 v[24:27], v[44:47], v[200:207], v3
    v_cmp_eq_u32 vcc, -1, v9
    s_waitcnt lgkmcnt(6)
    v_smfmac_f32_16x16x64_bf16 v[28:31], v[44:47], v[64:71], v3
    ds_read_b128 v[64:67], v2 offset:24576
    ds_read_b128 v[68:71], v2 offset:25600
    v_smfmac_f32_16x16x64_bf16 v[32:35], v[44:47], v[208:215], v3
    s_cbranch_vccnz cA_slowL3
cA_backL3:
    buffer_load_dwordx4 v[44:47], v11, s[32:35], s20 offen offset:0 sc1
    s_waitcnt lgkmcnt(6)
    v_smfmac_f32_16x16x64_bf16 v[12:15], v[48:51], v[72:79], v3
    ds_read_b128 v[72:75], v2 offset:26624
    ds_read_b128 v[76:79], v2 offset:27648
    v_smfmac_f32_16x16x64_bf16 v[16:19], v[48:51], v[216:223], v3
    s_waitcnt vmcnt(5)
    v_max3_u32 v9, v52, v53, v54
    s_waitcnt lgkmcnt(6)
    v_smfmac_f32_16x16x64_bf16 v[20:23], v[48:51], v[80:87], v3
    ds_read_b128 v[80:83], v2 offset:28672
    ds_read_b128 v[84:87], v2 offset:29696
    v_max_u32 v9, v9, v55
    v_smfmac_f32_16x16x64_bf16 v[24:27], v[48:51], v[224:231], v3
    v_cmp_eq_u32 vcc, -1, v9
    s_waitcnt lgkmcnt(6)
    v_smfmac_f32_16x16x64_bf16 v[28:31], v[48:51], v[88:95], v3
    ds_read_b128 v[88:91], v2 offset:30720
    ds_read_b128 v[92:95], v2 offset:31744
    v_smfmac_f32_16x16x64_bf16 v[32:35], v[48:51], v[232:239], v3
    s_cbranch_vccnz cA_slowL4
cA_backL4:
    s_waitcnt lgkmcnt(6)
    v_smfmac_f32_16x16x64_bf16 v[12:15], v[52:55], v[64:71], v3
    v_smfmac_f32_16x16x64_bf16 v[16:19], v[52:55], v[240:247], v3
    s_waitcnt lgkmcnt(4)
    v_smfmac_f32_16x16x64_bf16 v[20:23], v[52:55], v[72:79], v3
    s_waitcnt lgkmcnt(2)
    v_smfmac_f32_16x16x64_bf16 v[24:27], v[52:55], v[80:87], v3
    v_smfmac_f32_16x16x64_bf16 v[28:31], v[52:55], v[248:255], v3
    s_waitcnt lgkmcnt(0)
    v_smfmac_f32_16x16x64_bf16 v[32:35], v[52:55], v[88:95], v3
    s_waitcnt vmcnt(4)
    v_max3_u32 v9, v56, v57, v58
    v_max_u32 v9, v9, v59
    v_cmp_eq_u32 vcc, -1, v9
    s_cbranch_vccnz cA_slowR0
cA_backR0:
    v_smfmac_f32_16x16x64_bf16 v[12:15], v[56:59], a[0:7], v3
    s_waitcnt vmcnt(3)
    v_max3_u32 v9, v60, v61, v62
    v_max_u32 v9, v9, v63
    v_smfmac_f32_16x16x64_bf16 v[16:19], v[56:59], a[8:15], v3
    v_cmp_eq_u32 vcc, -1, v9
    v_smfmac_f32_16x16x64_bf16 v[20:23], v[56:59], a[16:23], v3
    ds_read_b128 v[64:67], v2 offset:32768
    ds_read_b128 v[68:71], v2 offset:33792
    v_smfmac_f32_16x16x64_bf16 v[24:27], v[56:59], a[24:31], v3
    s_cbranch_vccnz cA_slowR1
cA_backR1:
    v_smfmac_f32_16x16x64_bf16 v[12:15], v[60:63], a[32:39], v3
    s_waitcnt vmcnt(2)
    v_max3_u32 v9, v36, v37, v38
    v_max_u32 v9, v9, v39
    v_smfmac_f32_16x16x64_bf16 v[16:19], v[60:63], a[40:47], v3
    v_cmp_eq_u32 vcc, -1, v9
    v_smfmac_f32_16x16x64_bf16 v[20:23], v[60:63], a[48:55], v3
    ds_read_b128 v[72:75], v2 offset:34816
    ds_read_b128 v[76:79], v2 offset:35840
    v_smfmac_f32_16x16x64_bf16 v[24:27], v[60:63], a[56:63], v3
    s_cbranch_vccnz cA_slowR2
cA_backR2:
    v_smfmac_f32_16x16x64_bf16 v[12:15], v[36:39], a[64:71], v3
    s_waitcnt vmcnt(1)
    v_max3_u32 v9, v40, v41, v42
    v_max_u32 v9, v9, v43
    v_smfmac_f32_16x16x64_bf16 v[16:19], v[36:39], a[72:79], v3
    v_cmp_eq_u32 vcc, -1, v9
    v_smfmac_f32_16x16x64_bf16 v[20:23], v[36:39], a[80:87], v3
    ds_read_b128 v[80:83], v2 offset:36864
    ds_read_b128 v[84:87], v2 offset:37888
    v_smfmac_f32_16x16x64_bf16 v[24:27], v[36:39], a[88:95], v3
    s_cbranch_vccnz cA_slowR3
cA_backR3:
    v_smfmac_f32_16x16x64_bf16 v[12:15], v[40:43], a[112:119], v3
    s_waitcnt vmcnt(0)
    v_max3_u32 v9, v44, v45, v46
    v_max_u32 v9, v9, v47
    v_smfmac_f32_16x16x64_bf16 v[16:19], v[40:43], a[120:127], v3
    v_cmp_eq_u32 vcc, -1, v9
    v_smfmac_f32_16x16x64_bf16 v[20:23], v[40:43], a[128:135], v3
    ds_read_b128 v[88:91], v2 offset:38912
    ds_read_b128 v[92:95], v2 offset:39936
    v_smfmac_f32_16x16x64_bf16 v[24:27], v[40:43], a[136:143], v3
    s_cbranch_vccnz cA_slowR4
cA_backR4:
    v_smfmac_f32_16x16x64_bf16 v[12:15], v[44:47], a[160:167], v3
    buffer_load_dwordx4 v[48:51], v0, s[32:35], s23 offen sc1
    buffer_load_dwordx4 v[52:55], v0, s[32:35], s23 offen offset:1024 sc1
    v_smfmac_f32_16x16x64_bf16 v[16:19], v[44:47], a[168:175], v3
    v_xor_b32 v10, 16, v4
    v_smfmac_f32_16x16x64_bf16 v[20:23], v[44:47], a[176:183], v3
    v_lshrrev_b32 v9, 1, v0
    v_smfmac_f32_16x16x64_bf16 v[24:27], v[44:47], a[184:191], v3
    s_waitcnt lgkmcnt(0)
    v_smfmac_f32_16x16x64_bf16 v[28:31], v[56:59], v[64:71], v3
    ds_read_b128 v[64:67], v0 offset:8192
    ds_read_b128 v[68:71], v0 offset:12288
    v_smfmac_f32_16x16x64_bf16 v[32:35], v[56:59], v[72:79], v3
    ds_read_b128 v[72:75], v0 offset:9216
    ds_read_b128 v[76:79], v0 offset:13312
    v_permlane32_swap_b32 v12, v16
    v_permlane32_swap_b32 v13, v17
    v_permlane32_swap_b32 v14, v18
    v_permlane32_swap_b32 v15, v19
    v_pk_add_f32 v[12:13], v[12:13], v[16:17]
    v_pk_add_f32 v[14:15], v[14:15], v[18:19]
    v_permlane32_swap_b32 v20, v24
    v_cvt_pk_bf16_f32 v12, v12, v13
    v_cvt_pk_bf16_f32 v13, v14, v15
    v_permlane32_swap_b32 v21, v25
    ds_write_b64 v4, v[12:13]
    v_permlane32_swap_b32 v22, v26
    v_permlane32_swap_b32 v23, v27
    v_pk_add_f32 v[20:21], v[20:21], v[24:25]
    v_pk_add_f32 v[22:23], v[22:23], v[26:27]
    v_cvt_pk_bf16_f32 v20, v20, v21
    v_cvt_pk_bf16_f32 v21, v22, v23
    ds_write_b64 v10, v[20:21]
    v_smfmac_f32_16x16x64_bf16 v[28:31], v[60:63], v[80:87], v3
    ds_read_b128 v[80:83], v0 offset:10240
    ds_read_b128 v[84:87], v0 offset:14336
    v_subrev_u32 v56, 512, v0
    v_smfmac_f32_16x16x64_bf16 v[32:35], v[60:63], v[88:95], v3
    ds_read_b128 v[88:91], v0 offset:11264
    ds_read_b128 v[92:95], v0 offset:15360
    v_ashrrev_i32 v56, 31, v56
    s_not_b64 exec, s[100:101]
    buffer_store_dwordx2 v[20:21], v9, s[32:35], s24 offen sc1
    s_mov_b64 exec, -1
    v_smfmac_f32_16x16x64_bf16 v[28:31], v[36:39], a[96:103], v3
    v_and_b32 v56, 0xf149f2ca, v56
    v_smfmac_f32_16x16x64_bf16 v[32:35], v[36:39], a[104:111], v3
    v_mov_b32 v57, v56
    v_smfmac_f32_16x16x64_bf16 v[28:31], v[40:43], a[144:151], v3
    v_mov_b64 v[58:59], v[56:57]
    s_waitcnt lgkmcnt(4)
    s_barrier
    ds_read_b64_tr_b16 v[12:13], v1 offset:0
    ds_read_b64_tr_b16 v[14:15], v1 offset:512
    v_smfmac_f32_16x16x64_bf16 v[32:35], v[40:43], a[152:159], v3
    ds_read_b64_tr_b16 v[16:17], v1 offset:1024
    ds_read_b64_tr_b16 v[18:19], v1 offset:1536
    ds_read_b64_tr_b16 v[20:21], v1 offset:2048
    ds_read_b64_tr_b16 v[22:23], v1 offset:2560
    v_smfmac_f32_16x16x64_bf16 v[28:31], v[44:47], a[192:199], v3
    ds_read_b64_tr_b16 v[24:25], v1 offset:3072
    ds_read_b64_tr_b16 v[26:27], v1 offset:3584
    buffer_load_dwordx4 v0, s[32:35], s25 offen offset:0 sc1 lds
    buffer_load_dwordx4 v0, s[32:35], s25 offen offset:1024 sc1 lds
    buffer_load_dwordx4 v0, s[32:35], s25 offen offset:2048 sc1 lds
    buffer_load_dwordx4 v0, s[32:35], s25 offen offset:3072 sc1 lds
    v_mov_b32 v10, s11
    s_mov_b64 exec, s[74:75]
    buffer_store_dword v10, v0, s[32:35], s93 offen sc1
    s_mov_b64 exec, -1
    v_smfmac_f32_16x16x64_bf16 v[32:35], v[44:47], a[200:207], v3
    s_waitcnt lgkmcnt(6)
    v_mfma_f32_16x16x32_bf16 v[60:63], v[64:67], v[12:15], 0
    v_mfma_f32_16x16x32_bf16 v[36:39], v[68:71], v[12:15], 0
    s_waitcnt lgkmcnt(4)
    v_mfma_f32_16x16x32_bf16 v[60:63], v[72:75], v[16:19], v[60:63]
    v_permlane32_swap_b32 v28, v32
    v_mfma_f32_16x16x32_bf16 v[36:39], v[76:79], v[16:19], v[36:39]
    v_permlane32_swap_b32 v29, v33
    s_waitcnt lgkmcnt(2)
    v_mfma_f32_16x16x32_bf16 v[60:63], v[80:83], v[20:23], v[60:63]
    v_permlane32_swap_b32 v30, v34
    v_mfma_f32_16x16x32_bf16 v[36:39], v[84:87], v[20:23], v[36:39]
    v_permlane32_swap_b32 v31, v35
    s_waitcnt lgkmcnt(0)
    v_mfma_f32_16x16x32_bf16 v[60:63], v[88:91], v[24:27], v[60:63]
    v_pk_add_f32 v[28:29], v[28:29], v[32:33]
    v_pk_add_f32 v[30:31], v[30:31], v[34:35]
    v_mfma_f32_16x16x32_bf16 v[36:39], v[92:95], v[24:27], v[36:39]
    v_cvt_pk_bf16_f32 v28, v28, v29
    v_cvt_pk_bf16_f32 v29, v30, v31
    v_mfma_f32_16x16x32_bf16 v[56:59], v[12:15], v[12:15], v[56:59]
    v_mov_b32 v30, v28
    v_mov_b32 v31, v29
    v_mfma_f32_16x16x32_bf16 v[56:59], v[16:19], v[16:19], v[56:59]
    v_max3_f32 v9, v60, v61, v62
    v_max3_f32 v9, v9, v63, v36
    v_mfma_f32_16x16x32_bf16 v[56:59], v[20:23], v[20:23], v[56:59]
    v_permlane32_swap_b32 v28, v30
    v_mfma_f32_16x16x32_bf16 v[56:59], v[24:27], v[24:27], v[56:59]
    v_permlane32_swap_b32 v29, v31
    s_nop 1
    v_max3_f32 v9, v9, v37, v38
    v_max_f32 v9, v9, v39
    s_cmp_eq_u32 s11, 63
    s_cbranch_scc1 cA_done
    v_mov_b32 v64, 0x3f803f80
    v_mov_b32 v65, 0x3f803f80
    v_max3_f32 v9, v9, v56, v57
    v_max3_f32 v9, v9, v58, v59
    v_mov_b32 v10, v9
    v_mov_b32 v66, 0x3f803f80
    v_mov_b32 v67, 0x3f803f80
    v_permlane32_swap_b32 v9, v10
    v_max_f32 v9, v9, v10
    v_mov_b32 v10, v9
    v_mov_b32 v84, 0
    v_mov_b32 v85, 0
    v_permlane16_swap_b32 v9, v10
    v_max_f32 v9, v9, v10
    v_mul_f32 v10, s48, v9
    v_pk_fma_f32 v[60:61], v[60:61], s[48:49], v[10:11] op_sel_hi:[1,1,0] neg_lo:[0,0,1] neg_hi:[0,0,1]
    v_pk_fma_f32 v[62:63], v[62:63], s[48:49], v[10:11] op_sel_hi:[1,1,0] neg_lo:[0,0,1] neg_hi:[0,0,1]
    v_exp_f32 v60, v60
    v_exp_f32 v61, v61
    v_exp_f32 v62, v62
    v_exp_f32 v63, v63
    v_pk_fma_f32 v[36:37], v[36:37], s[48:49], v[10:11] op_sel_hi:[1,1,0] neg_lo:[0,0,1] neg_hi:[0,0,1]
    v_pk_fma_f32 v[38:39], v[38:39], s[48:49], v[10:11] op_sel_hi:[1,1,0] neg_lo:[0,0,1] neg_hi:[0,0,1]
    v_exp_f32 v36, v36
    v_exp_f32 v37, v37
    v_exp_f32 v38, v38
    v_exp_f32 v39, v39
    v_cvt_pk_bf16_f32 v40, v60, v61
    v_cvt_pk_bf16_f32 v41, v62, v63
    v_cvt_pk_bf16_f32 v42, v36, v37
    v_cvt_pk_bf16_f32 v43, v38, v39
    v_pk_fma_f32 v[56:57], v[56:57], s[48:49], v[10:11] op_sel_hi:[1,1,0] neg_lo:[0,0,1] neg_hi:[0,0,1]
    v_pk_fma_f32 v[58:59], v[58:59], s[48:49], v[10:11] op_sel_hi:[1,1,0] neg_lo:[0,0,1] neg_hi:[0,0,1]
    s_waitcnt vmcnt(6)
    v_mfma_f32_16x16x32_bf16 v[68:71], v[64:67], v[40:43], 0
    v_exp_f32 v56, v56
    v_mfma_f32_16x16x32_bf16 v[72:75], v[48:51], v[40:43], 0
    v_exp_f32 v57, v57
    v_mfma_f32_16x16x32_bf16 v[76:79], v[52:55], v[40:43], 0
    v_exp_f32 v58, v58
    v_exp_f32 v59, v59
    v_cvt_pk_bf16_f32 v44, v56, v57
    v_cvt_pk_bf16_f32 v45, v58, v59
    v_mov_b32 v86, 0
    v_mov_b32 v87, 0
    v_mfma_f32_16x16x16_bf16 v[68:71], v[64:65], v[44:45], v[68:71]
    v_mov_b32 v88, 0
    v_mov_b32 v89, 0
    v_mfma_f32_16x16x16_bf16 v[72:75], v[28:29], v[44:45], v[72:75]
    v_mov_b32 v90, 0
    v_mov_b32 v91, 0
    v_mfma_f32_16x16x16_bf16 v[76:79], v[30:31], v[44:45], v[76:79]
    v_mov_b32 v92, 0
    v_mov_b32 v93, 0
    v_rcp_f32 v10, v68
    v_mov_b32 v94, 0
    v_mov_b32 v95, 0
    s_mov_b64 exec, s[44:45]
    v_pk_mul_f32 v[72:73], v[72:73], v[10:11] op_sel_hi:[1,0]
    v_pk_mul_f32 v[74:75], v[74:75], v[10:11] op_sel_hi:[1,0]
    v_cvt_pk_bf16_f32 v80, v72, v73
    v_cvt_pk_bf16_f32 v81, v74, v75
    v_pk_mul_f32 v[76:77], v[76:77], v[10:11] op_sel_hi:[1,0]
    v_pk_mul_f32 v[78:79], v[78:79], v[10:11] op_sel_hi:[1,0]
    v_cvt_pk_bf16_f32 v82, v76, v77
    v_cvt_pk_bf16_f32 v83, v78, v79
    ds_write_b128 v5, v[80:83]
    s_mov_b64 exec, -1
    v_cndmask_b32 v28, v28, v30, s[46:47]
    v_cndmask_b32 v29, v29, v31, s[46:47]
    v_lshrrev_b32 v9, 1, v0
    s_mov_b64 exec, s[100:101]
    buffer_store_dwordx2 v[28:29], v9, s[32:35], s24 offen sc1
    s_mov_b64 exec, -1
    s_waitcnt lgkmcnt(0)
    s_barrier
    ds_read_b128 v[12:15], v6 offset:4096
    ds_read_b128 v[16:19], v6 offset:4608
    ds_read_b128 v[20:23], v6 offset:5120
    ds_read_b128 v[24:27], v6 offset:5632
    v_mov_b32 v10, 0xfffe0000
    s_waitcnt lgkmcnt(3)
    v_smfmac_f32_16x16x64_bf16 v[84:87], v[12:15], a[208:215], v3
    v_smfmac_f32_16x16x64_bf16 v[88:91], v[12:15], a[240:247], v3
    s_waitcnt lgkmcnt(2)
    v_smfmac_f32_16x16x64_bf16 v[84:87], v[16:19], a[216:223], v3
    v_smfmac_f32_16x16x64_bf16 v[88:91], v[16:19], a[248:255], v3
    s_waitcnt lgkmcnt(1)
    v_smfmac_f32_16x16x64_bf16 v[84:87], v[20:23], a[224:231], v3
    v_smfmac_f32_16x16x64_bf16 v[88:91], v[20:23], v[96:103], v3
    s_waitcnt lgkmcnt(0)
    v_smfmac_f32_16x16x64_bf16 v[84:87], v[24:27], a[232:239], v3
    v_smfmac_f32_16x16x64_bf16 v[88:91], v[24:27], v[104:111], v3
    v_smfmac_f32_16x16x64_bf16 v[92:95], v[12:15], v[112:119], v3
    v_smfmac_f32_16x16x64_bf16 v[92:95], v[16:19], v[120:127], v3
    v_add_u32 v84, s26, v84
    v_cvt_pk_bf16_f32 v81, v86, v87
    v_smfmac_f32_16x16x64_bf16 v[92:95], v[20:23], v[128:135], v3
    v_and_or_b32 v84, v84, v10, s27
    v_cvt_pk_bf16_f32 v80, v84, v85
    v_smfmac_f32_16x16x64_bf16 v[92:95], v[24:27], v[136:143], v3
    v_add_u32 v88, s26, v88
    v_cvt_pk_bf16_f32 v83, v90, v91
    v_and_or_b32 v88, v88, v10, s27
    v_cvt_pk_bf16_f32 v82, v88, v89
    buffer_store_dwordx4 v[80:83], v7, s[32:35], s21 offen
    s_nop 2
    v_add_u32 v92, s26, v92
    v_cvt_pk_bf16_f32 v79, v94, v95
    v_and_or_b32 v92, v92, v10, s27
    v_cvt_pk_bf16_f32 v78, v92, v93
    buffer_store_dwordx2 v[78:79], v8, s[32:35], s21 offen
    ds_read_b128 v[64:67], v2 offset:0
    ds_read_b128 v[68:71], v2 offset:1024
    ds_read_b128 v[72:75], v2 offset:2048
    ds_read_b128 v[76:79], v2 offset:3072
    ds_read_b128 v[80:83], v2 offset:4096
    ds_read_b128 v[84:87], v2 offset:5120
    ds_read_b128 v[88:91], v2 offset:6144
    ds_read_b128 v[92:95], v2 offset:7168
    v_mov_b64 v[12:13], 0
    v_mov_b64 v[14:15], 0
    v_mov_b64 v[16:17], 0
    v_mov_b64 v[18:19], 0
    v_mov_b64 v[20:21], 0
    v_mov_b64 v[22:23], 0
    v_mov_b64 v[24:25], 0
    v_mov_b64 v[26:27], 0
    v_mov_b64 v[28:29], 0
    v_mov_b64 v[30:31], 0
    v_mov_b64 v[32:33], 0
    v_mov_b64 v[34:35], 0
    s_add_u32 s11, s11, 1
    s_mov_b32 s12, s13
    s_mov_b32 s13, s14
    s_add_u32 s14, s14, 0x4000
    s_bitset0_b32 s14, 16
    s_add_u32 s18, s12, s29
    s_xor_b32 s28, s18, 2048
    s_add_u32 s15, s18, 4096
    s_add_u32 s16, s16, 0x4000
    s_add_u32 s19, s19, 0x4000
    s_add_u32 s20, s19, 4096
    s_xor_b32 s26, s26, 0x10000
    s_xor_b32 s27, s27, 0x10000
    s_add_u32 s24, s24, 0x40000
    s_and_b32 s36, s11, 7
    s_cselect_b32 s36, 0, 0x2000
    s_xor_b32 s24, s24, s36
    s_add_u32 s23, s23, 0x40000
    s_cmp_lt_u32 s11, 63
    s_cselect_b32 s36, 0x40000, 0
    s_add_u32 s25, s25, s36
    s_add_u32 s39, s11, 2
    s_min_u32 s39, s39, 64
cpj_6:
    s_cmp_ge_u32 s92, s39
    s_cbranch_scc1 cpk_7
    s_sub_u32 s88, s88, 1
    s_cbranch_scc1 k_end
    s_load_dword s70, s[30:31], 0 glc
    s_load_dword s71, s[30:31], 128 glc
    s_load_dword s72, s[30:31], 384 glc
    s_load_dword s73, s[30:31], 512 glc
    s_waitcnt lgkmcnt(0)
    s_min_u32 s70, s70, s71
    s_min_u32 s72, s72, s73
    s_lshl_b32 s70, s70, 1
    s_lshl_b32 s72, s72, 1
    s_add_u32 s72, s72, 1
    s_min_u32 s92, s70, s72
    s_branch cpj_6
cpk_7:
    s_waitcnt vmcnt(3)
    s_branch cA_top
cA_slowL0:
    s_sub_u32 s88, s88, 1
    s_cbranch_scc1 k_end
    s_add_u32 s50, s50, 1
    buffer_load_dwordx4 v[36:39], v11, s[32:35], s18 offen offset:0 sc1
    s_nop 9
    buffer_load_dwordx4 v[40:43], v11, s[32:35], s28 offen offset:0 sc1
    s_nop 9
    buffer_load_dwordx4 v[44:47], v11, s[32:35], s18 offen offset:128 sc1
    s_nop 9
    buffer_load_dwordx4 v[48:51], v11, s[32:35], s28 offen offset:128 sc1
    s_nop 9
    buffer_load_dwordx4 v[52:55], v11, s[32:35], s15 offen offset:0 sc1
    s_waitcnt vmcnt(4)
    v_max3_u32 v9, v36, v37, v38
    v_max_u32 v9, v9, v39
    v_cmp_eq_u32 vcc, -1, v9
    s_cbranch_vccnz cA_slowL0
    s_branch cA_backL0
cA_slowL1:
    s_sub_u32 s88, s88, 1
    s_cbranch_scc1 k_end
    s_add_u32 s50, s50, 1
    buffer_load_dwordx4 v[40:43], v11, s[32:35], s28 offen offset:0 sc1
    buffer_load_dwordx4 v[44:47], v11, s[32:35], s18 offen offset:128 sc1
    buffer_load_dwordx4 v[48:51], v11, s[32:35], s28 offen offset:128 sc1
    buffer_load_dwordx4 v[52:55], v11, s[32:35], s15 offen offset:0 sc1
    s_waitcnt vmcnt(0)
    v_max3_u32 v9, v40, v41, v42
    v_max_u32 v9, v9, v43
    v_cmp_eq_u32 vcc, -1, v9
    s_cbranch_vccnz cA_slowL1
    s_branch cA_backL1
cA_slowL2:
    s_sub_u32 s88, s88, 1
    s_cbranch_scc1 k_end
    s_add_u32 s50, s50, 1
    buffer_load_dwordx4 v[44:47], v11, s[32:35], s18 offen offset:128 sc1
    buffer_load_dwordx4 v[48:51], v11, s[32:35], s28 offen offset:128 sc1
    buffer_load_dwordx4 v[52:55], v11, s[32:35], s15 offen offset:0 sc1
    s_waitcnt vmcnt(0)
    v_max3_u32 v9, v44, v45, v46
    v_max_u32 v9, v9, v47
    v_cmp_eq_u32 vcc, -1, v9
    s_cbranch_vccnz cA_slowL2
    s_branch cA_backL2
cA_slowL3:
    s_sub_u32 s88, s88, 1
    s_cbranch_scc1 k_end
    s_add_u32 s50, s50, 1
    buffer_load_dwordx4 v[48:51], v11, s[32:35], s28 offen offset:128 sc1
    buffer_load_dwordx4 v[52:55], v11, s[32:35], s15 offen offset:0 sc1
    s_waitcnt vmcnt(0)
    v_max3_u32 v9, v48, v49, v50
    v_max_u32 v9, v9, v51
    v_cmp_eq_u32 vcc, -1, v9
    s_cbranch_vccnz cA_slowL3
    s_branch cA_backL3
cA_slowL4:
    s_sub_u32 s88, s88, 1
    s_cbranch_scc1 k_end
    s_add_u32 s50, s50, 1
    buffer_load_dwordx4 v[52:55], v11, s[32:35], s15 offen offset:0 sc1
    s_waitcnt vmcnt(0)
    v_max3_u32 v9, v52, v53, v54
    v_max_u32 v9, v9, v55
    v_cmp_eq_u32 vcc, -1, v9
    s_cbranch_vccnz cA_slowL4
    s_branch cA_backL4
cA_slowR0:
    s_sub_u32 s88, s88, 1
    s_cbranch_scc1 k_end
    s_add_u32 s50, s50, 65536
    buffer_load_dwordx4 v[56:59], v11, s[32:35], s19 offen offset:0 sc1
    s_nop 9
    buffer_load_dwordx4 v[60:63], v11, s[32:35], s19 offen offset:2048 sc1
    s_nop 9
    buffer_load_dwordx4 v[36:39], v11, s[32:35], s19 offen offset:128 sc1
    s_nop 9
    buffer_load_dwordx4 v[40:43], v11, s[32:35], s19 offen offset:2176 sc1
    s_nop 9
    buffer_load_dwordx4 v[44:47], v11, s[32:35], s20 offen offset:0 sc1
    s_waitcnt vmcnt(4)
    v_max3_u32 v9, v56, v57, v58
    v_max_u32 v9, v9, v59
    v_cmp_eq_u32 vcc, -1, v9
    s_cbranch_vccnz cA_slowR0
    s_branch cA_backR0
cA_slowR1:
    s_sub_u32 s88, s88, 1
    s_cbranch_scc1 k_end
    s_add_u32 s50, s50, 65536
    buffer_load_dwordx4 v[60:63], v11, s[32:35], s19 offen offset:2048 sc1
    buffer_load_dwordx4 v[36:39], v11, s[32:35], s19 offen offset:128 sc1
    buffer_load_dwordx4 v[40:43], v11, s[32:35], s19 offen offset:2176 sc1
    buffer_load_dwordx4 v[44:47], v11, s[32:35], s20 offen offset:0 sc1
    s_waitcnt vmcnt(0)
    v_max3_u32 v9, v60, v61, v62
    v_max_u32 v9, v9, v63
    v_cmp_eq_u32 vcc, -1, v9
    s_cbranch_vccnz cA_slowR1
    s_branch cA_backR1
cA_slowR2:
    s_sub_u32 s88, s88, 1
    s_cbranch_scc1 k_end
    s_add_u32 s50, s50, 65536
    buffer_load_dwordx4 v[36:39], v11, s[32:35], s19 offen offset:128 sc1
    buffer_load_dwordx4 v[40:43], v11, s[32:35], s19 offen offset:2176 sc1
    buffer_load_dwordx4 v[44:47], v11, s[32:35], s20 offen offset:0 sc1
    s_waitcnt vmcnt(0)
    v_max3_u32 v9, v36, v37, v38
    v_max_u32 v9, v9, v39
    v_cmp_eq_u32 vcc, -1, v9
    s_cbranch_vccnz cA_slowR2
    s_branch cA_backR2
cA_slowR3:
    s_sub_u32 s88, s88, 1
    s_cbranch_scc1 k_end
    s_add_u32 s50, s50, 65536
    buffer_load_dwordx4 v[40:43], v11, s[32:35], s19 offen offset:2176 sc1
    buffer_load_dwordx4 v[44:47], v11, s[32:35], s20 offen offset:0 sc1
    s_waitcnt vmcnt(0)
    v_max3_u32 v9, v40, v41, v42
    v_max_u32 v9, v9, v43
    v_cmp_eq_u32 vcc, -1, v9
    s_cbranch_vccnz cA_slowR3
    s_branch cA_backR3
cA_slowR4:
    s_sub_u32 s88, s88, 1
    s_cbranch_scc1 k_end
    s_add_u32 s50, s50, 65536
    buffer_load_dwordx4 v[44:47], v11, s[32:35], s20 offen offset:0 sc1
    s_waitcnt vmcnt(0)
    v_max3_u32 v9, v44, v45, v46
    v_max_u32 v9, v9, v47
    v_cmp_eq_u32 vcc, -1, v9
    s_cbranch_vccnz cA_slowR4
    s_branch cA_backR4
cA_done:
    s_mov_b64 exec, -1
    v_cndmask_b32 v28, v28, v30, s[46:47]
    v_cndmask_b32 v29, v29, v31, s[46:47]
    v_lshrrev_b32 v9, 1, v0
    s_mov_b64 exec, s[100:101]
    buffer_store_dwordx2 v[28:29], v9, s[32:35], s24 offen sc1
    s_mov_b64 exec, -1
    s_waitcnt vmcnt(0)
    s_barrier
    v_mov_b32 v10, 64
    s_mov_b64 exec, s[74:75]
    buffer_store_dword v10, v0, s[32:35], s93 offen sc1
    s_mov_b64 exec, -1
    s_branch chain_exit
cB_entry:
    s_add_u32 s36, s9, 32
    s_add_u32 s37, s9, 24
    s_and_b32 s37, s37, 31
    s_cmp_eq_u32 s10, 2
    s_cselect_b32 s63, s37, s36
    s_cmp_lt_u32 s63, 40
    s_cselect_b32 s43, 1, 0
    v_lshrrev_b32 v10, 4, v0
    v_bfe_u32 v11, v10, 4, 1
    v_lshlrev_b32 v8, 2, v11
    v_and_b32 v11, 3, v10
    v_add_u32 v8, v8, v11
    v_mul_u32_u24 v18, 1280, v8
    v_lshlrev_b32 v8, 4, v8
    v_bfe_u32 v11, v10, 2, 1
    v_lshlrev_b32 v9, 3, v11
    v_bfe_u32 v11, v10, 5, 1
    v_lshl_add_u32 v9, v11, 2, v9
    v_add_u32 v8, v8, v9
    v_add_u32 v18, v18, v9
    s_and_b32 s36, s63, 15
    s_lshl_b32 s36, s36, 8
    s_bfe_u32 s37, s63, 0x10004
    s_lshl_b32 s37, s37, 7
    s_add_u32 s36, s36, s37
    s_lshr_b32 s37, s63, 5
    s_lshl_b32 s37, s37, 12
    s_add_u32 s64, s36, s37
    v_add_u32 v8, s64, v8
    v_bfe_u32 v11, v10, 3, 1
    v_lshlrev_b32 v9, 11, v11
    v_xor_b32 v8, v8, v9
    v_lshl_add_u32 v8, v11, 13, v8
    s_sub_u32 s98, 0, s43
    s_mov_b32 s99, s98
    s_and_b64 s[96:97], s[98:99], s[44:45]
    s_mul_i32 s37, s8, 640
    s_lshl_b32 s36, s63, 4
    s_add_u32 s36, s36, s37
    v_add_u32 v18, s36, v18
    s_mov_b64 exec, s[98:99]
    global_load_dword v32, v18, s[28:29]
    s_mov_b64 exec, -1
    v_lshrrev_b32 v9, 4, v0
    v_bfe_u32 v10, v9, 5, 1
    v_lshlrev_b32 v16, 3, v10
    v_bfe_u32 v10, v9, 4, 1
    v_add_u32 v16, v16, v10
    v_lshlrev_b32 v16, 13, v16
    v_bfe_u32 v10, v9, 1, 3
    v_lshrrev_b32 v11, 4, v9
    v_xor_b32 v10, v10, v11
    v_lshl_add_u32 v16, v10, 5, v16
    v_and_b32 v10, 1, v9
    v_lshl_add_u32 v16, v10, 4, v16
    v_xor_b32 v17, 128, v16
    v_bfe_u32 v10, v9, 4, 1
    v_lshlrev_b32 v18, 4, v10
    v_bfe_u32 v10, v9, 5, 1
    v_lshl_add_u32 v18, v10, 2, v18
    v_bfe_u32 v10, v9, 2, 1
    v_add_u32 v18, v18, v10
    v_mul_u32_u24 v18, 1280, v18
    v_bfe_u32 v10, v9, 3, 1
    v_lshl_add_u32 v18, v10, 6, v18
    v_and_b32 v10, 3, v9
    v_lshl_add_u32 v18, v10, 4, v18
    v_lshrrev_b32 v11, 2, v9
    v_lshlrev_b32 v19, 8, v11
    v_lshl_add_u32 v19, v10, 3, v19
    v_and_b32 v11, 7, v11
    s_lshl_b32 s36, s10, 1
    v_xor_b32 v11, s36, v11
    v_lshl_add_u32 v19, v11, 5, v19
    v_xor_b32 v20, 32, v19
    s_mul_i32 s40, s8, 2621440
    s_sub_u32 s41, 2621440, s40
    s_lshl_b32 s36, s9, 8
    s_lshr_b32 s37, s10, 1
    s_lshl_b32 s37, s37, 18
    s_add_u32 s36, s36, s37
    s_and_b32 s37, s10, 1
    s_lshl_b32 s37, s37, 14
    s_add_u32 s36, s36, s37
    s_add_u32 s40, s40, s36
    s_add_u32 s41, s41, s36
    s_mul_i32 s38, s9, 163840
    s_mul_i32 s36, s8, 640
    s_add_u32 s38, s38, s36
    s_xor_b32 s36, s10, 2
    s_lshl_b32 s36, s36, 7
    s_add_u32 s39, s38, s36
    s_add_u32 s38, s38, 512
    v_readfirstlane_b32 s3, v2
    s_lshl_b32 s42, s10, 12
    s_add_u32 m0, s42, 0
    s_add_u32 s36, s41, 0
    buffer_load_dwordx4 v16, s[12:15], s36 offen lds
    s_add_u32 m0, s42, 1024
    s_add_u32 s36, s41, 32768
    buffer_load_dwordx4 v17, s[12:15], s36 offen lds
    s_add_u32 m0, s42, 2048
    s_add_u32 s36, s41, 131072
    buffer_load_dwordx4 v16, s[12:15], s36 offen lds
    s_add_u32 m0, s42, 3072
    s_add_u32 s36, s41, 163840
    buffer_load_dwordx4 v17, s[12:15], s36 offen lds
    s_add_u32 m0, s42, 40960
    s_add_u32 s36, s41, 0
    buffer_load_dwordx4 v16, s[16:19], s36 offen lds
    s_add_u32 m0, s42, 41984
    s_add_u32 s36, s41, 32768
    buffer_load_dwordx4 v17, s[16:19], s36 offen lds
    s_add_u32 m0, s42, 43008
    s_add_u32 s36, s41, 131072
    buffer_load_dwordx4 v16, s[16:19], s36 offen lds
    s_add_u32 m0, s42, 44032
    s_add_u32 s36, s41, 163840
    buffer_load_dwordx4 v17, s[16:19], s36 offen lds
    s_add_u32 m0, s42, 81920
    s_add_u32 s36, s41, 524288
    buffer_load_dwordx4 v16, s[12:15], s36 offen lds
    s_add_u32 m0, s42, 82944
    s_add_u32 s36, s41, 557056
    buffer_load_dwordx4 v17, s[12:15], s36 offen lds
    s_add_u32 m0, s42, 83968
    s_add_u32 s36, s41, 655360
    buffer_load_dwordx4 v16, s[12:15], s36 offen lds
    s_add_u32 m0, s42, 84992
    s_add_u32 s36, s41, 688128
    buffer_load_dwordx4 v17, s[12:15], s36 offen lds
    s_add_u32 m0, s42, 114688
    s_add_u32 s36, s41, 524288
    buffer_load_dwordx4 v16, s[16:19], s36 offen lds
    s_add_u32 m0, s42, 115712
    s_add_u32 s36, s41, 557056
    buffer_load_dwordx4 v17, s[16:19], s36 offen lds
    s_add_u32 m0, s42, 116736
    s_add_u32 s36, s41, 655360
    buffer_load_dwordx4 v16, s[16:19], s36 offen lds
    s_add_u32 m0, s42, 117760
    s_add_u32 s36, s41, 688128
    buffer_load_dwordx4 v17, s[16:19], s36 offen lds
    s_add_u32 m0, s3, 0
    s_add_u32 s36, s39, 0
    buffer_load_dwordx4 v18, s[24:27], s36 offen lds
    s_add_u32 m0, s3, 1024
    s_add_u32 s36, s39, 2560
    buffer_load_dwordx4 v18, s[24:27], s36 offen lds
    s_add_u32 m0, s3, 2048
    s_add_u32 s36, s39, 10240
    buffer_load_dwordx4 v18, s[24:27], s36 offen lds
    s_add_u32 m0, s3, 3072
    s_add_u32 s36, s39, 12800
    buffer_load_dwordx4 v18, s[24:27], s36 offen lds
    s_add_u32 m0, s3, 4096
    s_add_u32 s36, s39, 40960
    buffer_load_dwordx4 v18, s[24:27], s36 offen lds
    s_add_u32 m0, s3, 5120
    s_add_u32 s36, s39, 43520
    buffer_load_dwordx4 v18, s[24:27], s36 offen lds
    s_add_u32 m0, s3, 6144
    s_add_u32 s36, s39, 51200
    buffer_load_dwordx4 v18, s[24:27], s36 offen lds
    s_add_u32 m0, s3, 7168
    s_add_u32 s36, s39, 53760
    buffer_load_dwordx4 v18, s[24:27], s36 offen lds
    s_add_u32 m0, s3, 8192
    s_add_u32 s36, s39, 81920
    buffer_load_dwordx4 v18, s[24:27], s36 offen lds
    s_add_u32 m0, s3, 9216
    s_add_u32 s36, s39, 84480
    buffer_load_dwordx4 v18, s[24:27], s36 offen lds
    s_add_u32 m0, s3, 10240
    s_add_u32 s36, s39, 92160
    buffer_load_dwordx4 v18, s[24:27], s36 offen lds
    s_add_u32 m0, s3, 11264
    s_add_u32 s36, s39, 94720
    buffer_load_dwordx4 v18, s[24:27], s36 offen lds
    s_add_u32 m0, s3, 12288
    s_add_u32 s36, s39, 122880
    buffer_load_dwordx4 v18, s[24:27], s36 offen lds
    s_add_u32 m0, s3, 13312
    s_add_u32 s36, s39, 125440
    buffer_load_dwordx4 v18, s[24:27], s36 offen lds
    s_add_u32 m0, s3, 14336
    s_add_u32 s36, s39, 133120
    buffer_load_dwordx4 v18, s[24:27], s36 offen lds
    s_add_u32 m0, s3, 15360
    s_add_u32 s36, s39, 135680
    buffer_load_dwordx4 v18, s[24:27], s36 offen lds
    s_waitcnt vmcnt(28)
    s_barrier
    s_add_u32 m0, s42, 147456
    s_add_u32 s36, s41, 1048576
    buffer_load_dwordx4 v16, s[12:15], s36 offen lds
    s_add_u32 m0, s42, 148480
    s_add_u32 s36, s41, 1081344
    buffer_load_dwordx4 v17, s[12:15], s36 offen lds
    s_add_u32 m0, s42, 149504
    s_add_u32 s36, s41, 1179648
    buffer_load_dwordx4 v16, s[12:15], s36 offen lds
    s_add_u32 m0, s42, 150528
    s_add_u32 s36, s41, 1212416
    buffer_load_dwordx4 v17, s[12:15], s36 offen lds
    v_add_u32 v21, 0, v19
    v_add_u32 v22, 0, v20
    ds_read_b64_tr_b16 a[0:1], v21 offset:0
    ds_read_b64_tr_b16 a[2:3], v21 offset:4096
    ds_read_b64_tr_b16 a[4:5], v21 offset:8192
    ds_read_b64_tr_b16 a[6:7], v21 offset:12288
    ds_read_b64_tr_b16 a[8:9], v22 offset:0
    ds_read_b64_tr_b16 a[10:11], v22 offset:4096
    ds_read_b64_tr_b16 a[12:13], v22 offset:8192
    ds_read_b64_tr_b16 a[14:15], v22 offset:12288
    s_waitcnt lgkmcnt(0)
    s_waitcnt vmcnt(28)
    s_barrier
    s_add_u32 m0, s42, 0
    s_add_u32 s36, s41, 1048576
    buffer_load_dwordx4 v16, s[16:19], s36 offen lds
    s_add_u32 m0, s42, 1024
    s_add_u32 s36, s41, 1081344
    buffer_load_dwordx4 v17, s[16:19], s36 offen lds
    s_add_u32 m0, s42, 2048
    s_add_u32 s36, s41, 1179648
    buffer_load_dwordx4 v16, s[16:19], s36 offen lds
    s_add_u32 m0, s42, 3072
    s_add_u32 s36, s41, 1212416
    buffer_load_dwordx4 v17, s[16:19], s36 offen lds
    v_add_u32 v21, 40960, v19
    v_add_u32 v22, 40960, v20
    ds_read_b64_tr_b16 a[16:17], v21 offset:0
    ds_read_b64_tr_b16 a[18:19], v21 offset:4096
    ds_read_b64_tr_b16 a[20:21], v21 offset:8192
    ds_read_b64_tr_b16 a[22:23], v21 offset:12288
    ds_read_b64_tr_b16 a[24:25], v22 offset:0
    ds_read_b64_tr_b16 a[26:27], v22 offset:4096
    ds_read_b64_tr_b16 a[28:29], v22 offset:8192
    ds_read_b64_tr_b16 a[30:31], v22 offset:12288
    s_waitcnt lgkmcnt(0)
    s_waitcnt vmcnt(28)
    s_barrier
    s_add_u32 m0, s42, 40960
    s_add_u32 s36, s41, 1048576
    buffer_load_dwordx4 v16, s[20:23], s36 offen lds
    s_add_u32 m0, s42, 41984
    s_add_u32 s36, s41, 1081344
    buffer_load_dwordx4 v17, s[20:23], s36 offen lds
    s_add_u32 m0, s42, 43008
    s_add_u32 s36, s41, 1179648
    buffer_load_dwordx4 v16, s[20:23], s36 offen lds
    s_add_u32 m0, s42, 44032
    s_add_u32 s36, s41, 1212416
    buffer_load_dwordx4 v17, s[20:23], s36 offen lds
    v_add_u32 v21, 81920, v19
    v_add_u32 v22, 81920, v20
    ds_read_b64_tr_b16 a[32:33], v21 offset:0
    ds_read_b64_tr_b16 a[34:35], v21 offset:4096
    ds_read_b64_tr_b16 a[36:37], v21 offset:8192
    ds_read_b64_tr_b16 a[38:39], v21 offset:12288
    ds_read_b64_tr_b16 a[40:41], v22 offset:0
    ds_read_b64_tr_b16 a[42:43], v22 offset:4096
    ds_read_b64_tr_b16 a[44:45], v22 offset:8192
    ds_read_b64_tr_b16 a[46:47], v22 offset:12288
    s_waitcnt lgkmcnt(0)
    s_waitcnt vmcnt(28)
    s_barrier
    s_add_u32 m0, s42, 81920
    s_add_u32 s36, s41, 1572864
    buffer_load_dwordx4 v16, s[12:15], s36 offen lds
    s_add_u32 m0, s42, 82944
    s_add_u32 s36, s41, 1605632
    buffer_load_dwordx4 v17, s[12:15], s36 offen lds
    s_add_u32 m0, s42, 83968
    s_add_u32 s36, s41, 1703936
    buffer_load_dwordx4 v16, s[12:15], s36 offen lds
    s_add_u32 m0, s42, 84992
    s_add_u32 s36, s41, 1736704
    buffer_load_dwordx4 v17, s[12:15], s36 offen lds
    v_add_u32 v21, 114688, v19
    v_add_u32 v22, 114688, v20
    ds_read_b64_tr_b16 a[48:49], v21 offset:0
    ds_read_b64_tr_b16 a[50:51], v21 offset:4096
    ds_read_b64_tr_b16 a[52:53], v21 offset:8192
    ds_read_b64_tr_b16 a[54:55], v21 offset:12288
    ds_read_b64_tr_b16 a[56:57], v22 offset:0
    ds_read_b64_tr_b16 a[58:59], v22 offset:4096
    ds_read_b64_tr_b16 a[60:61], v22 offset:8192
    ds_read_b64_tr_b16 a[62:63], v22 offset:12288
    s_waitcnt lgkmcnt(0)
    s_waitcnt vmcnt(16)
    ds_read_b64_tr_b16 a[208:209], v2 offset:0
    ds_read_b64_tr_b16 a[210:211], v2 offset:1024
    ds_read_b64_tr_b16 a[212:213], v2 offset:2048
    ds_read_b64_tr_b16 a[214:215], v2 offset:3072
    ds_read_b64_tr_b16 a[240:241], v2 offset:8
    ds_read_b64_tr_b16 a[242:243], v2 offset:1032
    ds_read_b64_tr_b16 a[244:245], v2 offset:2056
    ds_read_b64_tr_b16 a[246:247], v2 offset:3080
    ds_read_b64_tr_b16 a[216:217], v2 offset:4096
    ds_read_b64_tr_b16 a[218:219], v2 offset:5120
    ds_read_b64_tr_b16 a[220:221], v2 offset:6144
    ds_read_b64_tr_b16 a[222:223], v2 offset:7168
    ds_read_b64_tr_b16 a[248:249], v2 offset:4104
    ds_read_b64_tr_b16 a[250:251], v2 offset:5128
    ds_read_b64_tr_b16 a[252:253], v2 offset:6152
    ds_read_b64_tr_b16 a[254:255], v2 offset:7176
    ds_read_b64_tr_b16 a[224:225], v2 offset:8192
    ds_read_b64_tr_b16 a[226:227], v2 offset:9216
    ds_read_b64_tr_b16 a[228:229], v2 offset:10240
    ds_read_b64_tr_b16 a[230:231], v2 offset:11264
    ds_read_b64_tr_b16 v[96:97], v2 offset:8200
    ds_read_b64_tr_b16 v[98:99], v2 offset:9224
    ds_read_b64_tr_b16 v[100:101], v2 offset:10248
    ds_read_b64_tr_b16 v[102:103], v2 offset:11272
    ds_read_b64_tr_b16 a[232:233], v2 offset:12288
    ds_read_b64_tr_b16 a[234:235], v2 offset:13312
    ds_read_b64_tr_b16 a[236:237], v2 offset:14336
    ds_read_b64_tr_b16 a[238:239], v2 offset:15360
    ds_read_b64_tr_b16 v[104:105], v2 offset:12296
    ds_read_b64_tr_b16 v[106:107], v2 offset:13320
    ds_read_b64_tr_b16 v[108:109], v2 offset:14344
    ds_read_b64_tr_b16 v[110:111], v2 offset:15368
    s_waitcnt lgkmcnt(0)
    s_waitcnt vmcnt(12)
    s_barrier
    s_add_u32 m0, s42, 114688
    s_add_u32 s36, s41, 1572864
    buffer_load_dwordx4 v16, s[16:19], s36 offen lds
    s_add_u32 m0, s42, 115712
    s_add_u32 s36, s41, 1605632
    buffer_load_dwordx4 v17, s[16:19], s36 offen lds
    s_add_u32 m0, s42, 116736
    s_add_u32 s36, s41, 1703936
    buffer_load_dwordx4 v16, s[16:19], s36 offen lds
    s_add_u32 m0, s42, 117760
    s_add_u32 s36, s41, 1736704
    buffer_load_dwordx4 v17, s[16:19], s36 offen lds
    v_add_u32 v21, 147456, v19
    v_add_u32 v22, 147456, v20
    ds_read_b64_tr_b16 a[64:65], v21 offset:0
    ds_read_b64_tr_b16 a[66:67], v21 offset:4096
    ds_read_b64_tr_b16 a[68:69], v21 offset:8192
    ds_read_b64_tr_b16 a[70:71], v21 offset:12288
    ds_read_b64_tr_b16 a[72:73], v22 offset:0
    ds_read_b64_tr_b16 a[74:75], v22 offset:4096
    ds_read_b64_tr_b16 a[76:77], v22 offset:8192
    ds_read_b64_tr_b16 a[78:79], v22 offset:12288
    s_waitcnt lgkmcnt(0)
    s_waitcnt vmcnt(12)
    s_barrier
    s_add_u32 m0, s42, 147456
    s_add_u32 s36, s41, 1572864
    buffer_load_dwordx4 v16, s[20:23], s36 offen lds
    s_add_u32 m0, s42, 148480
    s_add_u32 s36, s41, 1605632
    buffer_load_dwordx4 v17, s[20:23], s36 offen lds
    s_add_u32 m0, s42, 149504
    s_add_u32 s36, s41, 1703936
    buffer_load_dwordx4 v16, s[20:23], s36 offen lds
    s_add_u32 m0, s42, 150528
    s_add_u32 s36, s41, 1736704
    buffer_load_dwordx4 v17, s[20:23], s36 offen lds
    v_add_u32 v21, 0, v19
    v_add_u32 v22, 0, v20
    ds_read_b64_tr_b16 a[80:81], v21 offset:0
    ds_read_b64_tr_b16 a[82:83], v21 offset:4096
    ds_read_b64_tr_b16 a[84:85], v21 offset:8192
    ds_read_b64_tr_b16 a[86:87], v21 offset:12288
    ds_read_b64_tr_b16 a[88:89], v22 offset:0
    ds_read_b64_tr_b16 a[90:91], v22 offset:4096
    ds_read_b64_tr_b16 a[92:93], v22 offset:8192
    ds_read_b64_tr_b16 a[94:95], v22 offset:12288
    s_waitcnt lgkmcnt(0)
    s_waitcnt vmcnt(12)
    s_barrier
    s_add_u32 m0, s42, 0
    s_add_u32 s36, s41, 2097152
    buffer_load_dwordx4 v16, s[12:15], s36 offen lds
    s_add_u32 m0, s42, 1024
    s_add_u32 s36, s41, 2129920
    buffer_load_dwordx4 v17, s[12:15], s36 offen lds
    s_add_u32 m0, s42, 2048
    s_add_u32 s36, s41, 2228224
    buffer_load_dwordx4 v16, s[12:15], s36 offen lds
    s_add_u32 m0, s42, 3072
    s_add_u32 s36, s41, 2260992
    buffer_load_dwordx4 v17, s[12:15], s36 offen lds
    v_add_u32 v21, 40960, v19
    v_add_u32 v22, 40960, v20
    ds_read_b64_tr_b16 a[96:97], v21 offset:0
    ds_read_b64_tr_b16 a[98:99], v21 offset:4096
    ds_read_b64_tr_b16 a[100:101], v21 offset:8192
    ds_read_b64_tr_b16 a[102:103], v21 offset:12288
    ds_read_b64_tr_b16 a[104:105], v22 offset:0
    ds_read_b64_tr_b16 a[106:107], v22 offset:4096
    ds_read_b64_tr_b16 a[108:109], v22 offset:8192
    ds_read_b64_tr_b16 a[110:111], v22 offset:12288
    s_waitcnt lgkmcnt(0)
    s_waitcnt vmcnt(12)
    s_barrier
    s_add_u32 m0, s42, 40960
    s_add_u32 s36, s41, 2097152
    buffer_load_dwordx4 v16, s[16:19], s36 offen lds
    s_add_u32 m0, s42, 41984
    s_add_u32 s36, s41, 2129920
    buffer_load_dwordx4 v17, s[16:19], s36 offen lds
    s_add_u32 m0, s42, 43008
    s_add_u32 s36, s41, 2228224
    buffer_load_dwordx4 v16, s[16:19], s36 offen lds
    s_add_u32 m0, s42, 44032
    s_add_u32 s36, s41, 2260992
    buffer_load_dwordx4 v17, s[16:19], s36 offen lds
    v_add_u32 v21, 81920, v19
    v_add_u32 v22, 81920, v20
    ds_read_b64_tr_b16 a[112:113], v21 offset:0
    ds_read_b64_tr_b16 a[114:115], v21 offset:4096
    ds_read_b64_tr_b16 a[116:117], v21 offset:8192
    ds_read_b64_tr_b16 a[118:119], v21 offset:12288
    ds_read_b64_tr_b16 a[120:121], v22 offset:0
    ds_read_b64_tr_b16 a[122:123], v22 offset:4096
    ds_read_b64_tr_b16 a[124:125], v22 offset:8192
    ds_read_b64_tr_b16 a[126:127], v22 offset:12288
    s_waitcnt lgkmcnt(0)
    s_waitcnt vmcnt(12)
    s_barrier
    s_add_u32 m0, s42, 81920
    s_add_u32 s36, s41, 2097152
    buffer_load_dwordx4 v16, s[20:23], s36 offen lds
    s_add_u32 m0, s42, 82944
    s_add_u32 s36, s41, 2129920
    buffer_load_dwordx4 v17, s[20:23], s36 offen lds
    s_add_u32 m0, s42, 83968
    s_add_u32 s36, s41, 2228224
    buffer_load_dwordx4 v16, s[20:23], s36 offen lds
    s_add_u32 m0, s42, 84992
    s_add_u32 s36, s41, 2260992
    buffer_load_dwordx4 v17, s[20:23], s36 offen lds
    v_add_u32 v21, 114688, v19
    v_add_u32 v22, 114688, v20
    ds_read_b64_tr_b16 a[128:129], v21 offset:0
    ds_read_b64_tr_b16 a[130:131], v21 offset:4096
    ds_read_b64_tr_b16 a[132:133], v21 offset:8192
    ds_read_b64_tr_b16 a[134:135], v21 offset:12288
    ds_read_b64_tr_b16 a[136:137], v22 offset:0
    ds_read_b64_tr_b16 a[138:139], v22 offset:4096
    ds_read_b64_tr_b16 a[140:141], v22 offset:8192
    ds_read_b64_tr_b16 a[142:143], v22 offset:12288
    s_waitcnt lgkmcnt(0)
    s_waitcnt vmcnt(12)
    s_barrier
    s_add_u32 m0, s42, 114688
    s_add_u32 s36, s40, 0
    buffer_load_dwordx4 v16, s[12:15], s36 offen lds
    s_add_u32 m0, s42, 115712
    s_add_u32 s36, s40, 32768
    buffer_load_dwordx4 v17, s[12:15], s36 offen lds
    s_add_u32 m0, s42, 116736
    s_add_u32 s36, s40, 131072
    buffer_load_dwordx4 v16, s[12:15], s36 offen lds
    s_add_u32 m0, s42, 117760
    s_add_u32 s36, s40, 163840
    buffer_load_dwordx4 v17, s[12:15], s36 offen lds
    v_add_u32 v21, 147456, v19
    v_add_u32 v22, 147456, v20
    ds_read_b64_tr_b16 a[144:145], v21 offset:0
    ds_read_b64_tr_b16 a[146:147], v21 offset:4096
    ds_read_b64_tr_b16 a[148:149], v21 offset:8192
    ds_read_b64_tr_b16 a[150:151], v21 offset:12288
    ds_read_b64_tr_b16 a[152:153], v22 offset:0
    ds_read_b64_tr_b16 a[154:155], v22 offset:4096
    ds_read_b64_tr_b16 a[156:157], v22 offset:8192
    ds_read_b64_tr_b16 a[158:159], v22 offset:12288
    s_waitcnt lgkmcnt(0)
    s_waitcnt vmcnt(12)
    s_barrier
    s_add_u32 m0, s42, 147456
    s_add_u32 s36, s40, 0
    buffer_load_dwordx4 v16, s[16:19], s36 offen lds
    s_add_u32 m0, s42, 148480
    s_add_u32 s36, s40, 32768
    buffer_load_dwordx4 v17, s[16:19], s36 offen lds
    s_add_u32 m0, s42, 149504
    s_add_u32 s36, s40, 131072
    buffer_load_dwordx4 v16, s[16:19], s36 offen lds
    s_add_u32 m0, s42, 150528
    s_add_u32 s36, s40, 163840
    buffer_load_dwordx4 v17, s[16:19], s36 offen lds
    v_add_u32 v21, 0, v19
    v_add_u32 v22, 0, v20
    ds_read_b64_tr_b16 a[160:161], v21 offset:0
    ds_read_b64_tr_b16 a[162:163], v21 offset:4096
    ds_read_b64_tr_b16 a[164:165], v21 offset:8192
    ds_read_b64_tr_b16 a[166:167], v21 offset:12288
    ds_read_b64_tr_b16 a[168:169], v22 offset:0
    ds_read_b64_tr_b16 a[170:171], v22 offset:4096
    ds_read_b64_tr_b16 a[172:173], v22 offset:8192
    ds_read_b64_tr_b16 a[174:175], v22 offset:12288
    s_waitcnt lgkmcnt(0)
    s_waitcnt vmcnt(12)
    s_barrier
    s_add_u32 m0, s42, 0
    s_add_u32 s36, s40, 0
    buffer_load_dwordx4 v16, s[20:23], s36 offen lds
    s_add_u32 m0, s42, 1024
    s_add_u32 s36, s40, 32768
    buffer_load_dwordx4 v17, s[20:23], s36 offen lds
    s_add_u32 m0, s42, 2048
    s_add_u32 s36, s40, 131072
    buffer_load_dwordx4 v16, s[20:23], s36 offen lds
    s_add_u32 m0, s42, 3072
    s_add_u32 s36, s40, 163840
    buffer_load_dwordx4 v17, s[20:23], s36 offen lds
    v_add_u32 v21, 40960, v19
    v_add_u32 v22, 40960, v20
    ds_read_b64_tr_b16 a[176:177], v21 offset:0
    ds_read_b64_tr_b16 a[178:179], v21 offset:4096
    ds_read_b64_tr_b16 a[180:181], v21 offset:8192
    ds_read_b64_tr_b16 a[182:183], v21 offset:12288
    ds_read_b64_tr_b16 a[184:185], v22 offset:0
    ds_read_b64_tr_b16 a[186:187], v22 offset:4096
    ds_read_b64_tr_b16 a[188:189], v22 offset:8192
    ds_read_b64_tr_b16 a[190:191], v22 offset:12288
    s_waitcnt lgkmcnt(0)
    s_waitcnt vmcnt(12)
    s_barrier
    s_add_u32 m0, s42, 40960
    s_add_u32 s36, s40, 524288
    buffer_load_dwordx4 v16, s[12:15], s36 offen lds
    s_add_u32 m0, s42, 41984
    s_add_u32 s36, s40, 557056
    buffer_load_dwordx4 v17, s[12:15], s36 offen lds
    s_add_u32 m0, s42, 43008
    s_add_u32 s36, s40, 655360
    buffer_load_dwordx4 v16, s[12:15], s36 offen lds
    s_add_u32 m0, s42, 44032
    s_add_u32 s36, s40, 688128
    buffer_load_dwordx4 v17, s[12:15], s36 offen lds
    v_add_u32 v21, 81920, v19
    v_add_u32 v22, 81920, v20
    ds_read_b64_tr_b16 a[192:193], v21 offset:0
    ds_read_b64_tr_b16 a[194:195], v21 offset:4096
    ds_read_b64_tr_b16 a[196:197], v21 offset:8192
    ds_read_b64_tr_b16 a[198:199], v21 offset:12288
    ds_read_b64_tr_b16 a[200:201], v22 offset:0
    ds_read_b64_tr_b16 a[202:203], v22 offset:4096
    ds_read_b64_tr_b16 a[204:205], v22 offset:8192
    ds_read_b64_tr_b16 a[206:207], v22 offset:12288
    s_waitcnt lgkmcnt(0)
    s_waitcnt vmcnt(12)
    s_barrier
    s_add_u32 m0, s42, 81920
    s_add_u32 s36, s40, 524288
    buffer_load_dwordx4 v16, s[16:19], s36 offen lds
    s_add_u32 m0, s42, 82944
    s_add_u32 s36, s40, 557056
    buffer_load_dwordx4 v17, s[16:19], s36 offen lds
    s_add_u32 m0, s42, 83968
    s_add_u32 s36, s40, 655360
    buffer_load_dwordx4 v16, s[16:19], s36 offen lds
    s_add_u32 m0, s42, 84992
    s_add_u32 s36, s40, 688128
    buffer_load_dwordx4 v17, s[16:19], s36 offen lds
    v_add_u32 v21, 114688, v19
    v_add_u32 v22, 114688, v20
    ds_read_b64_tr_b16 v[24:25], v21 offset:0
    ds_read_b64_tr_b16 v[26:27], v21 offset:4096
    ds_read_b64_tr_b16 v[28:29], v21 offset:8192
    ds_read_b64_tr_b16 v[30:31], v21 offset:12288
    ds_read_b64_tr_b16 v[112:113], v22 offset:0
    ds_read_b64_tr_b16 v[114:115], v22 offset:4096
    ds_read_b64_tr_b16 v[116:117], v22 offset:8192
    ds_read_b64_tr_b16 v[118:119], v22 offset:12288
    s_waitcnt lgkmcnt(0)
    ds_write_b128 v2, v[24:27] offset:0
    ds_write_b128 v2, v[28:31] offset:1024
    s_waitcnt vmcnt(12)
    s_barrier
    s_add_u32 m0, s42, 114688
    s_add_u32 s36, s40, 524288
    buffer_load_dwordx4 v16, s[20:23], s36 offen lds
    s_add_u32 m0, s42, 115712
    s_add_u32 s36, s40, 557056
    buffer_load_dwordx4 v17, s[20:23], s36 offen lds
    s_add_u32 m0, s42, 116736
    s_add_u32 s36, s40, 655360
    buffer_load_dwordx4 v16, s[20:23], s36 offen lds
    s_add_u32 m0, s42, 117760
    s_add_u32 s36, s40, 688128
    buffer_load_dwordx4 v17, s[20:23], s36 offen lds
    v_add_u32 v21, 147456, v19
    v_add_u32 v22, 147456, v20
    ds_read_b64_tr_b16 v[120:121], v21 offset:0
    ds_read_b64_tr_b16 v[122:123], v21 offset:4096
    ds_read_b64_tr_b16 v[124:125], v21 offset:8192
    ds_read_b64_tr_b16 v[126:127], v21 offset:12288
    ds_read_b64_tr_b16 v[24:25], v22 offset:0
    ds_read_b64_tr_b16 v[26:27], v22 offset:4096
    ds_read_b64_tr_b16 v[28:29], v22 offset:8192
    ds_read_b64_tr_b16 v[30:31], v22 offset:12288
    s_waitcnt lgkmcnt(0)
    ds_write_b128 v2, v[24:27] offset:2048
    ds_write_b128 v2, v[28:31] offset:3072
    s_waitcnt vmcnt(12)
    s_barrier
    s_add_u32 m0, s42, 147456
    s_add_u32 s36, s40, 1048576
    buffer_load_dwordx4 v16, s[12:15], s36 offen lds
    s_add_u32 m0, s42, 148480
    s_add_u32 s36, s40, 1081344
    buffer_load_dwordx4 v17, s[12:15], s36 offen lds
    s_add_u32 m0, s42, 149504
    s_add_u32 s36, s40, 1179648
    buffer_load_dwordx4 v16, s[12:15], s36 offen lds
    s_add_u32 m0, s42, 150528
    s_add_u32 s36, s40, 1212416
    buffer_load_dwordx4 v17, s[12:15], s36 offen lds
    v_add_u32 v21, 0, v19
    v_add_u32 v22, 0, v20
    ds_read_b64_tr_b16 v[128:129], v21 offset:0
    ds_read_b64_tr_b16 v[130:131], v21 offset:4096
    ds_read_b64_tr_b16 v[132:133], v21 offset:8192
    ds_read_b64_tr_b16 v[134:135], v21 offset:12288
    ds_read_b64_tr_b16 v[136:137], v22 offset:0
    ds_read_b64_tr_b16 v[138:139], v22 offset:4096
    ds_read_b64_tr_b16 v[140:141], v22 offset:8192
    ds_read_b64_tr_b16 v[142:143], v22 offset:12288
    s_waitcnt lgkmcnt(0)
    s_waitcnt vmcnt(12)
    s_barrier
    s_add_u32 m0, s42, 0
    s_add_u32 s36, s40, 1048576
    buffer_load_dwordx4 v16, s[16:19], s36 offen lds
    s_add_u32 m0, s42, 1024
    s_add_u32 s36, s40, 1081344
    buffer_load_dwordx4 v17, s[16:19], s36 offen lds
    s_add_u32 m0, s42, 2048
    s_add_u32 s36, s40, 1179648
    buffer_load_dwordx4 v16, s[16:19], s36 offen lds
    s_add_u32 m0, s42, 3072
    s_add_u32 s36, s40, 1212416
    buffer_load_dwordx4 v17, s[16:19], s36 offen lds
    v_add_u32 v21, 40960, v19
    v_add_u32 v22, 40960, v20
    ds_read_b64_tr_b16 v[24:25], v21 offset:0
    ds_read_b64_tr_b16 v[26:27], v21 offset:4096
    ds_read_b64_tr_b16 v[28:29], v21 offset:8192
    ds_read_b64_tr_b16 v[30:31], v21 offset:12288
    ds_read_b64_tr_b16 v[144:145], v22 offset:0
    ds_read_b64_tr_b16 v[146:147], v22 offset:4096
    ds_read_b64_tr_b16 v[148:149], v22 offset:8192
    ds_read_b64_tr_b16 v[150:151], v22 offset:12288
    s_waitcnt lgkmcnt(0)
    ds_write_b128 v2, v[24:27] offset:4096
    ds_write_b128 v2, v[28:31] offset:5120
    s_waitcnt vmcnt(12)
    s_barrier
    s_add_u32 m0, s42, 40960
    s_add_u32 s36, s40, 1048576
    buffer_load_dwordx4 v16, s[20:23], s36 offen lds
    s_add_u32 m0, s42, 41984
    s_add_u32 s36, s40, 1081344
    buffer_load_dwordx4 v17, s[20:23], s36 offen lds
    s_add_u32 m0, s42, 43008
    s_add_u32 s36, s40, 1179648
    buffer_load_dwordx4 v16, s[20:23], s36 offen lds
    s_add_u32 m0, s42, 44032
    s_add_u32 s36, s40, 1212416
    buffer_load_dwordx4 v17, s[20:23], s36 offen lds
    v_add_u32 v21, 81920, v19
    v_add_u32 v22, 81920, v20
    ds_read_b64_tr_b16 v[152:153], v21 offset:0
    ds_read_b64_tr_b16 v[154:155], v21 offset:4096
    ds_read_b64_tr_b16 v[156:157], v21 offset:8192
    ds_read_b64_tr_b16 v[158:159], v21 offset:12288
    ds_read_b64_tr_b16 v[24:25], v22 offset:0
    ds_read_b64_tr_b16 v[26:27], v22 offset:4096
    ds_read_b64_tr_b16 v[28:29], v22 offset:8192
    ds_read_b64_tr_b16 v[30:31], v22 offset:12288
    s_waitcnt lgkmcnt(0)
    ds_write_b128 v2, v[24:27] offset:6144
    ds_write_b128 v2, v[28:31] offset:7168
    s_waitcnt vmcnt(12)
    s_barrier
    s_add_u32 m0, s42, 81920
    s_add_u32 s36, s40, 1572864
    buffer_load_dwordx4 v16, s[12:15], s36 offen lds
    s_add_u32 m0, s42, 82944
    s_add_u32 s36, s40, 1605632
    buffer_load_dwordx4 v17, s[12:15], s36 offen lds
    s_add_u32 m0, s42, 83968
    s_add_u32 s36, s40, 1703936
    buffer_load_dwordx4 v16, s[12:15], s36 offen lds
    s_add_u32 m0, s42, 84992
    s_add_u32 s36, s40, 1736704
    buffer_load_dwordx4 v17, s[12:15], s36 offen lds
    v_add_u32 v21, 114688, v19
    v_add_u32 v22, 114688, v20
    ds_read_b64_tr_b16 v[160:161], v21 offset:0
    ds_read_b64_tr_b16 v[162:163], v21 offset:4096
    ds_read_b64_tr_b16 v[164:165], v21 offset:8192
    ds_read_b64_tr_b16 v[166:167], v21 offset:12288
    ds_read_b64_tr_b16 v[168:169], v22 offset:0
    ds_read_b64_tr_b16 v[170:171], v22 offset:4096
    ds_read_b64_tr_b16 v[172:173], v22 offset:8192
    ds_read_b64_tr_b16 v[174:175], v22 offset:12288
    s_waitcnt lgkmcnt(0)
    s_waitcnt vmcnt(12)
    s_barrier
    s_add_u32 m0, s42, 114688
    s_add_u32 s36, s40, 1572864
    buffer_load_dwordx4 v16, s[16:19], s36 offen lds
    s_add_u32 m0, s42, 115712
    s_add_u32 s36, s40, 1605632
    buffer_load_dwordx4 v17, s[16:19], s36 offen lds
    s_add_u32 m0, s42, 116736
    s_add_u32 s36, s40, 1703936
    buffer_load_dwordx4 v16, s[16:19], s36 offen lds
    s_add_u32 m0, s42, 117760
    s_add_u32 s36, s40, 1736704
    buffer_load_dwordx4 v17, s[16:19], s36 offen lds
    v_add_u32 v21, 147456, v19
    v_add_u32 v22, 147456, v20
    ds_read_b64_tr_b16 v[24:25], v21 offset:0
    ds_read_b64_tr_b16 v[26:27], v21 offset:4096
    ds_read_b64_tr_b16 v[28:29], v21 offset:8192
    ds_read_b64_tr_b16 v[30:31], v21 offset:12288
    ds_read_b64_tr_b16 v[176:177], v22 offset:0
    ds_read_b64_tr_b16 v[178:179], v22 offset:4096
    ds_read_b64_tr_b16 v[180:181], v22 offset:8192
    ds_read_b64_tr_b16 v[182:183], v22 offset:12288
    s_waitcnt lgkmcnt(0)
    ds_write_b128 v2, v[24:27] offset:8192
    ds_write_b128 v2, v[28:31] offset:9216
    s_waitcnt vmcnt(12)
    s_barrier
    s_add_u32 m0, s42, 147456
    s_add_u32 s36, s40, 1572864
    buffer_load_dwordx4 v16, s[20:23], s36 offen lds
    s_add_u32 m0, s42, 148480
    s_add_u32 s36, s40, 1605632
    buffer_load_dwordx4 v17, s[20:23], s36 offen lds
    s_add_u32 m0, s42, 149504
    s_add_u32 s36, s40, 1703936
    buffer_load_dwordx4 v16, s[20:23], s36 offen lds
    s_add_u32 m0, s42, 150528
    s_add_u32 s36, s40, 1736704
    buffer_load_dwordx4 v17, s[20:23], s36 offen lds
    v_add_u32 v21, 0, v19
    v_add_u32 v22, 0, v20
    ds_read_b64_tr_b16 v[24:25], v21 offset:0
    ds_read_b64_tr_b16 v[26:27], v21 offset:4096
    ds_read_b64_tr_b16 v[28:29], v21 offset:8192
    ds_read_b64_tr_b16 v[30:31], v21 offset:12288
    ds_read_b64_tr_b16 v[184:185], v22 offset:0
    ds_read_b64_tr_b16 v[186:187], v22 offset:4096
    ds_read_b64_tr_b16 v[188:189], v22 offset:8192
    ds_read_b64_tr_b16 v[190:191], v22 offset:12288
    s_waitcnt lgkmcnt(0)
    ds_write_b128 v2, v[24:27] offset:10240
    ds_write_b128 v2, v[28:31] offset:11264
    s_waitcnt vmcnt(12)
    s_barrier
    s_add_u32 m0, s42, 0
    s_add_u32 s36, s40, 2097152
    buffer_load_dwordx4 v16, s[12:15], s36 offen lds
    s_add_u32 m0, s42, 1024
    s_add_u32 s36, s40, 2129920
    buffer_load_dwordx4 v17, s[12:15], s36 offen lds
    s_add_u32 m0, s42, 2048
    s_add_u32 s36, s40, 2228224
    buffer_load_dwordx4 v16, s[12:15], s36 offen lds
    s_add_u32 m0, s42, 3072
    s_add_u32 s36, s40, 2260992
    buffer_load_dwordx4 v17, s[12:15], s36 offen lds
    v_add_u32 v21, 40960, v19
    v_add_u32 v22, 40960, v20
    ds_read_b64_tr_b16 v[24:25], v21 offset:0
    ds_read_b64_tr_b16 v[26:27], v21 offset:4096
    ds_read_b64_tr_b16 v[28:29], v21 offset:8192
    ds_read_b64_tr_b16 v[30:31], v21 offset:12288
    ds_read_b64_tr_b16 v[192:193], v22 offset:0
    ds_read_b64_tr_b16 v[194:195], v22 offset:4096
    ds_read_b64_tr_b16 v[196:197], v22 offset:8192
    ds_read_b64_tr_b16 v[198:199], v22 offset:12288
    s_waitcnt lgkmcnt(0)
    ds_write_b128 v2, v[24:27] offset:12288
    ds_write_b128 v2, v[28:31] offset:13312
    s_waitcnt vmcnt(12)
    s_barrier
    s_add_u32 m0, s42, 40960
    s_add_u32 s36, s40, 2097152
    buffer_load_dwordx4 v16, s[16:19], s36 offen lds
    s_add_u32 m0, s42, 41984
    s_add_u32 s36, s40, 2129920
    buffer_load_dwordx4 v17, s[16:19], s36 offen lds
    s_add_u32 m0, s42, 43008
    s_add_u32 s36, s40, 2228224
    buffer_load_dwordx4 v16, s[16:19], s36 offen lds
    s_add_u32 m0, s42, 44032
    s_add_u32 s36, s40, 2260992
    buffer_load_dwordx4 v17, s[16:19], s36 offen lds
    v_add_u32 v21, 81920, v19
    v_add_u32 v22, 81920, v20
    ds_read_b64_tr_b16 v[24:25], v21 offset:0
    ds_read_b64_tr_b16 v[26:27], v21 offset:4096
    ds_read_b64_tr_b16 v[28:29], v21 offset:8192
    ds_read_b64_tr_b16 v[30:31], v21 offset:12288
    ds_read_b64_tr_b16 v[200:201], v22 offset:0
    ds_read_b64_tr_b16 v[202:203], v22 offset:4096
    ds_read_b64_tr_b16 v[204:205], v22 offset:8192
    ds_read_b64_tr_b16 v[206:207], v22 offset:12288
    s_waitcnt lgkmcnt(0)
    ds_write_b128 v2, v[24:27] offset:14336
    ds_write_b128 v2, v[28:31] offset:15360
    s_waitcnt vmcnt(12)
    s_barrier
    s_add_u32 m0, s42, 81920
    s_add_u32 s36, s40, 2097152
    buffer_load_dwordx4 v16, s[20:23], s36 offen lds
    s_add_u32 m0, s42, 82944
    s_add_u32 s36, s40, 2129920
    buffer_load_dwordx4 v17, s[20:23], s36 offen lds
    s_add_u32 m0, s42, 83968
    s_add_u32 s36, s40, 2228224
    buffer_load_dwordx4 v16, s[20:23], s36 offen lds
    s_add_u32 m0, s42, 84992
    s_add_u32 s36, s40, 2260992
    buffer_load_dwordx4 v17, s[20:23], s36 offen lds
    v_add_u32 v21, 114688, v19
    v_add_u32 v22, 114688, v20
    ds_read_b64_tr_b16 v[208:209], v21 offset:0
    ds_read_b64_tr_b16 v[210:211], v21 offset:4096
    ds_read_b64_tr_b16 v[212:213], v21 offset:8192
    ds_read_b64_tr_b16 v[214:215], v21 offset:12288
    ds_read_b64_tr_b16 v[64:65], v22 offset:0
    ds_read_b64_tr_b16 v[66:67], v22 offset:4096
    ds_read_b64_tr_b16 v[68:69], v22 offset:8192
    ds_read_b64_tr_b16 v[70:71], v22 offset:12288
    s_waitcnt lgkmcnt(0)
    s_waitcnt vmcnt(12)
    s_barrier
    s_add_u32 m0, s42, 114688
    s_add_u32 s36, s41, 0
    buffer_load_dwordx4 v16, s[20:23], s36 offen lds
    s_add_u32 m0, s42, 115712
    s_add_u32 s36, s41, 32768
    buffer_load_dwordx4 v17, s[20:23], s36 offen lds
    s_add_u32 m0, s42, 116736
    s_add_u32 s36, s41, 131072
    buffer_load_dwordx4 v16, s[20:23], s36 offen lds
    s_add_u32 m0, s42, 117760
    s_add_u32 s36, s41, 163840
    buffer_load_dwordx4 v17, s[20:23], s36 offen lds
    v_add_u32 v21, 147456, v19
    v_add_u32 v22, 147456, v20
    ds_read_b64_tr_b16 v[216:217], v21 offset:0
    ds_read_b64_tr_b16 v[218:219], v21 offset:4096
    ds_read_b64_tr_b16 v[220:221], v21 offset:8192
    ds_read_b64_tr_b16 v[222:223], v21 offset:12288
    ds_read_b64_tr_b16 v[224:225], v22 offset:0
    ds_read_b64_tr_b16 v[226:227], v22 offset:4096
    ds_read_b64_tr_b16 v[228:229], v22 offset:8192
    ds_read_b64_tr_b16 v[230:231], v22 offset:12288
    s_waitcnt lgkmcnt(0)
    s_waitcnt vmcnt(12)
    s_barrier
    s_add_u32 m0, s42, 147456
    s_add_u32 s36, s41, 524288
    buffer_load_dwordx4 v16, s[20:23], s36 offen lds
    s_add_u32 m0, s42, 148480
    s_add_u32 s36, s41, 557056
    buffer_load_dwordx4 v17, s[20:23], s36 offen lds
    s_add_u32 m0, s42, 149504
    s_add_u32 s36, s41, 655360
    buffer_load_dwordx4 v16, s[20:23], s36 offen lds
    s_add_u32 m0, s42, 150528
    s_add_u32 s36, s41, 688128
    buffer_load_dwordx4 v17, s[20:23], s36 offen lds
    v_mov_b64 v[24:25], 0
    v_mov_b64 v[26:27], 0
    v_mov_b64 v[28:29], -1
    v_mov_b64 v[30:31], -1
    v_min_u32 v32, 0xfffffffe, v32
    v_lshrrev_b32 v9, 7, v0
    v_lshlrev_b32 v9, 13, v9
    v_and_b32 v10, 0x70, v0
    v_add_u32 v9, v9, v10
    s_mov_b64 exec, s[98:99]
    s_lshl_b32 s36, s8, 19
    s_mul_i32 s37, s63, 4352
    s_add_u32 s36, s36, s37
    s_add_u32 s36, s36, 70254592
    buffer_store_dwordx4 v[24:27], v0, s[32:35], s36 offen offset:0
    buffer_store_dwordx4 v[24:27], v0, s[32:35], s36 offen offset:1024
    buffer_store_dwordx4 v[24:27], v0, s[32:35], s36 offen offset:2048
    buffer_store_dwordx4 v[24:27], v0, s[32:35], s36 offen offset:3072
    s_lshl_b32 s36, s8, 17
    s_add_u32 s36, s36, 69206016
    buffer_store_dword v32, v8, s[32:35], s36 offen
    s_lshl_b32 s36, s8, 17
    s_add_u32 s36, s36, 69222400
    buffer_store_dword v28, v8, s[32:35], s36 offen
    s_lshl_b32 s36, s8, 17
    s_add_u32 s36, s36, 69238784
    buffer_store_dword v28, v8, s[32:35], s36 offen
    s_lshl_b32 s36, s8, 20
    s_add_u32 s36, s36, s64
    s_add_u32 s36, s36, 67125248
    buffer_store_dwordx4 v[28:31], v9, s[32:35], s36 offen sc1
    s_add_u32 s36, s36, 0x10000
    buffer_store_dwordx4 v[28:31], v9, s[32:35], s36 offen sc1
    s_add_u32 s36, s36, 0x10000
    buffer_store_dwordx4 v[28:31], v9, s[32:35], s36 offen sc1
    s_add_u32 s36, s36, 0x10000
    buffer_store_dwordx4 v[28:31], v9, s[32:35], s36 offen sc1
    s_add_u32 s36, s36, 0x10000
    buffer_store_dwordx4 v[28:31], v9, s[32:35], s36 offen sc1
    s_add_u32 s36, s36, 0x10000
    buffer_store_dwordx4 v[28:31], v9, s[32:35], s36 offen sc1
    s_add_u32 s36, s36, 0x10000
    buffer_store_dwordx4 v[28:31], v9, s[32:35], s36 offen sc1
    s_add_u32 s36, s36, 0x10000
    buffer_store_dwordx4 v[28:31], v9, s[32:35], s36 offen sc1
    s_add_u32 s36, s36, 0x10000
    buffer_store_dwordx4 v[28:31], v9, s[32:35], s36 offen sc1
    s_add_u32 s36, s36, 0x10000
    buffer_store_dwordx4 v[28:31], v9, s[32:35], s36 offen sc1
    s_add_u32 s36, s36, 0x10000
    buffer_store_dwordx4 v[28:31], v9, s[32:35], s36 offen sc1
    s_add_u32 s36, s36, 0x10000
    buffer_store_dwordx4 v[28:31], v9, s[32:35], s36 offen sc1
    s_add_u32 s36, s36, 0x10000
    buffer_store_dwordx4 v[28:31], v9, s[32:35], s36 offen sc1
    s_add_u32 s36, s36, 0x10000
    buffer_store_dwordx4 v[28:31], v9, s[32:35], s36 offen sc1
    s_add_u32 s36, s36, 0x10000
    buffer_store_dwordx4 v[28:31], v9, s[32:35], s36 offen sc1
    s_add_u32 s36, s36, 0x10000
    s_and_b32 exec_hi, exec_hi, 0xffff
    buffer_store_dwordx4 v[28:31], v9, s[32:35], s36 offen sc1
    s_add_u32 s36, s36, 0x10000
    s_mov_b64 exec, s[96:97]
    s_lshl_b32 s36, s8, 20
    s_add_u32 s36, s36, 67108864
    buffer_store_dword v32, v8, s[32:35], s36 offen sc1
    s_lshl_b32 s36, s8, 20
    s_add_u32 s36, s36, 67117056
    buffer_store_dword v32, v8, s[32:35], s36 offen sc1
    s_mov_b64 exec, -1
    v_add_u32 v21, 0, v19
    v_add_u32 v22, 0, v20
    ds_read_b64_tr_b16 v[72:73], v21 offset:0
    ds_read_b64_tr_b16 v[74:75], v21 offset:4096
    ds_read_b64_tr_b16 v[76:77], v21 offset:8192
    ds_read_b64_tr_b16 v[78:79], v21 offset:12288
    ds_read_b64_tr_b16 v[232:233], v22 offset:0
    ds_read_b64_tr_b16 v[234:235], v22 offset:4096
    ds_read_b64_tr_b16 v[236:237], v22 offset:8192
    ds_read_b64_tr_b16 v[238:239], v22 offset:12288
    s_waitcnt lgkmcnt(0)
    s_waitcnt vmcnt(37)
    s_barrier
    v_add_u32 v21, 40960, v19
    v_add_u32 v22, 40960, v20
    ds_read_b64_tr_b16 v[80:81], v21 offset:0
    ds_read_b64_tr_b16 v[82:83], v21 offset:4096
    ds_read_b64_tr_b16 v[84:85], v21 offset:8192
    ds_read_b64_tr_b16 v[86:87], v21 offset:12288
    ds_read_b64_tr_b16 v[240:241], v22 offset:0
    ds_read_b64_tr_b16 v[242:243], v22 offset:4096
    ds_read_b64_tr_b16 v[244:245], v22 offset:8192
    ds_read_b64_tr_b16 v[246:247], v22 offset:12288
    s_waitcnt lgkmcnt(0)
    s_waitcnt vmcnt(33)
    s_barrier
    v_add_u32 v21, 81920, v19
    v_add_u32 v22, 81920, v20
    ds_read_b64_tr_b16 v[88:89], v21 offset:0
    ds_read_b64_tr_b16 v[90:91], v21 offset:4096
    ds_read_b64_tr_b16 v[92:93], v21 offset:8192
    ds_read_b64_tr_b16 v[94:95], v21 offset:12288
    ds_read_b64_tr_b16 v[248:249], v22 offset:0
    ds_read_b64_tr_b16 v[250:251], v22 offset:4096
    ds_read_b64_tr_b16 v[252:253], v22 offset:8192
    ds_read_b64_tr_b16 v[254:255], v22 offset:12288
    s_waitcnt lgkmcnt(0)
    s_waitcnt vmcnt(29)
    s_barrier
    v_add_u32 v21, 114688, v19
    v_add_u32 v22, 114688, v20
    ds_read_b64_tr_b16 v[36:37], v21 offset:0
    ds_read_b64_tr_b16 v[38:39], v21 offset:4096
    ds_read_b64_tr_b16 v[40:41], v21 offset:8192
    ds_read_b64_tr_b16 v[42:43], v21 offset:12288
    ds_read_b64_tr_b16 v[44:45], v22 offset:0
    ds_read_b64_tr_b16 v[46:47], v22 offset:4096
    ds_read_b64_tr_b16 v[48:49], v22 offset:8192
    ds_read_b64_tr_b16 v[50:51], v22 offset:12288
    s_waitcnt lgkmcnt(0)
    s_waitcnt vmcnt(25)
    s_barrier
    v_add_u32 v21, 147456, v19
    v_add_u32 v22, 147456, v20
    ds_read_b64_tr_b16 v[52:53], v21 offset:0
    ds_read_b64_tr_b16 v[54:55], v21 offset:4096
    ds_read_b64_tr_b16 v[56:57], v21 offset:8192
    ds_read_b64_tr_b16 v[58:59], v21 offset:12288
    ds_read_b64_tr_b16 v[60:61], v22 offset:0
    ds_read_b64_tr_b16 v[62:63], v22 offset:4096
    ds_read_b64_tr_b16 v[12:13], v22 offset:8192
    ds_read_b64_tr_b16 v[14:15], v22 offset:12288
    s_waitcnt lgkmcnt(0)
    s_barrier
    ds_write_b128 v2, v[64:67] offset:16384
    ds_write_b128 v2, v[68:71] offset:17408
    ds_write_b128 v2, v[72:75] offset:18432
    ds_write_b128 v2, v[76:79] offset:19456
    ds_write_b128 v2, v[80:83] offset:20480
    ds_write_b128 v2, v[84:87] offset:21504
    ds_write_b128 v2, v[88:91] offset:22528
    ds_write_b128 v2, v[92:95] offset:23552
    ds_write_b128 v2, v[36:39] offset:24576
    ds_write_b128 v2, v[40:43] offset:25600
    ds_write_b128 v2, v[44:47] offset:26624
    ds_write_b128 v2, v[48:51] offset:27648
    ds_write_b128 v2, v[52:55] offset:28672
    ds_write_b128 v2, v[56:59] offset:29696
    ds_write_b128 v2, v[60:63] offset:30720
    ds_write_b128 v2, v[12:15] offset:31744
    s_waitcnt lgkmcnt(0)
    s_mov_b32 s3, s63
    s_mov_b32 m0, 6400
    v_bfe_u32 v9, v0, 4, 3
    v_and_b32 v10, 1, v9
    v_lshlrev_b32 v10, 4, v10
    v_mov_b32 v11, 0x3f80
    v_lshlrev_b32 v10, v10, v11
    v_lshrrev_b32 v9, 1, v9
    v_cmp_eq_u32 vcc, 0, v9
    s_nop 1
    v_cndmask_b32 v52, 0, v10, vcc
    v_cmp_eq_u32 vcc, 1, v9
    s_nop 1
    v_cndmask_b32 v53, 0, v10, vcc
    v_cmp_eq_u32 vcc, 2, v9
    s_nop 1
    v_cndmask_b32 v54, 0, v10, vcc
    v_cmp_eq_u32 vcc, 3, v9
    s_nop 1
    v_cndmask_b32 v55, 0, v10, vcc
    ds_write_b128 v0, v[52:55] offset:7168
    s_waitcnt lgkmcnt(0)
    s_waitcnt vmcnt(0)
    s_barrier
    v_mov_b32 v9, 32
cwait_8:
    s_sub_u32 s88, s88, 1
    s_cbranch_scc1 k_end
    global_load_dwordx2 v[12:13], v9, s[6:7] sc1
    s_waitcnt vmcnt(0)
    v_readfirstlane_b32 s36, v12
    v_readfirstlane_b32 s37, v13
    s_cmp_lt_u32 s36, 64
    s_cbranch_scc1 cwait_8
    s_cmp_eq_u32 s37, 0
    s_cbranch_scc1 cwait_8
    s_and_b32 s42, s37, 2
    s_lshl_b32 s42, s42, 12
    v_lshrrev_b32 v11, 7, v0
    v_lshlrev_b32 v11, 8, v11
    v_and_b32 v9, 0x70, v0
    v_add_u32 v11, v11, v9
    s_memtime s[82:83]
    s_memrealtime s[84:85]
    s_waitcnt lgkmcnt(0)
    v_lshrrev_b32 v9, 7, v1
    v_lshlrev_b32 v9, 3, v9
    v_xor_b32 v1, v1, v9
    ds_read_b128 v[64:67], v2 offset:0
    ds_read_b128 v[68:71], v2 offset:1024
    ds_read_b128 v[72:75], v2 offset:2048
    ds_read_b128 v[76:79], v2 offset:3072
    ds_read_b128 v[80:83], v2 offset:4096
    ds_read_b128 v[84:87], v2 offset:5120
    ds_read_b128 v[88:91], v2 offset:6144
    ds_read_b128 v[92:95], v2 offset:7168
    v_mov_b64 v[12:13], 0
    v_mov_b64 v[14:15], 0
    v_mov_b64 v[16:17], 0
    v_mov_b64 v[18:19], 0
    v_mov_b64 v[20:21], 0
    v_mov_b64 v[22:23], 0
    v_mov_b64 v[24:25], 0
    v_mov_b64 v[26:27], 0
    v_mov_b64 v[28:29], 0
    v_mov_b64 v[30:31], 0
    v_mov_b64 v[32:33], 0
    v_mov_b64 v[34:35], 0
    s_lshl_b32 s36, s8, 17
    s_add_u32 s12, s36, 69206016
    s_add_u32 s13, s12, 0x4000
    s_add_u32 s14, s12, 0x8000
    s_and_b32 s29, s9, 1
    s_mul_i32 s29, s29, 10240
    s_add_u32 s18, s12, s29
    s_xor_b32 s28, s18, 2048
    s_add_u32 s15, s18, 4096
    s_lshl_b32 s36, s8, 20
    s_add_u32 s36, s36, s42
    s_add_u32 s16, s36, 67108864
    s_xor_b32 s19, s16, 0x100000
    s_add_u32 s20, s19, 4096
    s_lshl_b32 s36, s8, 19
    s_add_u32 s21, s36, 70254592
    s_mul_i32 s37, s3, 4352
    s_add_u32 s22, s21, s37
    s_mov_b32 s26, 0
    s_mov_b32 s17, 0
    s_mov_b32 s27, 0x10000
    s_lshl_b32 s36, s9, 13
    s_lshl_b32 s37, s10, 11
    s_add_u32 s23, s36, s37
    s_add_u32 s23, s23, 16777216
    s_lshl_b32 s37, s10, 12
    s_add_u32 s25, s36, s37
    s_add_u32 s25, s25, 262144
    s_lshr_b32 s36, s9, 1
    s_lshl_b32 s36, s36, 14
    s_and_b32 s37, s9, 1
    s_lshl_b32 s37, s37, 12
    s_add_u32 s24, s36, s37
    s_lshl_b32 s37, s8, 11
    s_add_u32 s24, s24, s37
    s_lshl_b32 s37, s10, 9
    s_add_u32 s24, s24, s37
    s_add_u32 s24, s24, s42
    s_add_u32 s24, s24, 50331648
    s_sub_u32 s100, 0, s8
    s_mov_b32 s101, s100
    s_mov_b64 exec, s[96:97]
    buffer_load_dword v56, v8, s[32:35], s12 offen sc1
    s_mov_b64 exec, -1
    s_waitcnt vmcnt(0)
cB_top:
    s_barrier
    s_nop 15
    s_nop 15
    s_nop 15
    s_nop 6
    buffer_load_dwordx4 v[36:39], v11, s[32:35], s18 offen offset:0 sc1
    s_waitcnt vmcnt(3)
    ds_read_b128 v[64:67], v2 offset:0
    ds_read_b128 v[68:71], v2 offset:1024
    ds_read_b128 v[72:75], v2 offset:2048
    ds_read_b128 v[76:79], v2 offset:3072
    ds_read_b128 v[80:83], v2 offset:4096
    ds_read_b128 v[84:87], v2 offset:5120
    ds_read_b128 v[88:91], v2 offset:6144
    ds_read_b128 v[92:95], v2 offset:7168
    v_mov_b64 v[12:13], 0
    v_mov_b64 v[14:15], 0
    v_mov_b64 v[16:17], 0
    v_mov_b64 v[18:19], 0
    v_mov_b64 v[20:21], 0
    v_mov_b64 v[22:23], 0
    v_mov_b64 v[24:25], 0
    v_mov_b64 v[26:27], 0
    v_mov_b64 v[28:29], 0
    v_mov_b64 v[30:31], 0
    v_mov_b64 v[32:33], 0
    v_mov_b64 v[34:35], 0
    buffer_load_dwordx4 v[40:43], v11, s[32:35], s28 offen offset:0 sc1
    s_nop 11
    buffer_load_dwordx4 v[44:47], v11, s[32:35], s18 offen offset:128 sc1
    s_nop 11
    buffer_load_dwordx4 v[48:51], v11, s[32:35], s28 offen offset:128 sc1
    s_nop 11
    buffer_load_dwordx4 v[52:55], v11, s[32:35], s15 offen offset:0 sc1
    s_waitcnt vmcnt(4)
    v_max3_u32 v9, v36, v37, v38
    v_max_u32 v9, v9, v39
    v_cmp_eq_u32 vcc, -1, v9
    s_cbranch_vccnz cB_slowL0
cB_backL0:
    s_waitcnt lgkmcnt(6)
    v_smfmac_f32_16x16x64_bf16 v[12:15], v[36:39], v[64:71], v3
    ds_read_b128 v[64:67], v2 offset:8192
    ds_read_b128 v[68:71], v2 offset:9216
    v_smfmac_f32_16x16x64_bf16 v[16:19], v[36:39], v[112:119], v3
    s_waitcnt vmcnt(3)
    v_max3_u32 v9, v40, v41, v42
    v_smfmac_f32_16x16x64_bf16 v[20:23], v[36:39], v[120:127], v3
    v_max_u32 v9, v9, v43
    s_waitcnt lgkmcnt(6)
    v_smfmac_f32_16x16x64_bf16 v[24:27], v[36:39], v[72:79], v3
    ds_read_b128 v[72:75], v2 offset:10240
    ds_read_b128 v[76:79], v2 offset:11264
    v_cmp_eq_u32 vcc, -1, v9
    v_smfmac_f32_16x16x64_bf16 v[28:31], v[36:39], v[128:135], v3
    v_smfmac_f32_16x16x64_bf16 v[32:35], v[36:39], v[136:143], v3
    s_cbranch_vccnz cB_slowL1
cB_backL1:
    buffer_load_dwordx4 v[56:59], v11, s[32:35], s19 offen offset:0 sc1
    buffer_load_dwordx4 v[60:63], v11, s[32:35], s19 offen offset:2048 sc1
    s_waitcnt lgkmcnt(6)
    v_smfmac_f32_16x16x64_bf16 v[12:15], v[40:43], v[80:87], v3
    ds_read_b128 v[80:83], v2 offset:12288
    ds_read_b128 v[84:87], v2 offset:13312
    v_smfmac_f32_16x16x64_bf16 v[16:19], v[40:43], v[144:151], v3
    s_waitcnt vmcnt(4)
    v_max3_u32 v9, v44, v45, v46
    v_smfmac_f32_16x16x64_bf16 v[20:23], v[40:43], v[152:159], v3
    v_max_u32 v9, v9, v47
    s_waitcnt lgkmcnt(6)
    v_smfmac_f32_16x16x64_bf16 v[24:27], v[40:43], v[88:95], v3
    ds_read_b128 v[88:91], v2 offset:14336
    ds_read_b128 v[92:95], v2 offset:15360
    v_cmp_eq_u32 vcc, -1, v9
    v_smfmac_f32_16x16x64_bf16 v[28:31], v[40:43], v[160:167], v3
    v_smfmac_f32_16x16x64_bf16 v[32:35], v[40:43], v[168:175], v3
    s_cbranch_vccnz cB_slowL2
cB_backL2:
    buffer_load_dwordx4 v[36:39], v11, s[32:35], s19 offen offset:128 sc1
    buffer_load_dwordx4 v[40:43], v11, s[32:35], s19 offen offset:2176 sc1
    s_waitcnt lgkmcnt(6)
    v_smfmac_f32_16x16x64_bf16 v[12:15], v[44:47], v[64:71], v3
    ds_read_b128 v[64:67], v2 offset:16384
    ds_read_b128 v[68:71], v2 offset:17408
    v_smfmac_f32_16x16x64_bf16 v[16:19], v[44:47], v[176:183], v3
    s_waitcnt vmcnt(5)
    v_max3_u32 v9, v48, v49, v50
    s_waitcnt lgkmcnt(6)
    v_smfmac_f32_16x16x64_bf16 v[20:23], v[44:47], v[72:79], v3
    ds_read_b128 v[72:75], v2 offset:18432
    ds_read_b128 v[76:79], v2 offset:19456
    v_max_u32 v9, v9, v51
    v_smfmac_f32_16x16x64_bf16 v[24:27], v[44:47], v[184:191], v3
    v_cmp_eq_u32 vcc, -1, v9
    s_waitcnt lgkmcnt(6)
    v_smfmac_f32_16x16x64_bf16 v[28:31], v[44:47], v[80:87], v3
    ds_read_b128 v[80:83], v2 offset:20480
    ds_read_b128 v[84:87], v2 offset:21504
    v_smfmac_f32_16x16x64_bf16 v[32:35], v[44:47], v[192:199], v3
    s_cbranch_vccnz cB_slowL3
cB_backL3:
    buffer_load_dwordx4 v[44:47], v11, s[32:35], s20 offen offset:0 sc1
    s_waitcnt lgkmcnt(6)
    v_smfmac_f32_16x16x64_bf16 v[12:15], v[48:51], v[88:95], v3
    ds_read_b128 v[88:91], v2 offset:22528
    ds_read_b128 v[92:95], v2 offset:23552
    v_smfmac_f32_16x16x64_bf16 v[16:19], v[48:51], v[200:207], v3
    s_waitcnt vmcnt(5)
    v_max3_u32 v9, v52, v53, v54
    v_smfmac_f32_16x16x64_bf16 v[20:23], v[48:51], v[208:215], v3
    v_max_u32 v9, v9, v55
    s_waitcnt lgkmcnt(6)
    v_smfmac_f32_16x16x64_bf16 v[24:27], v[48:51], v[64:71], v3
    v_cmp_eq_u32 vcc, -1, v9
    v_smfmac_f32_16x16x64_bf16 v[28:31], v[48:51], v[216:223], v3
    v_smfmac_f32_16x16x64_bf16 v[32:35], v[48:51], v[224:231], v3
    s_cbranch_vccnz cB_slowL4
cB_backL4:
    s_waitcnt lgkmcnt(4)
    v_smfmac_f32_16x16x64_bf16 v[12:15], v[52:55], v[72:79], v3
    v_smfmac_f32_16x16x64_bf16 v[16:19], v[52:55], v[232:239], v3
    s_waitcnt lgkmcnt(2)
    v_smfmac_f32_16x16x64_bf16 v[20:23], v[52:55], v[80:87], v3
    v_smfmac_f32_16x16x64_bf16 v[24:27], v[52:55], v[240:247], v3
    s_waitcnt lgkmcnt(0)
    v_smfmac_f32_16x16x64_bf16 v[28:31], v[52:55], v[88:95], v3
    v_smfmac_f32_16x16x64_bf16 v[32:35], v[52:55], v[248:255], v3
    s_waitcnt vmcnt(4)
    v_max3_u32 v9, v56, v57, v58
    v_max_u32 v9, v9, v59
    v_cmp_eq_u32 vcc, -1, v9
    s_cbranch_vccnz cB_slowR0
cB_backR0:
    v_smfmac_f32_16x16x64_bf16 v[12:15], v[56:59], a[0:7], v3
    s_waitcnt vmcnt(3)
    v_max3_u32 v9, v60, v61, v62
    v_max_u32 v9, v9, v63
    v_smfmac_f32_16x16x64_bf16 v[16:19], v[56:59], a[8:15], v3
    v_cmp_eq_u32 vcc, -1, v9
    v_smfmac_f32_16x16x64_bf16 v[20:23], v[56:59], a[16:23], v3
    ds_read_b128 v[64:67], v2 offset:24576
    ds_read_b128 v[68:71], v2 offset:25600
    v_smfmac_f32_16x16x64_bf16 v[24:27], v[56:59], a[24:31], v3
    s_cbranch_vccnz cB_slowR1
cB_backR1:
    v_smfmac_f32_16x16x64_bf16 v[12:15], v[60:63], a[32:39], v3
    s_waitcnt vmcnt(2)
    v_max3_u32 v9, v36, v37, v38
    v_max_u32 v9, v9, v39
    v_smfmac_f32_16x16x64_bf16 v[16:19], v[60:63], a[40:47], v3
    v_cmp_eq_u32 vcc, -1, v9
    v_smfmac_f32_16x16x64_bf16 v[20:23], v[60:63], a[48:55], v3
    ds_read_b128 v[72:75], v2 offset:26624
    ds_read_b128 v[76:79], v2 offset:27648
    v_smfmac_f32_16x16x64_bf16 v[24:27], v[60:63], a[56:63], v3
    s_cbranch_vccnz cB_slowR2
cB_backR2:
    v_smfmac_f32_16x16x64_bf16 v[12:15], v[36:39], a[64:71], v3
    s_waitcnt vmcnt(1)
    v_max3_u32 v9, v40, v41, v42
    v_max_u32 v9, v9, v43
    v_smfmac_f32_16x16x64_bf16 v[16:19], v[36:39], a[72:79], v3
    v_cmp_eq_u32 vcc, -1, v9
    v_smfmac_f32_16x16x64_bf16 v[20:23], v[36:39], a[80:87], v3
    ds_read_b128 v[80:83], v2 offset:28672
    ds_read_b128 v[84:87], v2 offset:29696
    v_smfmac_f32_16x16x64_bf16 v[24:27], v[36:39], a[88:95], v3
    s_cbranch_vccnz cB_slowR3
cB_backR3:
    v_smfmac_f32_16x16x64_bf16 v[12:15], v[40:43], a[112:119], v3
    s_waitcnt vmcnt(0)
    v_max3_u32 v9, v44, v45, v46
    v_max_u32 v9, v9, v47
    v_smfmac_f32_16x16x64_bf16 v[16:19], v[40:43], a[120:127], v3
    v_cmp_eq_u32 vcc, -1, v9
    v_smfmac_f32_16x16x64_bf16 v[20:23], v[40:43], a[128:135], v3
    ds_read_b128 v[88:91], v2 offset:30720
    ds_read_b128 v[92:95], v2 offset:31744
    v_smfmac_f32_16x16x64_bf16 v[24:27], v[40:43], a[136:143], v3
    s_cbranch_vccnz cB_slowR4
cB_backR4:
    v_smfmac_f32_16x16x64_bf16 v[12:15], v[44:47], a[160:167], v3
    buffer_load_dwordx4 v[48:51], v0, s[32:35], s23 offen sc1
    buffer_load_dwordx4 v[52:55], v0, s[32:35], s23 offen offset:1024 sc1
    v_smfmac_f32_16x16x64_bf16 v[16:19], v[44:47], a[168:175], v3
    v_xor_b32 v10, 16, v4
    v_smfmac_f32_16x16x64_bf16 v[20:23], v[44:47], a[176:183], v3
    v_lshrrev_b32 v9, 1, v0
    v_smfmac_f32_16x16x64_bf16 v[24:27], v[44:47], a[184:191], v3
    s_waitcnt lgkmcnt(0)
    v_smfmac_f32_16x16x64_bf16 v[28:31], v[56:59], v[64:71], v3
    ds_read_b128 v[64:67], v0 offset:8192
    ds_read_b128 v[68:71], v0 offset:12288
    v_smfmac_f32_16x16x64_bf16 v[32:35], v[56:59], v[72:79], v3
    ds_read_b128 v[72:75], v0 offset:9216
    ds_read_b128 v[76:79], v0 offset:13312
    v_permlane32_swap_b32 v12, v16
    v_permlane32_swap_b32 v13, v17
    v_permlane32_swap_b32 v14, v18
    v_permlane32_swap_b32 v15, v19
    v_pk_add_f32 v[12:13], v[12:13], v[16:17]
    v_pk_add_f32 v[14:15], v[14:15], v[18:19]
    v_permlane32_swap_b32 v20, v24
    v_cvt_pk_bf16_f32 v12, v12, v13
    v_cvt_pk_bf16_f32 v13, v14, v15
    v_permlane32_swap_b32 v21, v25
    ds_write_b64 v4, v[12:13]
    v_permlane32_swap_b32 v22, v26
    v_permlane32_swap_b32 v23, v27
    v_pk_add_f32 v[20:21], v[20:21], v[24:25]
    v_pk_add_f32 v[22:23], v[22:23], v[26:27]
    v_cvt_pk_bf16_f32 v20, v20, v21
    v_cvt_pk_bf16_f32 v21, v22, v23
    ds_write_b64 v10, v[20:21]
    v_smfmac_f32_16x16x64_bf16 v[28:31], v[60:63], v[80:87], v3
    ds_read_b128 v[80:83], v0 offset:10240
    ds_read_b128 v[84:87], v0 offset:14336
    v_subrev_u32 v56, 512, v0
    v_smfmac_f32_16x16x64_bf16 v[32:35], v[60:63], v[88:95], v3
    ds_read_b128 v[88:91], v0 offset:11264
    ds_read_b128 v[92:95], v0 offset:15360
    v_ashrrev_i32 v56, 31, v56
    s_not_b64 exec, s[100:101]
    buffer_store_dwordx2 v[20:21], v9, s[32:35], s24 offen sc1
    s_mov_b64 exec, -1
    v_smfmac_f32_16x16x64_bf16 v[28:31], v[36:39], a[96:103], v3
    v_and_b32 v56, 0xf149f2ca, v56
    v_mov_b32 v10, -1
    s_mov_b64 exec, s[98:99]
    buffer_store_dword v10, v8, s[32:35], s14 offen
    s_mov_b64 exec, -1
    v_smfmac_f32_16x16x64_bf16 v[32:35], v[36:39], a[104:111], v3
    v_mov_b32 v57, v56
    v_smfmac_f32_16x16x64_bf16 v[28:31], v[40:43], a[144:151], v3
    v_mov_b64 v[58:59], v[56:57]
    s_waitcnt lgkmcnt(4)
    s_barrier
    ds_read_b64_tr_b16 v[12:13], v1 offset:0
    ds_read_b64_tr_b16 v[14:15], v1 offset:512
    v_smfmac_f32_16x16x64_bf16 v[32:35], v[40:43], a[152:159], v3
    ds_read_b64_tr_b16 v[16:17], v1 offset:1024
    ds_read_b64_tr_b16 v[18:19], v1 offset:1536
    ds_read_b64_tr_b16 v[20:21], v1 offset:2048
    ds_read_b64_tr_b16 v[22:23], v1 offset:2560
    v_smfmac_f32_16x16x64_bf16 v[28:31], v[44:47], a[192:199], v3
    ds_read_b64_tr_b16 v[24:25], v1 offset:3072
    ds_read_b64_tr_b16 v[26:27], v1 offset:3584
    v_smfmac_f32_16x16x64_bf16 v[32:35], v[44:47], a[200:207], v3
    s_waitcnt lgkmcnt(6)
    v_mfma_f32_16x16x32_bf16 v[60:63], v[64:67], v[12:15], 0
    v_mfma_f32_16x16x32_bf16 v[36:39], v[68:71], v[12:15], 0
    s_waitcnt lgkmcnt(4)
    v_mfma_f32_16x16x32_bf16 v[60:63], v[72:75], v[16:19], v[60:63]
    v_permlane32_swap_b32 v28, v32
    v_mfma_f32_16x16x32_bf16 v[36:39], v[76:79], v[16:19], v[36:39]
    v_permlane32_swap_b32 v29, v33
    s_waitcnt lgkmcnt(2)
    v_mfma_f32_16x16x32_bf16 v[60:63], v[80:83], v[20:23], v[60:63]
    v_permlane32_swap_b32 v30, v34
    v_mfma_f32_16x16x32_bf16 v[36:39], v[84:87], v[20:23], v[36:39]
    v_permlane32_swap_b32 v31, v35
    s_waitcnt lgkmcnt(0)
    v_mfma_f32_16x16x32_bf16 v[60:63], v[88:91], v[24:27], v[60:63]
    v_pk_add_f32 v[28:29], v[28:29], v[32:33]
    v_pk_add_f32 v[30:31], v[30:31], v[34:35]
    v_mfma_f32_16x16x32_bf16 v[36:39], v[92:95], v[24:27], v[36:39]
    v_cvt_pk_bf16_f32 v28, v28, v29
    v_cvt_pk_bf16_f32 v29, v30, v31
    v_mfma_f32_16x16x32_bf16 v[56:59], v[12:15], v[12:15], v[56:59]
    v_mov_b32 v30, v28
    v_mov_b32 v31, v29
    v_mfma_f32_16x16x32_bf16 v[56:59], v[16:19], v[16:19], v[56:59]
    v_max3_f32 v9, v60, v61, v62
    v_max3_f32 v9, v9, v63, v36
    v_mfma_f32_16x16x32_bf16 v[56:59], v[20:23], v[20:23], v[56:59]
    v_permlane32_swap_b32 v28, v30
    v_mfma_f32_16x16x32_bf16 v[56:59], v[24:27], v[24:27], v[56:59]
    v_permlane32_swap_b32 v29, v31
    s_nop 1
    v_max3_f32 v9, v9, v37, v38
    v_max_f32 v9, v9, v39
    s_cmp_eq_u32 s11, 63
    s_cbranch_scc1 cB_done
    v_mov_b32 v64, 0x3f803f80
    v_mov_b32 v65, 0x3f803f80
    v_max3_f32 v9, v9, v56, v57
    v_max3_f32 v9, v9, v58, v59
    v_mov_b32 v10, v9
    v_mov_b32 v66, 0x3f803f80
    v_mov_b32 v67, 0x3f803f80
    v_permlane32_swap_b32 v9, v10
    v_max_f32 v9, v9, v10
    v_mov_b32 v10, v9
    v_mov_b32 v84, 0
    v_mov_b32 v85, 0
    v_permlane16_swap_b32 v9, v10
    v_max_f32 v9, v9, v10
    v_mul_f32 v10, s48, v9
    v_pk_fma_f32 v[60:61], v[60:61], s[48:49], v[10:11] op_sel_hi:[1,1,0] neg_lo:[0,0,1] neg_hi:[0,0,1]
    v_pk_fma_f32 v[62:63], v[62:63], s[48:49], v[10:11] op_sel_hi:[1,1,0] neg_lo:[0,0,1] neg_hi:[0,0,1]
    v_exp_f32 v60, v60
    v_exp_f32 v61, v61
    v_exp_f32 v62, v62
    v_exp_f32 v63, v63
    v_pk_fma_f32 v[36:37], v[36:37], s[48:49], v[10:11] op_sel_hi:[1,1,0] neg_lo:[0,0,1] neg_hi:[0,0,1]
    v_pk_fma_f32 v[38:39], v[38:39], s[48:49], v[10:11] op_sel_hi:[1,1,0] neg_lo:[0,0,1] neg_hi:[0,0,1]
    v_exp_f32 v36, v36
    v_exp_f32 v37, v37
    v_exp_f32 v38, v38
    v_exp_f32 v39, v39
    v_cvt_pk_bf16_f32 v40, v60, v61
    v_cvt_pk_bf16_f32 v41, v62, v63
    v_cvt_pk_bf16_f32 v42, v36, v37
    v_cvt_pk_bf16_f32 v43, v38, v39
    v_pk_fma_f32 v[56:57], v[56:57], s[48:49], v[10:11] op_sel_hi:[1,1,0] neg_lo:[0,0,1] neg_hi:[0,0,1]
    v_pk_fma_f32 v[58:59], v[58:59], s[48:49], v[10:11] op_sel_hi:[1,1,0] neg_lo:[0,0,1] neg_hi:[0,0,1]
    s_waitcnt vmcnt(2)
    v_mfma_f32_16x16x32_bf16 v[68:71], v[64:67], v[40:43], 0
    v_exp_f32 v56, v56
    v_mfma_f32_16x16x32_bf16 v[72:75], v[48:51], v[40:43], 0
    v_exp_f32 v57, v57
    v_mfma_f32_16x16x32_bf16 v[76:79], v[52:55], v[40:43], 0
    v_exp_f32 v58, v58
    v_exp_f32 v59, v59
    v_cvt_pk_bf16_f32 v44, v56, v57
    v_cvt_pk_bf16_f32 v45, v58, v59
    v_mov_b32 v86, 0
    v_mov_b32 v87, 0
    v_mfma_f32_16x16x16_bf16 v[68:71], v[64:65], v[44:45], v[68:71]
    v_mov_b32 v88, 0
    v_mov_b32 v89, 0
    v_mfma_f32_16x16x16_bf16 v[72:75], v[28:29], v[44:45], v[72:75]
    v_mov_b32 v90, 0
    v_mov_b32 v91, 0
    v_mfma_f32_16x16x16_bf16 v[76:79], v[30:31], v[44:45], v[76:79]
    v_mov_b32 v92, 0
    v_mov_b32 v93, 0
    v_rcp_f32 v10, v68
    v_mov_b32 v94, 0
    v_mov_b32 v95, 0
    s_mov_b64 exec, s[44:45]
    v_pk_mul_f32 v[72:73], v[72:73], v[10:11] op_sel_hi:[1,0]
    v_pk_mul_f32 v[74:75], v[74:75], v[10:11] op_sel_hi:[1,0]
    v_cvt_pk_bf16_f32 v80, v72, v73
    v_cvt_pk_bf16_f32 v81, v74, v75
    v_pk_mul_f32 v[76:77], v[76:77], v[10:11] op_sel_hi:[1,0]
    v_pk_mul_f32 v[78:79], v[78:79], v[10:11] op_sel_hi:[1,0]
    v_cvt_pk_bf16_f32 v82, v76, v77
    v_cvt_pk_bf16_f32 v83, v78, v79
    ds_write_b128 v5, v[80:83]
    s_mov_b64 exec, -1
    v_cndmask_b32 v28, v28, v30, s[46:47]
    v_cndmask_b32 v29, v29, v31, s[46:47]
    v_lshrrev_b32 v9, 1, v0
    s_mov_b64 exec, s[100:101]
    buffer_store_dwordx2 v[28:29], v9, s[32:35], s24 offen sc1
    s_mov_b64 exec, -1
    s_waitcnt lgkmcnt(0)
    s_barrier
    ds_read_b128 v[12:15], v6 offset:4096
    ds_read_b128 v[16:19], v6 offset:4608
    ds_read_b128 v[20:23], v6 offset:5120
    ds_read_b128 v[24:27], v6 offset:5632
    v_mov_b32 v10, 0xfffe0000
    s_waitcnt lgkmcnt(3)
    v_smfmac_f32_16x16x64_bf16 v[84:87], v[12:15], a[208:215], v3
    v_smfmac_f32_16x16x64_bf16 v[88:91], v[12:15], a[240:247], v3
    s_waitcnt lgkmcnt(2)
    v_smfmac_f32_16x16x64_bf16 v[84:87], v[16:19], a[216:223], v3
    v_smfmac_f32_16x16x64_bf16 v[88:91], v[16:19], a[248:255], v3
    s_waitcnt lgkmcnt(1)
    v_smfmac_f32_16x16x64_bf16 v[84:87], v[20:23], a[224:231], v3
    v_smfmac_f32_16x16x64_bf16 v[88:91], v[20:23], v[96:103], v3
    s_waitcnt lgkmcnt(0)
    v_smfmac_f32_16x16x64_bf16 v[84:87], v[24:27], a[232:239], v3
    v_smfmac_f32_16x16x64_bf16 v[88:91], v[24:27], v[104:111], v3
    s_nop 3
    v_add_u32 v84, s26, v84
    v_cvt_pk_bf16_f32 v81, v86, v87
    v_and_or_b32 v84, v84, v10, s27
    v_cvt_pk_bf16_f32 v80, v84, v85
    v_add_u32 v88, s26, v88
    v_cvt_pk_bf16_f32 v83, v90, v91
    v_and_or_b32 v88, v88, v10, s27
    v_cvt_pk_bf16_f32 v82, v88, v89
    buffer_store_dwordx4 v[80:83], v7, s[32:35], s21 offen
    s_lshr_b32 s95, s27, 16
    ds_read_b128 v[52:55], v0 offset:7168
    s_add_u32 s11, s11, 1
    s_mov_b32 s12, s13
    s_mov_b32 s13, s14
    s_add_u32 s14, s14, 0x4000
    s_bitset0_b32 s14, 16
    s_add_u32 s18, s12, s29
    s_xor_b32 s28, s18, 2048
    s_add_u32 s15, s18, 4096
    s_add_u32 s16, s16, 0x4000
    s_add_u32 s19, s19, 0x4000
    s_add_u32 s20, s19, 4096
    s_xor_b32 s26, s26, 0x10000
    s_xor_b32 s27, s27, 0x10000
    s_add_u32 s24, s24, 0x40000
    s_and_b32 s36, s11, 7
    s_cselect_b32 s36, 0, 0x2000
    s_xor_b32 s24, s24, s36
    s_add_u32 s23, s23, 0x40000
    s_cmp_eq_u32 s43, 0
    s_cbranch_scc1 cnr_9
    s_nop 15
    s_nop 3
    s_cmp_lt_u32 s3, 16
    s_cbranch_scc1 cgo_12
    s_nop 11
    s_cmp_lt_u32 s3, 32
    s_cbranch_scc1 cgo_12
    s_nop 11
cgo_12:
    buffer_load_dwordx4 v[36:39], v0, s[32:35], s22 offen offset:0 sc1
    buffer_load_dwordx4 v[40:43], v0, s[32:35], s22 offen offset:1024 sc1
    buffer_load_dwordx4 v[44:47], v0, s[32:35], s22 offen offset:2048 sc1
    buffer_load_dwordx4 v[48:51], v0, s[32:35], s22 offen offset:3072 sc1
    s_nop 15
    s_nop 15
    s_nop 3
    buffer_load_dwordx4 v[12:15], v0, s[32:35], s22 offen offset:0 sc1
    buffer_load_dwordx4 v[16:19], v0, s[32:35], s22 offen offset:1024 sc1
    buffer_load_dwordx4 v[20:23], v0, s[32:35], s22 offen offset:2048 sc1
    buffer_load_dwordx4 v[24:27], v0, s[32:35], s22 offen offset:3072 sc1
    s_waitcnt lgkmcnt(0)
crp_10:
    s_waitcnt vmcnt(7)
    v_mfma_f32_16x16x32_bf16 v[56:59], v[36:39], v[52:55], 0
    v_xor_b32 v9, s95, v36
    v_bitop3_b32 v9, v9, v38, s95 bitop3:0xf6
    s_waitcnt vmcnt(6)
    v_mfma_f32_16x16x32_bf16 v[56:59], v[40:43], v[52:55], v[56:59]
    v_bitop3_b32 v9, v9, v40, s95 bitop3:0xf6
    v_bitop3_b32 v9, v9, v42, s95 bitop3:0xf6
    s_waitcnt vmcnt(5)
    v_mfma_f32_16x16x32_bf16 v[56:59], v[44:47], v[52:55], v[56:59]
    v_bitop3_b32 v9, v9, v44, s95 bitop3:0xf6
    v_bitop3_b32 v9, v9, v46, s95 bitop3:0xf6
    s_waitcnt vmcnt(4)
    v_mfma_f32_16x16x32_bf16 v[56:59], v[48:51], v[52:55], v[56:59]
    v_bitop3_b32 v9, v9, v48, s95 bitop3:0xf6
    v_bitop3_b32 v9, v9, v50, s95 bitop3:0xf6
    v_and_b32 v9, 1, v9
    v_cmp_eq_u32 vcc, 1, v9
    s_nop 1
    s_cbranch_vccnz cf_13
    s_nop 0
    v_permlane32_swap_b32 v56, v58
    v_permlane32_swap_b32 v57, v59
    v_pk_add_f32 v[56:57], v[56:57], v[58:59]
    v_cvt_pk_bf16_f32 v56, v56, v57
    v_min_u32 v56, 0xfffffffe, v56
    s_mov_b64 exec, s[44:45]
    buffer_store_dword v56, v8, s[32:35], s16 offen sc1
    s_mov_b64 exec, -1
    buffer_store_dword v56, v8, s[32:35], s12 offen
    s_branch cfin_11
cf_13:
    buffer_load_dwordx4 v[36:39], v0, s[32:35], s22 offen offset:0 sc1
    buffer_load_dwordx4 v[40:43], v0, s[32:35], s22 offen offset:1024 sc1
    buffer_load_dwordx4 v[44:47], v0, s[32:35], s22 offen offset:2048 sc1
    buffer_load_dwordx4 v[48:51], v0, s[32:35], s22 offen offset:3072 sc1
    s_add_u32 s51, s51, 1
    s_waitcnt vmcnt(7)
    v_mfma_f32_16x16x32_bf16 v[56:59], v[12:15], v[52:55], 0
    v_xor_b32 v9, s95, v12
    v_bitop3_b32 v9, v9, v14, s95 bitop3:0xf6
    s_waitcnt vmcnt(6)
    v_mfma_f32_16x16x32_bf16 v[56:59], v[16:19], v[52:55], v[56:59]
    v_bitop3_b32 v9, v9, v16, s95 bitop3:0xf6
    v_bitop3_b32 v9, v9, v18, s95 bitop3:0xf6
    s_waitcnt vmcnt(5)
    v_mfma_f32_16x16x32_bf16 v[56:59], v[20:23], v[52:55], v[56:59]
    v_bitop3_b32 v9, v9, v20, s95 bitop3:0xf6
    v_bitop3_b32 v9, v9, v22, s95 bitop3:0xf6
    s_waitcnt vmcnt(4)
    v_mfma_f32_16x16x32_bf16 v[56:59], v[24:27], v[52:55], v[56:59]
    v_bitop3_b32 v9, v9, v24, s95 bitop3:0xf6
    v_bitop3_b32 v9, v9, v26, s95 bitop3:0xf6
    v_and_b32 v9, 1, v9
    v_cmp_eq_u32 vcc, 1, v9
    s_nop 1
    s_cbranch_vccnz cf_14
    s_nop 0
    v_permlane32_swap_b32 v56, v58
    v_permlane32_swap_b32 v57, v59
    v_pk_add_f32 v[56:57], v[56:57], v[58:59]
    v_cvt_pk_bf16_f32 v56, v56, v57
    v_min_u32 v56, 0xfffffffe, v56
    s_mov_b64 exec, s[44:45]
    buffer_store_dword v56, v8, s[32:35], s16 offen sc1
    s_mov_b64 exec, -1
    buffer_store_dword v56, v8, s[32:35], s12 offen
    s_branch cfin_11
cf_14:
    buffer_load_dwordx4 v[12:15], v0, s[32:35], s22 offen offset:0 sc1
    buffer_load_dwordx4 v[16:19], v0, s[32:35], s22 offen offset:1024 sc1
    buffer_load_dwordx4 v[20:23], v0, s[32:35], s22 offen offset:2048 sc1
    buffer_load_dwordx4 v[24:27], v0, s[32:35], s22 offen offset:3072 sc1
    s_add_u32 s51, s51, 1
    s_sub_u32 s88, s88, 1
    s_cbranch_scc1 k_end
    s_branch crp_10
cfin_11:
    s_mov_b64 exec, -1
cnr_9:
    s_branch cB_top
cB_slowL0:
    s_sub_u32 s88, s88, 1
    s_cbranch_scc1 k_end
    s_add_u32 s50, s50, 1
    buffer_load_dwordx4 v[36:39], v11, s[32:35], s18 offen offset:0 sc1
    s_nop 9
    buffer_load_dwordx4 v[40:43], v11, s[32:35], s28 offen offset:0 sc1
    s_nop 9
    buffer_load_dwordx4 v[44:47], v11, s[32:35], s18 offen offset:128 sc1
    s_nop 9
    buffer_load_dwordx4 v[48:51], v11, s[32:35], s28 offen offset:128 sc1
    s_nop 9
    buffer_load_dwordx4 v[52:55], v11, s[32:35], s15 offen offset:0 sc1
    s_waitcnt vmcnt(4)
    v_max3_u32 v9, v36, v37, v38
    v_max_u32 v9, v9, v39
    v_cmp_eq_u32 vcc, -1, v9
    s_cbranch_vccnz cB_slowL0
    s_branch cB_backL0
cB_slowL1:
    s_sub_u32 s88, s88, 1
    s_cbranch_scc1 k_end
    s_add_u32 s50, s50, 1
    buffer_load_dwordx4 v[40:43], v11, s[32:35], s28 offen offset:0 sc1
    buffer_load_dwordx4 v[44:47], v11, s[32:35], s18 offen offset:128 sc1
    buffer_load_dwordx4 v[48:51], v11, s[32:35], s28 offen offset:128 sc1
    buffer_load_dwordx4 v[52:55], v11, s[32:35], s15 offen offset:0 sc1
    s_waitcnt vmcnt(0)
    v_max3_u32 v9, v40, v41, v42
    v_max_u32 v9, v9, v43
    v_cmp_eq_u32 vcc, -1, v9
    s_cbranch_vccnz cB_slowL1
    s_branch cB_backL1
cB_slowL2:
    s_sub_u32 s88, s88, 1
    s_cbranch_scc1 k_end
    s_add_u32 s50, s50, 1
    buffer_load_dwordx4 v[44:47], v11, s[32:35], s18 offen offset:128 sc1
    buffer_load_dwordx4 v[48:51], v11, s[32:35], s28 offen offset:128 sc1
    buffer_load_dwordx4 v[52:55], v11, s[32:35], s15 offen offset:0 sc1
    s_waitcnt vmcnt(0)
    v_max3_u32 v9, v44, v45, v46
    v_max_u32 v9, v9, v47
    v_cmp_eq_u32 vcc, -1, v9
    s_cbranch_vccnz cB_slowL2
    s_branch cB_backL2
cB_slowL3:
    s_sub_u32 s88, s88, 1
    s_cbranch_scc1 k_end
    s_add_u32 s50, s50, 1
    buffer_load_dwordx4 v[48:51], v11, s[32:35], s28 offen offset:128 sc1
    buffer_load_dwordx4 v[52:55], v11, s[32:35], s15 offen offset:0 sc1
    s_waitcnt vmcnt(0)
    v_max3_u32 v9, v48, v49, v50
    v_max_u32 v9, v9, v51
    v_cmp_eq_u32 vcc, -1, v9
    s_cbranch_vccnz cB_slowL3
    s_branch cB_backL3
cB_slowL4:
    s_sub_u32 s88, s88, 1
    s_cbranch_scc1 k_end
    s_add_u32 s50, s50, 1
    buffer_load_dwordx4 v[52:55], v11, s[32:35], s15 offen offset:0 sc1
    s_waitcnt vmcnt(0)
    v_max3_u32 v9, v52, v53, v54
    v_max_u32 v9, v9, v55
    v_cmp_eq_u32 vcc, -1, v9
    s_cbranch_vccnz cB_slowL4
    s_branch cB_backL4
cB_slowR0:
    s_sub_u32 s88, s88, 1
    s_cbranch_scc1 k_end
    s_add_u32 s50, s50, 65536
    buffer_load_dwordx4 v[56:59], v11, s[32:35], s19 offen offset:0 sc1
    s_nop 9
    buffer_load_dwordx4 v[60:63], v11, s[32:35], s19 offen offset:2048 sc1
    s_nop 9
    buffer_load_dwordx4 v[36:39], v11, s[32:35], s19 offen offset:128 sc1
    s_nop 9
    buffer_load_dwordx4 v[40:43], v11, s[32:35], s19 offen offset:2176 sc1
    s_nop 9
    buffer_load_dwordx4 v[44:47], v11, s[32:35], s20 offen offset:0 sc1
    s_waitcnt vmcnt(4)
    v_max3_u32 v9, v56, v57, v58
    v_max_u32 v9, v9, v59
    v_cmp_eq_u32 vcc, -1, v9
    s_cbranch_vccnz cB_slowR0
    s_branch cB_backR0
cB_slowR1:
    s_sub_u32 s88, s88, 1
    s_cbranch_scc1 k_end
    s_add_u32 s50, s50, 65536
    buffer_load_dwordx4 v[60:63], v11, s[32:35], s19 offen offset:2048 sc1
    buffer_load_dwordx4 v[36:39], v11, s[32:35], s19 offen offset:128 sc1
    buffer_load_dwordx4 v[40:43], v11, s[32:35], s19 offen offset:2176 sc1
    buffer_load_dwordx4 v[44:47], v11, s[32:35], s20 offen offset:0 sc1
    s_waitcnt vmcnt(0)
    v_max3_u32 v9, v60, v61, v62
    v_max_u32 v9, v9, v63
    v_cmp_eq_u32 vcc, -1, v9
    s_cbranch_vccnz cB_slowR1
    s_branch cB_backR1
cB_slowR2:
    s_sub_u32 s88, s88, 1
    s_cbranch_scc1 k_end
    s_add_u32 s50, s50, 65536
    buffer_load_dwordx4 v[36:39], v11, s[32:35], s19 offen offset:128 sc1
    buffer_load_dwordx4 v[40:43], v11, s[32:35], s19 offen offset:2176 sc1
    buffer_load_dwordx4 v[44:47], v11, s[32:35], s20 offen offset:0 sc1
    s_waitcnt vmcnt(0)
    v_max3_u32 v9, v36, v37, v38
    v_max_u32 v9, v9, v39
    v_cmp_eq_u32 vcc, -1, v9
    s_cbranch_vccnz cB_slowR2
    s_branch cB_backR2
cB_slowR3:
    s_sub_u32 s88, s88, 1
    s_cbranch_scc1 k_end
    s_add_u32 s50, s50, 65536
    buffer_load_dwordx4 v[40:43], v11, s[32:35], s19 offen offset:2176 sc1
    buffer_load_dwordx4 v[44:47], v11, s[32:35], s20 offen offset:0 sc1
    s_waitcnt vmcnt(0)
    v_max3_u32 v9, v40, v41, v42
    v_max_u32 v9, v9, v43
    v_cmp_eq_u32 vcc, -1, v9
    s_cbranch_vccnz cB_slowR3
    s_branch cB_backR3
cB_slowR4:
    s_sub_u32 s88, s88, 1
    s_cbranch_scc1 k_end
    s_add_u32 s50, s50, 65536
    buffer_load_dwordx4 v[44:47], v11, s[32:35], s20 offen offset:0 sc1
    s_waitcnt vmcnt(0)
    v_max3_u32 v9, v44, v45, v46
    v_max_u32 v9, v9, v47
    v_cmp_eq_u32 vcc, -1, v9
    s_cbranch_vccnz cB_slowR4
    s_branch cB_backR4
cB_done:
    s_mov_b64 exec, -1
    v_cndmask_b32 v28, v28, v30, s[46:47]
    v_cndmask_b32 v29, v29, v31, s[46:47]
    v_lshrrev_b32 v9, 1, v0
    s_mov_b64 exec, s[100:101]
    buffer_store_dwordx2 v[28:29], v9, s[32:35], s24 offen sc1
    s_mov_b64 exec, -1
    s_waitcnt vmcnt(0)
    s_barrier
    s_branch chain_exit
chain_exit:
    s_branch k_end
k_bulk:
    s_sub_u32 s10, s8, 2
    s_lshl_b32 s10, s10, 5
    s_add_u32 s10, s10, s9
    v_lshrrev_b32 v8, 6, v0
    s_mov_b32 s16, s4
    v_readfirstlane_b32 s11, v8
    s_mov_b32 s17, s5
    s_mov_b32 s18, 0x10000000
    s_mov_b32 s19, 0x20000
    s_mov_b32 s88, 1048576
    v_and_b32 v0, 63, v0
    v_lshlrev_b32 v1, 4, v0
    v_and_b32 v2, 15, v0
    v_lshrrev_b32 v3, 4, v0
    v_mov_b32 v12, 0
    s_cmp_eq_u32 s11, 0
    s_cselect_b32 s14, 1, 0
    s_mov_b32 s15, 0
    s_cmp_eq_u32 s10, 0
    s_cbranch_scc0 b_noinit
    s_cmp_eq_u32 s11, 0
    s_cbranch_scc0 b_noinit
    v_mov_b32 v14, 0
    v_mov_b32 v15, 0
    v_mov_b32 v16, 0
    v_mov_b32 v17, 0
    s_mov_b32 s28, 69730304
    buffer_store_dwordx4 v[14:17], v1, s[16:19], s28 offen offset:0 sc1
    buffer_store_dwordx4 v[14:17], v1, s[16:19], s28 offen offset:1024 sc1
    buffer_store_dwordx4 v[14:17], v1, s[16:19], s28 offen offset:2048 sc1
    s_waitcnt vmcnt(0)
    v_mov_b32 v8, 1
    v_mov_b32 v9, 40
    s_mov_b64 exec, 1
    global_store_dword v9, v8, s[6:7] sc1
    s_mov_b64 exec, -1
    v_mov_b32 v14, 67116032
    v_lshl_add_u32 v14, v0, 13, v14
    s_mov_b64 exec, 0xffff
    global_store_dword v14, v0, s[4:5] sc1
    s_waitcnt vmcnt(0)
    s_mov_b64 exec, 1
    s_mov_b32 s70, -1
    s_mov_b32 s71, -1
    v_mov_b32 v15, 67116032
    s_memtime s[64:65]
    s_waitcnt lgkmcnt(0)
    global_load_dword v16, v15, s[4:5] sc1
    s_waitcnt vmcnt(0)
    s_memtime s[66:67]
    v_add_u32 v15, 8192, v15
    s_waitcnt lgkmcnt(0)
    s_sub_u32 s68, s66, s64
    s_min_u32 s70, s70, s68
    s_memtime s[64:65]
    s_waitcnt lgkmcnt(0)
    global_load_dword v16, v15, s[4:5] sc1
    s_waitcnt vmcnt(0)
    s_memtime s[66:67]
    v_add_u32 v15, 8192, v15
    s_waitcnt lgkmcnt(0)
    s_sub_u32 s68, s66, s64
    s_min_u32 s71, s71, s68
    s_memtime s[64:65]
    s_waitcnt lgkmcnt(0)
    global_load_dword v16, v15, s[4:5] sc1
    s_waitcnt vmcnt(0)
    s_memtime s[66:67]
    v_add_u32 v15, 8192, v15
    s_waitcnt lgkmcnt(0)
    s_sub_u32 s68, s66, s64
    s_min_u32 s70, s70, s68
    s_memtime s[64:65]
    s_waitcnt lgkmcnt(0)
    global_load_dword v16, v15, s[4:5] sc1
    s_waitcnt vmcnt(0)
    s_memtime s[66:67]
    v_add_u32 v15, 8192, v15
    s_waitcnt lgkmcnt(0)
    s_sub_u32 s68, s66, s64
    s_min_u32 s71, s71, s68
    s_memtime s[64:65]
    s_waitcnt lgkmcnt(0)
    global_load_dword v16, v15, s[4:5] sc1
    s_waitcnt vmcnt(0)
    s_memtime s[66:67]
    v_add_u32 v15, 8192, v15
    s_waitcnt lgkmcnt(0)
    s_sub_u32 s68, s66, s64
    s_min_u32 s70, s70, s68
    s_memtime s[64:65]
    s_waitcnt lgkmcnt(0)
    global_load_dword v16, v15, s[4:5] sc1
    s_waitcnt vmcnt(0)
    s_memtime s[66:67]
    v_add_u32 v15, 8192, v15
    s_waitcnt lgkmcnt(0)
    s_sub_u32 s68, s66, s64
    s_min_u32 s71, s71, s68
    s_memtime s[64:65]
    s_waitcnt lgkmcnt(0)
    global_load_dword v16, v15, s[4:5] sc1
    s_waitcnt vmcnt(0)
    s_memtime s[66:67]
    v_add_u32 v15, 8192, v15
    s_waitcnt lgkmcnt(0)
    s_sub_u32 s68, s66, s64
    s_min_u32 s70, s70, s68
    s_memtime s[64:65]
    s_waitcnt lgkmcnt(0)
    global_load_dword v16, v15, s[4:5] sc1
    s_waitcnt vmcnt(0)
    s_memtime s[66:67]
    v_add_u32 v15, 8192, v15
    s_waitcnt lgkmcnt(0)
    s_sub_u32 s68, s66, s64
    s_min_u32 s71, s71, s68
    s_memtime s[64:65]
    s_waitcnt lgkmcnt(0)
    global_load_dword v16, v15, s[4:5] sc1
    s_waitcnt vmcnt(0)
    s_memtime s[66:67]
    v_add_u32 v15, 8192, v15
    s_waitcnt lgkmcnt(0)
    s_sub_u32 s68, s66, s64
    s_min_u32 s70, s70, s68
    s_memtime s[64:65]
    s_waitcnt lgkmcnt(0)
    global_load_dword v16, v15, s[4:5] sc1
    s_waitcnt vmcnt(0)
    s_memtime s[66:67]
    v_add_u32 v15, 8192, v15
    s_waitcnt lgkmcnt(0)
    s_sub_u32 s68, s66, s64
    s_min_u32 s71, s71, s68
    s_memtime s[64:65]
    s_waitcnt lgkmcnt(0)
    global_load_dword v16, v15, s[4:5] sc1
    s_waitcnt vmcnt(0)
    s_memtime s[66:67]
    v_add_u32 v15, 8192, v15
    s_waitcnt lgkmcnt(0)
    s_sub_u32 s68, s66, s64
    s_min_u32 s70, s70, s68
    s_memtime s[64:65]
    s_waitcnt lgkmcnt(0)
    global_load_dword v16, v15, s[4:5] sc1
    s_waitcnt vmcnt(0)
    s_memtime s[66:67]
    v_add_u32 v15, 8192, v15
    s_waitcnt lgkmcnt(0)
    s_sub_u32 s68, s66, s64
    s_min_u32 s71, s71, s68
    s_memtime s[64:65]
    s_waitcnt lgkmcnt(0)
    global_load_dword v16, v15, s[4:5] sc1
    s_waitcnt vmcnt(0)
    s_memtime s[66:67]
    v_add_u32 v15, 8192, v15
    s_waitcnt lgkmcnt(0)
    s_sub_u32 s68, s66, s64
    s_min_u32 s70, s70, s68
    s_memtime s[64:65]
    s_waitcnt lgkmcnt(0)
    global_load_dword v16, v15, s[4:5] sc1
    s_waitcnt vmcnt(0)
    s_memtime s[66:67]
    v_add_u32 v15, 8192, v15
    s_waitcnt lgkmcnt(0)
    s_sub_u32 s68, s66, s64
    s_min_u32 s71, s71, s68
    s_memtime s[64:65]
    s_waitcnt lgkmcnt(0)
    global_load_dword v16, v15, s[4:5] sc1
    s_waitcnt vmcnt(0)
    s_memtime s[66:67]
    v_add_u32 v15, 8192, v15
    s_waitcnt lgkmcnt(0)
    s_sub_u32 s68, s66, s64
    s_min_u32 s70, s70, s68
    s_memtime s[64:65]
    s_waitcnt lgkmcnt(0)
    global_load_dword v16, v15, s[4:5] sc1
    s_waitcnt vmcnt(0)
    s_memtime s[66:67]
    v_add_u32 v15, 8192, v15
    s_waitcnt lgkmcnt(0)
    s_sub_u32 s68, s66, s64
    s_min_u32 s71, s71, s68
    s_cmp_lt_u32 s71, s70
    s_cselect_b32 s68, 3, 1
    v_mov_b32 v15, 36
    v_mov_b32 v16, s68
    global_store_dword v15, v16, s[6:7] sc1
    s_waitcnt vmcnt(0)
    s_mov_b64 exec, -1
b_noinit:
    s_cmp_lt_u32 s10, 128
    s_cbranch_scc1 b_t1
    s_load_dwordx2 s[24:25], s[0:1], 0
    s_waitcnt lgkmcnt(0)
    s_mov_b32 s26, 2621440
    s_mov_b32 s27, 0x20000
    s_sub_u32 s28, s10, 128
    s_lshl_b32 s39, s28, 2
    s_add_u32 s39, s39, 69730304
    s_lshl_b32 s28, s28, 2
    s_add_u32 s28, s28, s11
    s_mul_i32 s34, s28, 10240
    s_add_u32 s36, s34, 71303168
    v_lshlrev_b32 v4, 2, v0
    buffer_load_dword v14, v4, s[24:27], s34 offen offset:0
    buffer_load_dword v15, v4, s[24:27], s34 offen offset:256
    buffer_load_dword v16, v4, s[24:27], s34 offen offset:512
    buffer_load_dword v17, v4, s[24:27], s34 offen offset:768
    buffer_load_dword v18, v4, s[24:27], s34 offen offset:1024
    s_add_u32 s34, s34, 1280
    buffer_load_dword v19, v4, s[24:27], s34 offen offset:0
    buffer_load_dword v20, v4, s[24:27], s34 offen offset:256
    buffer_load_dword v21, v4, s[24:27], s34 offen offset:512
    buffer_load_dword v22, v4, s[24:27], s34 offen offset:768
    buffer_load_dword v23, v4, s[24:27], s34 offen offset:1024
    s_add_u32 s34, s34, 1280
    buffer_load_dword v24, v4, s[24:27], s34 offen offset:0
    buffer_load_dword v25, v4, s[24:27], s34 offen offset:256
    buffer_load_dword v26, v4, s[24:27], s34 offen offset:512
    buffer_load_dword v27, v4, s[24:27], s34 offen offset:768
    buffer_load_dword v28, v4, s[24:27], s34 offen offset:1024
    s_add_u32 s34, s34, 1280
    buffer_load_dword v29, v4, s[24:27], s34 offen offset:0
    buffer_load_dword v30, v4, s[24:27], s34 offen offset:256
    buffer_load_dword v31, v4, s[24:27], s34 offen offset:512
    buffer_load_dword v32, v4, s[24:27], s34 offen offset:768
    buffer_load_dword v33, v4, s[24:27], s34 offen offset:1024
    s_add_u32 s34, s34, 1280
    buffer_load_dword v34, v4, s[24:27], s34 offen offset:0
    buffer_load_dword v35, v4, s[24:27], s34 offen offset:256
    buffer_load_dword v36, v4, s[24:27], s34 offen offset:512
    buffer_load_dword v37, v4, s[24:27], s34 offen offset:768
    buffer_load_dword v38, v4, s[24:27], s34 offen offset:1024
    s_add_u32 s34, s34, 1280
    buffer_load_dword v39, v4, s[24:27], s34 offen offset:0
    buffer_load_dword v40, v4, s[24:27], s34 offen offset:256
    buffer_load_dword v41, v4, s[24:27], s34 offen offset:512
    buffer_load_dword v42, v4, s[24:27], s34 offen offset:768
    buffer_load_dword v43, v4, s[24:27], s34 offen offset:1024
    s_add_u32 s34, s34, 1280
    buffer_load_dword v44, v4, s[24:27], s34 offen offset:0
    buffer_load_dword v45, v4, s[24:27], s34 offen offset:256
    buffer_load_dword v46, v4, s[24:27], s34 offen offset:512
    buffer_load_dword v47, v4, s[24:27], s34 offen offset:768
    buffer_load_dword v48, v4, s[24:27], s34 offen offset:1024
    s_add_u32 s34, s34, 1280
    buffer_load_dword v49, v4, s[24:27], s34 offen offset:0
    buffer_load_dword v50, v4, s[24:27], s34 offen offset:256
    buffer_load_dword v51, v4, s[24:27], s34 offen offset:512
    buffer_load_dword v52, v4, s[24:27], s34 offen offset:768
    buffer_load_dword v53, v4, s[24:27], s34 offen offset:1024
    s_add_u32 s34, s34, 1280
    s_mov_b32 s46, 0x3acccccd
    v_mov_b32 v10, 0x3727c5ac
    s_waitcnt vmcnt(0)
    v_and_b32 v55, 0xffff0000, v14
    v_lshlrev_b32 v54, 16, v14
    v_and_b32 v57, 0xffff0000, v15
    v_lshlrev_b32 v56, 16, v15
    v_and_b32 v59, 0xffff0000, v16
    v_lshlrev_b32 v58, 16, v16
    v_and_b32 v61, 0xffff0000, v17
    v_lshlrev_b32 v60, 16, v17
    v_and_b32 v63, 0xffff0000, v18
    v_lshlrev_b32 v62, 16, v18
    v_and_b32 v65, 0xffff0000, v19
    v_lshlrev_b32 v64, 16, v19
    v_and_b32 v67, 0xffff0000, v20
    v_lshlrev_b32 v66, 16, v20
    v_and_b32 v69, 0xffff0000, v21
    v_lshlrev_b32 v68, 16, v21
    v_and_b32 v71, 0xffff0000, v22
    v_lshlrev_b32 v70, 16, v22
    v_and_b32 v73, 0xffff0000, v23
    v_lshlrev_b32 v72, 16, v23
    v_and_b32 v75, 0xffff0000, v24
    v_lshlrev_b32 v74, 16, v24
    v_and_b32 v77, 0xffff0000, v25
    v_lshlrev_b32 v76, 16, v25
    v_and_b32 v79, 0xffff0000, v26
    v_lshlrev_b32 v78, 16, v26
    v_and_b32 v81, 0xffff0000, v27
    v_lshlrev_b32 v80, 16, v27
    v_and_b32 v83, 0xffff0000, v28
    v_lshlrev_b32 v82, 16, v28
    v_and_b32 v85, 0xffff0000, v29
    v_lshlrev_b32 v84, 16, v29
    v_and_b32 v87, 0xffff0000, v30
    v_lshlrev_b32 v86, 16, v30
    v_and_b32 v89, 0xffff0000, v31
    v_lshlrev_b32 v88, 16, v31
    v_and_b32 v91, 0xffff0000, v32
    v_lshlrev_b32 v90, 16, v32
    v_and_b32 v93, 0xffff0000, v33
    v_lshlrev_b32 v92, 16, v33
    v_and_b32 v95, 0xffff0000, v34
    v_lshlrev_b32 v94, 16, v34
    v_and_b32 v97, 0xffff0000, v35
    v_lshlrev_b32 v96, 16, v35
    v_and_b32 v99, 0xffff0000, v36
    v_lshlrev_b32 v98, 16, v36
    v_and_b32 v101, 0xffff0000, v37
    v_lshlrev_b32 v100, 16, v37
    v_and_b32 v103, 0xffff0000, v38
    v_lshlrev_b32 v102, 16, v38
    v_and_b32 v105, 0xffff0000, v39
    v_lshlrev_b32 v104, 16, v39
    v_and_b32 v107, 0xffff0000, v40
    v_lshlrev_b32 v106, 16, v40
    v_and_b32 v109, 0xffff0000, v41
    v_lshlrev_b32 v108, 16, v41
    v_and_b32 v111, 0xffff0000, v42
    v_lshlrev_b32 v110, 16, v42
    v_and_b32 v113, 0xffff0000, v43
    v_lshlrev_b32 v112, 16, v43
    v_and_b32 v115, 0xffff0000, v44
    v_lshlrev_b32 v114, 16, v44
    v_and_b32 v117, 0xffff0000, v45
    v_lshlrev_b32 v116, 16, v45
    v_and_b32 v119, 0xffff0000, v46
    v_lshlrev_b32 v118, 16, v46
    v_and_b32 v121, 0xffff0000, v47
    v_lshlrev_b32 v120, 16, v47
    v_and_b32 v123, 0xffff0000, v48
    v_lshlrev_b32 v122, 16, v48
    v_and_b32 v125, 0xffff0000, v49
    v_lshlrev_b32 v124, 16, v49
    v_and_b32 v127, 0xffff0000, v50
    v_lshlrev_b32 v126, 16, v50
    v_and_b32 v129, 0xffff0000, v51
    v_lshlrev_b32 v128, 16, v51
    v_and_b32 v131, 0xffff0000, v52
    v_lshlrev_b32 v130, 16, v52
    v_and_b32 v133, 0xffff0000, v53
    v_lshlrev_b32 v132, 16, v53
    v_add_f32 v134, v54, v55
    v_add_f32 v134, v134, v56
    v_add_f32 v134, v134, v57
    v_add_f32 v134, v134, v58
    v_add_f32 v134, v134, v59
    v_add_f32 v134, v134, v60
    v_add_f32 v134, v134, v61
    v_add_f32 v134, v134, v62
    v_add_f32 v134, v134, v63
    v_add_f32 v135, v64, v65
    v_add_f32 v135, v135, v66
    v_add_f32 v135, v135, v67
    v_add_f32 v135, v135, v68
    v_add_f32 v135, v135, v69
    v_add_f32 v135, v135, v70
    v_add_f32 v135, v135, v71
    v_add_f32 v135, v135, v72
    v_add_f32 v135, v135, v73
    v_add_f32 v136, v74, v75
    v_add_f32 v136, v136, v76
    v_add_f32 v136, v136, v77
    v_add_f32 v136, v136, v78
    v_add_f32 v136, v136, v79
    v_add_f32 v136, v136, v80
    v_add_f32 v136, v136, v81
    v_add_f32 v136, v136, v82
    v_add_f32 v136, v136, v83
    v_add_f32 v137, v84, v85
    v_add_f32 v137, v137, v86
    v_add_f32 v137, v137, v87
    v_add_f32 v137, v137, v88
    v_add_f32 v137, v137, v89
    v_add_f32 v137, v137, v90
    v_add_f32 v137, v137, v91
    v_add_f32 v137, v137, v92
    v_add_f32 v137, v137, v93
    v_add_f32 v138, v94, v95
    v_add_f32 v138, v138, v96
    v_add_f32 v138, v138, v97
    v_add_f32 v138, v138, v98
    v_add_f32 v138, v138, v99
    v_add_f32 v138, v138, v100
    v_add_f32 v138, v138, v101
    v_add_f32 v138, v138, v102
    v_add_f32 v138, v138, v103
    v_add_f32 v139, v104, v105
    v_add_f32 v139, v139, v106
    v_add_f32 v139, v139, v107
    v_add_f32 v139, v139, v108
    v_add_f32 v139, v139, v109
    v_add_f32 v139, v139, v110
    v_add_f32 v139, v139, v111
    v_add_f32 v139, v139, v112
    v_add_f32 v139, v139, v113
    v_add_f32 v140, v114, v115
    v_add_f32 v140, v140, v116
    v_add_f32 v140, v140, v117
    v_add_f32 v140, v140, v118
    v_add_f32 v140, v140, v119
    v_add_f32 v140, v140, v120
    v_add_f32 v140, v140, v121
    v_add_f32 v140, v140, v122
    v_add_f32 v140, v140, v123
    v_add_f32 v141, v124, v125
    v_add_f32 v141, v141, v126
    v_add_f32 v141, v141, v127
    v_add_f32 v141, v141, v128
    v_add_f32 v141, v141, v129
    v_add_f32 v141, v141, v130
    v_add_f32 v141, v141, v131
    v_add_f32 v141, v141, v132
    v_add_f32 v141, v141, v133
    v_add_f32_dpp v134, v134, v134 quad_perm:[1,0,3,2] row_mask:0xf bank_mask:0xf
    v_add_f32_dpp v135, v135, v135 quad_perm:[1,0,3,2] row_mask:0xf bank_mask:0xf
    v_add_f32_dpp v136, v136, v136 quad_perm:[1,0,3,2] row_mask:0xf bank_mask:0xf
    v_add_f32_dpp v137, v137, v137 quad_perm:[1,0,3,2] row_mask:0xf bank_mask:0xf
    v_add_f32_dpp v138, v138, v138 quad_perm:[1,0,3,2] row_mask:0xf bank_mask:0xf
    v_add_f32_dpp v139, v139, v139 quad_perm:[1,0,3,2] row_mask:0xf bank_mask:0xf
    v_add_f32_dpp v140, v140, v140 quad_perm:[1,0,3,2] row_mask:0xf bank_mask:0xf
    v_add_f32_dpp v141, v141, v141 quad_perm:[1,0,3,2] row_mask:0xf bank_mask:0xf
    v_add_f32_dpp v134, v134, v134 quad_perm:[2,3,0,1] row_mask:0xf bank_mask:0xf
    v_add_f32_dpp v135, v135, v135 quad_perm:[2,3,0,1] row_mask:0xf bank_mask:0xf
    v_add_f32_dpp v136, v136, v136 quad_perm:[2,3,0,1] row_mask:0xf bank_mask:0xf
    v_add_f32_dpp v137, v137, v137 quad_perm:[2,3,0,1] row_mask:0xf bank_mask:0xf
    v_add_f32_dpp v138, v138, v138 quad_perm:[2,3,0,1] row_mask:0xf bank_mask:0xf
    v_add_f32_dpp v139, v139, v139 quad_perm:[2,3,0,1] row_mask:0xf bank_mask:0xf
    v_add_f32_dpp v140, v140, v140 quad_perm:[2,3,0,1] row_mask:0xf bank_mask:0xf
    v_add_f32_dpp v141, v141, v141 quad_perm:[2,3,0,1] row_mask:0xf bank_mask:0xf
    v_add_f32_dpp v134, v134, v134 row_half_mirror row_mask:0xf bank_mask:0xf
    v_add_f32_dpp v135, v135, v135 row_half_mirror row_mask:0xf bank_mask:0xf
    v_add_f32_dpp v136, v136, v136 row_half_mirror row_mask:0xf bank_mask:0xf
    v_add_f32_dpp v137, v137, v137 row_half_mirror row_mask:0xf bank_mask:0xf
    v_add_f32_dpp v138, v138, v138 row_half_mirror row_mask:0xf bank_mask:0xf
    v_add_f32_dpp v139, v139, v139 row_half_mirror row_mask:0xf bank_mask:0xf
    v_add_f32_dpp v140, v140, v140 row_half_mirror row_mask:0xf bank_mask:0xf
    v_add_f32_dpp v141, v141, v141 row_half_mirror row_mask:0xf bank_mask:0xf
    v_add_f32_dpp v134, v134, v134 row_mirror row_mask:0xf bank_mask:0xf
    v_add_f32_dpp v135, v135, v135 row_mirror row_mask:0xf bank_mask:0xf
    v_add_f32_dpp v136, v136, v136 row_mirror row_mask:0xf bank_mask:0xf
    v_add_f32_dpp v137, v137, v137 row_mirror row_mask:0xf bank_mask:0xf
    v_add_f32_dpp v138, v138, v138 row_mirror row_mask:0xf bank_mask:0xf
    v_add_f32_dpp v139, v139, v139 row_mirror row_mask:0xf bank_mask:0xf
    v_add_f32_dpp v140, v140, v140 row_mirror row_mask:0xf bank_mask:0xf
    v_add_f32_dpp v141, v141, v141 row_mirror row_mask:0xf bank_mask:0xf
    v_mov_b32 v150, v134
    v_mov_b32 v151, v135
    v_mov_b32 v152, v136
    v_mov_b32 v153, v137
    v_mov_b32 v154, v138
    v_mov_b32 v155, v139
    v_mov_b32 v156, v140
    v_mov_b32 v157, v141
    s_nop 1
    v_permlane16_swap_b32 v134, v150
    v_permlane16_swap_b32 v135, v151
    v_permlane16_swap_b32 v136, v152
    v_permlane16_swap_b32 v137, v153
    v_permlane16_swap_b32 v138, v154
    v_permlane16_swap_b32 v139, v155
    v_permlane16_swap_b32 v140, v156
    v_permlane16_swap_b32 v141, v157
    v_add_f32 v134, v134, v150
    v_add_f32 v135, v135, v151
    v_add_f32 v136, v136, v152
    v_add_f32 v137, v137, v153
    v_add_f32 v138, v138, v154
    v_add_f32 v139, v139, v155
    v_add_f32 v140, v140, v156
    v_add_f32 v141, v141, v157
    v_mov_b32 v150, v134
    v_mov_b32 v151, v135
    v_mov_b32 v152, v136
    v_mov_b32 v153, v137
    v_mov_b32 v154, v138
    v_mov_b32 v155, v139
    v_mov_b32 v156, v140
    v_mov_b32 v157, v141
    s_nop 1
    v_permlane32_swap_b32 v134, v150
    v_permlane32_swap_b32 v135, v151
    v_permlane32_swap_b32 v136, v152
    v_permlane32_swap_b32 v137, v153
    v_permlane32_swap_b32 v138, v154
    v_permlane32_swap_b32 v139, v155
    v_permlane32_swap_b32 v140, v156
    v_permlane32_swap_b32 v141, v157
    v_add_f32 v134, v134, v150
    v_add_f32 v135, v135, v151
    v_add_f32 v136, v136, v152
    v_add_f32 v137, v137, v153
    v_add_f32 v138, v138, v154
    v_add_f32 v139, v139, v155
    v_add_f32 v140, v140, v156
    v_add_f32 v141, v141, v157
    v_mul_f32 v134, s46, v134
    v_sub_f32 v54, v54, v134
    v_sub_f32 v55, v55, v134
    v_sub_f32 v56, v56, v134
    v_sub_f32 v57, v57, v134
    v_sub_f32 v58, v58, v134
    v_sub_f32 v59, v59, v134
    v_sub_f32 v60, v60, v134
    v_sub_f32 v61, v61, v134
    v_sub_f32 v62, v62, v134
    v_sub_f32 v63, v63, v134
    v_mul_f32 v142, v54, v54
    v_fmac_f32 v142, v55, v55
    v_fmac_f32 v142, v56, v56
    v_fmac_f32 v142, v57, v57
    v_fmac_f32 v142, v58, v58
    v_fmac_f32 v142, v59, v59
    v_fmac_f32 v142, v60, v60
    v_fmac_f32 v142, v61, v61
    v_fmac_f32 v142, v62, v62
    v_fmac_f32 v142, v63, v63
    v_mul_f32 v135, s46, v135
    v_sub_f32 v64, v64, v135
    v_sub_f32 v65, v65, v135
    v_sub_f32 v66, v66, v135
    v_sub_f32 v67, v67, v135
    v_sub_f32 v68, v68, v135
    v_sub_f32 v69, v69, v135
    v_sub_f32 v70, v70, v135
    v_sub_f32 v71, v71, v135
    v_sub_f32 v72, v72, v135
    v_sub_f32 v73, v73, v135
    v_mul_f32 v143, v64, v64
    v_fmac_f32 v143, v65, v65
    v_fmac_f32 v143, v66, v66
    v_fmac_f32 v143, v67, v67
    v_fmac_f32 v143, v68, v68
    v_fmac_f32 v143, v69, v69
    v_fmac_f32 v143, v70, v70
    v_fmac_f32 v143, v71, v71
    v_fmac_f32 v143, v72, v72
    v_fmac_f32 v143, v73, v73
    v_mul_f32 v136, s46, v136
    v_sub_f32 v74, v74, v136
    v_sub_f32 v75, v75, v136
    v_sub_f32 v76, v76, v136
    v_sub_f32 v77, v77, v136
    v_sub_f32 v78, v78, v136
    v_sub_f32 v79, v79, v136
    v_sub_f32 v80, v80, v136
    v_sub_f32 v81, v81, v136
    v_sub_f32 v82, v82, v136
    v_sub_f32 v83, v83, v136
    v_mul_f32 v144, v74, v74
    v_fmac_f32 v144, v75, v75
    v_fmac_f32 v144, v76, v76
    v_fmac_f32 v144, v77, v77
    v_fmac_f32 v144, v78, v78
    v_fmac_f32 v144, v79, v79
    v_fmac_f32 v144, v80, v80
    v_fmac_f32 v144, v81, v81
    v_fmac_f32 v144, v82, v82
    v_fmac_f32 v144, v83, v83
    v_mul_f32 v137, s46, v137
    v_sub_f32 v84, v84, v137
    v_sub_f32 v85, v85, v137
    v_sub_f32 v86, v86, v137
    v_sub_f32 v87, v87, v137
    v_sub_f32 v88, v88, v137
    v_sub_f32 v89, v89, v137
    v_sub_f32 v90, v90, v137
    v_sub_f32 v91, v91, v137
    v_sub_f32 v92, v92, v137
    v_sub_f32 v93, v93, v137
    v_mul_f32 v145, v84, v84
    v_fmac_f32 v145, v85, v85
    v_fmac_f32 v145, v86, v86
    v_fmac_f32 v145, v87, v87
    v_fmac_f32 v145, v88, v88
    v_fmac_f32 v145, v89, v89
    v_fmac_f32 v145, v90, v90
    v_fmac_f32 v145, v91, v91
    v_fmac_f32 v145, v92, v92
    v_fmac_f32 v145, v93, v93
    v_mul_f32 v138, s46, v138
    v_sub_f32 v94, v94, v138
    v_sub_f32 v95, v95, v138
    v_sub_f32 v96, v96, v138
    v_sub_f32 v97, v97, v138
    v_sub_f32 v98, v98, v138
    v_sub_f32 v99, v99, v138
    v_sub_f32 v100, v100, v138
    v_sub_f32 v101, v101, v138
    v_sub_f32 v102, v102, v138
    v_sub_f32 v103, v103, v138
    v_mul_f32 v146, v94, v94
    v_fmac_f32 v146, v95, v95
    v_fmac_f32 v146, v96, v96
    v_fmac_f32 v146, v97, v97
    v_fmac_f32 v146, v98, v98
    v_fmac_f32 v146, v99, v99
    v_fmac_f32 v146, v100, v100
    v_fmac_f32 v146, v101, v101
    v_fmac_f32 v146, v102, v102
    v_fmac_f32 v146, v103, v103
    v_mul_f32 v139, s46, v139
    v_sub_f32 v104, v104, v139
    v_sub_f32 v105, v105, v139
    v_sub_f32 v106, v106, v139
    v_sub_f32 v107, v107, v139
    v_sub_f32 v108, v108, v139
    v_sub_f32 v109, v109, v139
    v_sub_f32 v110, v110, v139
    v_sub_f32 v111, v111, v139
    v_sub_f32 v112, v112, v139
    v_sub_f32 v113, v113, v139
    v_mul_f32 v147, v104, v104
    v_fmac_f32 v147, v105, v105
    v_fmac_f32 v147, v106, v106
    v_fmac_f32 v147, v107, v107
    v_fmac_f32 v147, v108, v108
    v_fmac_f32 v147, v109, v109
    v_fmac_f32 v147, v110, v110
    v_fmac_f32 v147, v111, v111
    v_fmac_f32 v147, v112, v112
    v_fmac_f32 v147, v113, v113
    v_mul_f32 v140, s46, v140
    v_sub_f32 v114, v114, v140
    v_sub_f32 v115, v115, v140
    v_sub_f32 v116, v116, v140
    v_sub_f32 v117, v117, v140
    v_sub_f32 v118, v118, v140
    v_sub_f32 v119, v119, v140
    v_sub_f32 v120, v120, v140
    v_sub_f32 v121, v121, v140
    v_sub_f32 v122, v122, v140
    v_sub_f32 v123, v123, v140
    v_mul_f32 v148, v114, v114
    v_fmac_f32 v148, v115, v115
    v_fmac_f32 v148, v116, v116
    v_fmac_f32 v148, v117, v117
    v_fmac_f32 v148, v118, v118
    v_fmac_f32 v148, v119, v119
    v_fmac_f32 v148, v120, v120
    v_fmac_f32 v148, v121, v121
    v_fmac_f32 v148, v122, v122
    v_fmac_f32 v148, v123, v123
    v_mul_f32 v141, s46, v141
    v_sub_f32 v124, v124, v141
    v_sub_f32 v125, v125, v141
    v_sub_f32 v126, v126, v141
    v_sub_f32 v127, v127, v141
    v_sub_f32 v128, v128, v141
    v_sub_f32 v129, v129, v141
    v_sub_f32 v130, v130, v141
    v_sub_f32 v131, v131, v141
    v_sub_f32 v132, v132, v141
    v_sub_f32 v133, v133, v141
    v_mul_f32 v149, v124, v124
    v_fmac_f32 v149, v125, v125
    v_fmac_f32 v149, v126, v126
    v_fmac_f32 v149, v127, v127
    v_fmac_f32 v149, v128, v128
    v_fmac_f32 v149, v129, v129
    v_fmac_f32 v149, v130, v130
    v_fmac_f32 v149, v131, v131
    v_fmac_f32 v149, v132, v132
    v_fmac_f32 v149, v133, v133
    v_add_f32_dpp v142, v142, v142 quad_perm:[1,0,3,2] row_mask:0xf bank_mask:0xf
    v_add_f32_dpp v143, v143, v143 quad_perm:[1,0,3,2] row_mask:0xf bank_mask:0xf
    v_add_f32_dpp v144, v144, v144 quad_perm:[1,0,3,2] row_mask:0xf bank_mask:0xf
    v_add_f32_dpp v145, v145, v145 quad_perm:[1,0,3,2] row_mask:0xf bank_mask:0xf
    v_add_f32_dpp v146, v146, v146 quad_perm:[1,0,3,2] row_mask:0xf bank_mask:0xf
    v_add_f32_dpp v147, v147, v147 quad_perm:[1,0,3,2] row_mask:0xf bank_mask:0xf
    v_add_f32_dpp v148, v148, v148 quad_perm:[1,0,3,2] row_mask:0xf bank_mask:0xf
    v_add_f32_dpp v149, v149, v149 quad_perm:[1,0,3,2] row_mask:0xf bank_mask:0xf
    v_add_f32_dpp v142, v142, v142 quad_perm:[2,3,0,1] row_mask:0xf bank_mask:0xf
    v_add_f32_dpp v143, v143, v143 quad_perm:[2,3,0,1] row_mask:0xf bank_mask:0xf
    v_add_f32_dpp v144, v144, v144 quad_perm:[2,3,0,1] row_mask:0xf bank_mask:0xf
    v_add_f32_dpp v145, v145, v145 quad_perm:[2,3,0,1] row_mask:0xf bank_mask:0xf
    v_add_f32_dpp v146, v146, v146 quad_perm:[2,3,0,1] row_mask:0xf bank_mask:0xf
    v_add_f32_dpp v147, v147, v147 quad_perm:[2,3,0,1] row_mask:0xf bank_mask:0xf
    v_add_f32_dpp v148, v148, v148 quad_perm:[2,3,0,1] row_mask:0xf bank_mask:0xf
    v_add_f32_dpp v149, v149, v149 quad_perm:[2,3,0,1] row_mask:0xf bank_mask:0xf
    v_add_f32_dpp v142, v142, v142 row_half_mirror row_mask:0xf bank_mask:0xf
    v_add_f32_dpp v143, v143, v143 row_half_mirror row_mask:0xf bank_mask:0xf
    v_add_f32_dpp v144, v144, v144 row_half_mirror row_mask:0xf bank_mask:0xf
    v_add_f32_dpp v145, v145, v145 row_half_mirror row_mask:0xf bank_mask:0xf
    v_add_f32_dpp v146, v146, v146 row_half_mirror row_mask:0xf bank_mask:0xf
    v_add_f32_dpp v147, v147, v147 row_half_mirror row_mask:0xf bank_mask:0xf
    v_add_f32_dpp v148, v148, v148 row_half_mirror row_mask:0xf bank_mask:0xf
    v_add_f32_dpp v149, v149, v149 row_half_mirror row_mask:0xf bank_mask:0xf
    v_add_f32_dpp v142, v142, v142 row_mirror row_mask:0xf bank_mask:0xf
    v_add_f32_dpp v143, v143, v143 row_mirror row_mask:0xf bank_mask:0xf
    v_add_f32_dpp v144, v144, v144 row_mirror row_mask:0xf bank_mask:0xf
    v_add_f32_dpp v145, v145, v145 row_mirror row_mask:0xf bank_mask:0xf
    v_add_f32_dpp v146, v146, v146 row_mirror row_mask:0xf bank_mask:0xf
    v_add_f32_dpp v147, v147, v147 row_mirror row_mask:0xf bank_mask:0xf
    v_add_f32_dpp v148, v148, v148 row_mirror row_mask:0xf bank_mask:0xf
    v_add_f32_dpp v149, v149, v149 row_mirror row_mask:0xf bank_mask:0xf
    v_mov_b32 v150, v142
    v_mov_b32 v151, v143
    v_mov_b32 v152, v144
    v_mov_b32 v153, v145
    v_mov_b32 v154, v146
    v_mov_b32 v155, v147
    v_mov_b32 v156, v148
    v_mov_b32 v157, v149
    s_nop 1
    v_permlane16_swap_b32 v142, v150
    v_permlane16_swap_b32 v143, v151
    v_permlane16_swap_b32 v144, v152
    v_permlane16_swap_b32 v145, v153
    v_permlane16_swap_b32 v146, v154
    v_permlane16_swap_b32 v147, v155
    v_permlane16_swap_b32 v148, v156
    v_permlane16_swap_b32 v149, v157
    v_add_f32 v142, v142, v150
    v_add_f32 v143, v143, v151
    v_add_f32 v144, v144, v152
    v_add_f32 v145, v145, v153
    v_add_f32 v146, v146, v154
    v_add_f32 v147, v147, v155
    v_add_f32 v148, v148, v156
    v_add_f32 v149, v149, v157
    v_mov_b32 v150, v142
    v_mov_b32 v151, v143
    v_mov_b32 v152, v144
    v_mov_b32 v153, v145
    v_mov_b32 v154, v146
    v_mov_b32 v155, v147
    v_mov_b32 v156, v148
    v_mov_b32 v157, v149
    s_nop 1
    v_permlane32_swap_b32 v142, v150
    v_permlane32_swap_b32 v143, v151
    v_permlane32_swap_b32 v144, v152
    v_permlane32_swap_b32 v145, v153
    v_permlane32_swap_b32 v146, v154
    v_permlane32_swap_b32 v147, v155
    v_permlane32_swap_b32 v148, v156
    v_permlane32_swap_b32 v149, v157
    v_add_f32 v142, v142, v150
    v_add_f32 v143, v143, v151
    v_add_f32 v144, v144, v152
    v_add_f32 v145, v145, v153
    v_add_f32 v146, v146, v154
    v_add_f32 v147, v147, v155
    v_add_f32 v148, v148, v156
    v_add_f32 v149, v149, v157
    v_fma_f32 v142, v142, s46, v10
    v_fma_f32 v143, v143, s46, v10
    v_fma_f32 v144, v144, s46, v10
    v_fma_f32 v145, v145, s46, v10
    v_fma_f32 v146, v146, s46, v10
    v_fma_f32 v147, v147, s46, v10
    v_fma_f32 v148, v148, s46, v10
    v_fma_f32 v149, v149, s46, v10
    v_rsq_f32 v142, v142
    v_rsq_f32 v143, v143
    v_rsq_f32 v144, v144
    v_rsq_f32 v145, v145
    v_rsq_f32 v146, v146
    v_rsq_f32 v147, v147
    v_rsq_f32 v148, v148
    v_rsq_f32 v149, v149
    v_mul_f32 v54, v54, v142
    v_mul_f32 v55, v55, v142
    v_mul_f32 v56, v56, v142
    v_mul_f32 v57, v57, v142
    v_mul_f32 v58, v58, v142
    v_mul_f32 v59, v59, v142
    v_mul_f32 v60, v60, v142
    v_mul_f32 v61, v61, v142
    v_mul_f32 v62, v62, v142
    v_mul_f32 v63, v63, v142
    v_cvt_pk_bf16_f32 v14, v54, v55
    v_cvt_pk_bf16_f32 v15, v56, v57
    v_cvt_pk_bf16_f32 v16, v58, v59
    v_cvt_pk_bf16_f32 v17, v60, v61
    v_cvt_pk_bf16_f32 v18, v62, v63
    buffer_store_dword v14, v4, s[16:19], s36 offen offset:0 sc1
    buffer_store_dword v15, v4, s[16:19], s36 offen offset:256 sc1
    buffer_store_dword v16, v4, s[16:19], s36 offen offset:512 sc1
    buffer_store_dword v17, v4, s[16:19], s36 offen offset:768 sc1
    buffer_store_dword v18, v4, s[16:19], s36 offen offset:1024 sc1
    s_add_u32 s36, s36, 1280
    v_mul_f32 v64, v64, v143
    v_mul_f32 v65, v65, v143
    v_mul_f32 v66, v66, v143
    v_mul_f32 v67, v67, v143
    v_mul_f32 v68, v68, v143
    v_mul_f32 v69, v69, v143
    v_mul_f32 v70, v70, v143
    v_mul_f32 v71, v71, v143
    v_mul_f32 v72, v72, v143
    v_mul_f32 v73, v73, v143
    v_cvt_pk_bf16_f32 v19, v64, v65
    v_cvt_pk_bf16_f32 v20, v66, v67
    v_cvt_pk_bf16_f32 v21, v68, v69
    v_cvt_pk_bf16_f32 v22, v70, v71
    v_cvt_pk_bf16_f32 v23, v72, v73
    buffer_store_dword v19, v4, s[16:19], s36 offen offset:0 sc1
    buffer_store_dword v20, v4, s[16:19], s36 offen offset:256 sc1
    buffer_store_dword v21, v4, s[16:19], s36 offen offset:512 sc1
    buffer_store_dword v22, v4, s[16:19], s36 offen offset:768 sc1
    buffer_store_dword v23, v4, s[16:19], s36 offen offset:1024 sc1
    s_add_u32 s36, s36, 1280
    v_mul_f32 v74, v74, v144
    v_mul_f32 v75, v75, v144
    v_mul_f32 v76, v76, v144
    v_mul_f32 v77, v77, v144
    v_mul_f32 v78, v78, v144
    v_mul_f32 v79, v79, v144
    v_mul_f32 v80, v80, v144
    v_mul_f32 v81, v81, v144
    v_mul_f32 v82, v82, v144
    v_mul_f32 v83, v83, v144
    v_cvt_pk_bf16_f32 v24, v74, v75
    v_cvt_pk_bf16_f32 v25, v76, v77
    v_cvt_pk_bf16_f32 v26, v78, v79
    v_cvt_pk_bf16_f32 v27, v80, v81
    v_cvt_pk_bf16_f32 v28, v82, v83
    buffer_store_dword v24, v4, s[16:19], s36 offen offset:0 sc1
    buffer_store_dword v25, v4, s[16:19], s36 offen offset:256 sc1
    buffer_store_dword v26, v4, s[16:19], s36 offen offset:512 sc1
    buffer_store_dword v27, v4, s[16:19], s36 offen offset:768 sc1
    buffer_store_dword v28, v4, s[16:19], s36 offen offset:1024 sc1
    s_add_u32 s36, s36, 1280
    v_mul_f32 v84, v84, v145
    v_mul_f32 v85, v85, v145
    v_mul_f32 v86, v86, v145
    v_mul_f32 v87, v87, v145
    v_mul_f32 v88, v88, v145
    v_mul_f32 v89, v89, v145
    v_mul_f32 v90, v90, v145
    v_mul_f32 v91, v91, v145
    v_mul_f32 v92, v92, v145
    v_mul_f32 v93, v93, v145
    v_cvt_pk_bf16_f32 v29, v84, v85
    v_cvt_pk_bf16_f32 v30, v86, v87
    v_cvt_pk_bf16_f32 v31, v88, v89
    v_cvt_pk_bf16_f32 v32, v90, v91
    v_cvt_pk_bf16_f32 v33, v92, v93
    buffer_store_dword v29, v4, s[16:19], s36 offen offset:0 sc1
    buffer_store_dword v30, v4, s[16:19], s36 offen offset:256 sc1
    buffer_store_dword v31, v4, s[16:19], s36 offen offset:512 sc1
    buffer_store_dword v32, v4, s[16:19], s36 offen offset:768 sc1
    buffer_store_dword v33, v4, s[16:19], s36 offen offset:1024 sc1
    s_add_u32 s36, s36, 1280
    v_mul_f32 v94, v94, v146
    v_mul_f32 v95, v95, v146
    v_mul_f32 v96, v96, v146
    v_mul_f32 v97, v97, v146
    v_mul_f32 v98, v98, v146
    v_mul_f32 v99, v99, v146
    v_mul_f32 v100, v100, v146
    v_mul_f32 v101, v101, v146
    v_mul_f32 v102, v102, v146
    v_mul_f32 v103, v103, v146
    v_cvt_pk_bf16_f32 v34, v94, v95
    v_cvt_pk_bf16_f32 v35, v96, v97
    v_cvt_pk_bf16_f32 v36, v98, v99
    v_cvt_pk_bf16_f32 v37, v100, v101
    v_cvt_pk_bf16_f32 v38, v102, v103
    buffer_store_dword v34, v4, s[16:19], s36 offen offset:0 sc1
    buffer_store_dword v35, v4, s[16:19], s36 offen offset:256 sc1
    buffer_store_dword v36, v4, s[16:19], s36 offen offset:512 sc1
    buffer_store_dword v37, v4, s[16:19], s36 offen offset:768 sc1
    buffer_store_dword v38, v4, s[16:19], s36 offen offset:1024 sc1
    s_add_u32 s36, s36, 1280
    v_mul_f32 v104, v104, v147
    v_mul_f32 v105, v105, v147
    v_mul_f32 v106, v106, v147
    v_mul_f32 v107, v107, v147
    v_mul_f32 v108, v108, v147
    v_mul_f32 v109, v109, v147
    v_mul_f32 v110, v110, v147
    v_mul_f32 v111, v111, v147
    v_mul_f32 v112, v112, v147
    v_mul_f32 v113, v113, v147
    v_cvt_pk_bf16_f32 v39, v104, v105
    v_cvt_pk_bf16_f32 v40, v106, v107
    v_cvt_pk_bf16_f32 v41, v108, v109
    v_cvt_pk_bf16_f32 v42, v110, v111
    v_cvt_pk_bf16_f32 v43, v112, v113
    buffer_store_dword v39, v4, s[16:19], s36 offen offset:0 sc1
    buffer_store_dword v40, v4, s[16:19], s36 offen offset:256 sc1
    buffer_store_dword v41, v4, s[16:19], s36 offen offset:512 sc1
    buffer_store_dword v42, v4, s[16:19], s36 offen offset:768 sc1
    buffer_store_dword v43, v4, s[16:19], s36 offen offset:1024 sc1
    s_add_u32 s36, s36, 1280
    v_mul_f32 v114, v114, v148
    v_mul_f32 v115, v115, v148
    v_mul_f32 v116, v116, v148
    v_mul_f32 v117, v117, v148
    v_mul_f32 v118, v118, v148
    v_mul_f32 v119, v119, v148
    v_mul_f32 v120, v120, v148
    v_mul_f32 v121, v121, v148
    v_mul_f32 v122, v122, v148
    v_mul_f32 v123, v123, v148
    v_cvt_pk_bf16_f32 v44, v114, v115
    v_cvt_pk_bf16_f32 v45, v116, v117
    v_cvt_pk_bf16_f32 v46, v118, v119
    v_cvt_pk_bf16_f32 v47, v120, v121
    v_cvt_pk_bf16_f32 v48, v122, v123
    buffer_store_dword v44, v4, s[16:19], s36 offen offset:0 sc1
    buffer_store_dword v45, v4, s[16:19], s36 offen offset:256 sc1
    buffer_store_dword v46, v4, s[16:19], s36 offen offset:512 sc1
    buffer_store_dword v47, v4, s[16:19], s36 offen offset:768 sc1
    buffer_store_dword v48, v4, s[16:19], s36 offen offset:1024 sc1
    s_add_u32 s36, s36, 1280
    v_mul_f32 v124, v124, v149
    v_mul_f32 v125, v125, v149
    v_mul_f32 v126, v126, v149
    v_mul_f32 v127, v127, v149
    v_mul_f32 v128, v128, v149
    v_mul_f32 v129, v129, v149
    v_mul_f32 v130, v130, v149
    v_mul_f32 v131, v131, v149
    v_mul_f32 v132, v132, v149
    v_mul_f32 v133, v133, v149
    v_cvt_pk_bf16_f32 v49, v124, v125
    v_cvt_pk_bf16_f32 v50, v126, v127
    v_cvt_pk_bf16_f32 v51, v128, v129
    v_cvt_pk_bf16_f32 v52, v130, v131
    v_cvt_pk_bf16_f32 v53, v132, v133
    buffer_store_dword v49, v4, s[16:19], s36 offen offset:0 sc1
    buffer_store_dword v50, v4, s[16:19], s36 offen offset:256 sc1
    buffer_store_dword v51, v4, s[16:19], s36 offen offset:512 sc1
    buffer_store_dword v52, v4, s[16:19], s36 offen offset:768 sc1
    buffer_store_dword v53, v4, s[16:19], s36 offen offset:1024 sc1
    s_add_u32 s36, s36, 1280
    v_mov_b32 v9, 40
bi_15:
    s_sub_u32 s88, s88, 1
    s_cbranch_scc1 k_end
    global_load_dword v8, v9, s[6:7] sc1
    s_waitcnt vmcnt(0)
    v_cmp_eq_u32 vcc, 0, v8
    s_cbranch_vccnz bi_15
    s_mov_b32 s33, 1
    s_waitcnt vmcnt(0)
    s_barrier
    v_mov_b32 v8, s33
    s_mov_b64 exec, s[14:15]
    buffer_store_dword v8, v0, s[16:19], s39 offen sc1
    s_mov_b64 exec, -1
b_t1:
    s_cmp_ge_u32 s10, 96
    s_cselect_b32 s40, 1, 0
    s_mul_i32 s28, s40, 96
    s_sub_u32 s28, s10, s28
    s_lshr_b32 s41, s28, 5
    s_and_b32 s42, s28, 31
    s_lshl_b32 s34, s42, 8
    s_lshl_b32 s39, s10, 2
    s_add_u32 s39, s39, 69730560
    s_load_dwordx2 s[20:21], s[0:1], 24
    s_load_dwordx2 s[44:45], s[0:1], 32
    s_load_dwordx2 s[46:47], s[0:1], 16
    s_waitcnt lgkmcnt(0)
    s_cmp_eq_u32 s41, 1
    s_cselect_b64 s[20:21], s[44:45], s[20:21]
    s_cmp_eq_u32 s41, 2
    s_cselect_b64 s[20:21], s[46:47], s[20:21]
    s_mov_b32 s22, 5242880
    s_mov_b32 s23, 0x20000
    v_lshrrev_b32 v8, 4, v0
    v_and_b32 v9, 15, v0
    v_lshlrev_b32 v10, 2, v8
    v_xor_b32 v9, v9, v10
    s_mov_b32 s28, 8192
    v_mul_lo_u32 v14, v8, s28
    v_lshl_add_u32 v14, v9, 4, v14
    v_lshrrev_b32 v8, 2, v0
    v_lshlrev_b32 v15, 8, v8
    v_and_b32 v8, 3, v8
    v_xor_b32 v8, s11, v8
    v_lshl_add_u32 v15, v8, 6, v15
    v_and_b32 v8, 3, v0
    v_lshl_add_u32 v15, v8, 3, v15
    v_add_u32 v16, 0x10000, v15
    v_add_u32 v17, 0x20000, v15
    s_lshl_b32 s29, s11, 11
    s_lshr_b32 s30, s11, 1
    s_and_b32 s31, s11, 1
    s_lshl_b32 s30, s30, 2
    s_lshl_b32 s31, s31, 4
    s_add_u32 s30, s30, s31
    s_mul_i32 s30, s30, 8192
    s_add_u32 s30, s30, s34
    s_barrier
    s_add_u32 m0, s29, 0
    s_add_u32 s28, s30, 0
    buffer_load_dwordx4 v14, s[20:23], s28 offen lds
    s_add_u32 m0, s29, 1024
    s_add_u32 s28, s30, 65536
    buffer_load_dwordx4 v14, s[20:23], s28 offen lds
    s_add_u32 m0, s29, 8192
    s_add_u32 s28, s30, 262144
    buffer_load_dwordx4 v14, s[20:23], s28 offen lds
    s_add_u32 m0, s29, 9216
    s_add_u32 s28, s30, 327680
    buffer_load_dwordx4 v14, s[20:23], s28 offen lds
    s_add_u32 m0, s29, 16384
    s_add_u32 s28, s30, 524288
    buffer_load_dwordx4 v14, s[20:23], s28 offen lds
    s_add_u32 m0, s29, 17408
    s_add_u32 s28, s30, 589824
    buffer_load_dwordx4 v14, s[20:23], s28 offen lds
    s_add_u32 m0, s29, 24576
    s_add_u32 s28, s30, 786432
    buffer_load_dwordx4 v14, s[20:23], s28 offen lds
    s_add_u32 m0, s29, 25600
    s_add_u32 s28, s30, 851968
    buffer_load_dwordx4 v14, s[20:23], s28 offen lds
    s_add_u32 m0, s29, 32768
    s_add_u32 s28, s30, 1048576
    buffer_load_dwordx4 v14, s[20:23], s28 offen lds
    s_add_u32 m0, s29, 33792
    s_add_u32 s28, s30, 1114112
    buffer_load_dwordx4 v14, s[20:23], s28 offen lds
    s_add_u32 m0, s29, 40960
    s_add_u32 s28, s30, 1310720
    buffer_load_dwordx4 v14, s[20:23], s28 offen lds
    s_add_u32 m0, s29, 41984
    s_add_u32 s28, s30, 1376256
    buffer_load_dwordx4 v14, s[20:23], s28 offen lds
    s_add_u32 m0, s29, 49152
    s_add_u32 s28, s30, 1572864
    buffer_load_dwordx4 v14, s[20:23], s28 offen lds
    s_add_u32 m0, s29, 50176
    s_add_u32 s28, s30, 1638400
    buffer_load_dwordx4 v14, s[20:23], s28 offen lds
    s_add_u32 m0, s29, 57344
    s_add_u32 s28, s30, 1835008
    buffer_load_dwordx4 v14, s[20:23], s28 offen lds
    s_add_u32 m0, s29, 58368
    s_add_u32 s28, s30, 1900544
    buffer_load_dwordx4 v14, s[20:23], s28 offen lds
    s_add_u32 m0, s29, 65536
    s_add_u32 s28, s30, 2097152
    buffer_load_dwordx4 v14, s[20:23], s28 offen lds
    s_add_u32 m0, s29, 66560
    s_add_u32 s28, s30, 2162688
    buffer_load_dwordx4 v14, s[20:23], s28 offen lds
    s_add_u32 m0, s29, 73728
    s_add_u32 s28, s30, 2359296
    buffer_load_dwordx4 v14, s[20:23], s28 offen lds
    s_add_u32 m0, s29, 74752
    s_add_u32 s28, s30, 2424832
    buffer_load_dwordx4 v14, s[20:23], s28 offen lds
    s_add_u32 m0, s29, 81920
    s_add_u32 s28, s30, 2621440
    buffer_load_dwordx4 v14, s[20:23], s28 offen lds
    s_add_u32 m0, s29, 82944
    s_add_u32 s28, s30, 2686976
    buffer_load_dwordx4 v14, s[20:23], s28 offen lds
    s_add_u32 m0, s29, 90112
    s_add_u32 s28, s30, 2883584
    buffer_load_dwordx4 v14, s[20:23], s28 offen lds
    s_add_u32 m0, s29, 91136
    s_add_u32 s28, s30, 2949120
    buffer_load_dwordx4 v14, s[20:23], s28 offen lds
    s_add_u32 m0, s29, 98304
    s_add_u32 s28, s30, 3145728
    buffer_load_dwordx4 v14, s[20:23], s28 offen lds
    s_add_u32 m0, s29, 99328
    s_add_u32 s28, s30, 3211264
    buffer_load_dwordx4 v14, s[20:23], s28 offen lds
    s_add_u32 m0, s29, 106496
    s_add_u32 s28, s30, 3407872
    buffer_load_dwordx4 v14, s[20:23], s28 offen lds
    s_add_u32 m0, s29, 107520
    s_add_u32 s28, s30, 3473408
    buffer_load_dwordx4 v14, s[20:23], s28 offen lds
    s_add_u32 m0, s29, 114688
    s_add_u32 s28, s30, 3670016
    buffer_load_dwordx4 v14, s[20:23], s28 offen lds
    s_add_u32 m0, s29, 115712
    s_add_u32 s28, s30, 3735552
    buffer_load_dwordx4 v14, s[20:23], s28 offen lds
    s_add_u32 m0, s29, 122880
    s_add_u32 s28, s30, 3932160
    buffer_load_dwordx4 v14, s[20:23], s28 offen lds
    s_add_u32 m0, s29, 123904
    s_add_u32 s28, s30, 3997696
    buffer_load_dwordx4 v14, s[20:23], s28 offen lds
    s_add_u32 m0, s29, 131072
    s_add_u32 s28, s30, 4194304
    buffer_load_dwordx4 v14, s[20:23], s28 offen lds
    s_add_u32 m0, s29, 132096
    s_add_u32 s28, s30, 4259840
    buffer_load_dwordx4 v14, s[20:23], s28 offen lds
    s_add_u32 m0, s29, 139264
    s_add_u32 s28, s30, 4456448
    buffer_load_dwordx4 v14, s[20:23], s28 offen lds
    s_add_u32 m0, s29, 140288
    s_add_u32 s28, s30, 4521984
    buffer_load_dwordx4 v14, s[20:23], s28 offen lds
    s_add_u32 m0, s29, 147456
    s_add_u32 s28, s30, 4718592
    buffer_load_dwordx4 v14, s[20:23], s28 offen lds
    s_add_u32 m0, s29, 148480
    s_add_u32 s28, s30, 4784128
    buffer_load_dwordx4 v14, s[20:23], s28 offen lds
    s_add_u32 m0, s29, 155648
    s_add_u32 s28, s30, 4980736
    buffer_load_dwordx4 v14, s[20:23], s28 offen lds
    s_add_u32 m0, s29, 156672
    s_add_u32 s28, s30, 5046272
    buffer_load_dwordx4 v14, s[20:23], s28 offen lds
    s_waitcnt vmcnt(30)
    s_barrier
    ds_read_b64_tr_b16 a[0:1], v15 offset:0
    ds_read_b64_tr_b16 a[2:3], v15 offset:4096
    ds_read_b64_tr_b16 a[4:5], v15 offset:32
    ds_read_b64_tr_b16 a[6:7], v15 offset:4128
    ds_read_b64_tr_b16 a[8:9], v15 offset:8192
    ds_read_b64_tr_b16 a[10:11], v15 offset:12288
    ds_read_b64_tr_b16 a[12:13], v15 offset:8224
    ds_read_b64_tr_b16 a[14:15], v15 offset:12320
    ds_read_b64_tr_b16 a[16:17], v15 offset:16384
    ds_read_b64_tr_b16 a[18:19], v15 offset:20480
    ds_read_b64_tr_b16 a[20:21], v15 offset:16416
    ds_read_b64_tr_b16 a[22:23], v15 offset:20512
    ds_read_b64_tr_b16 a[24:25], v15 offset:24576
    ds_read_b64_tr_b16 a[26:27], v15 offset:28672
    ds_read_b64_tr_b16 a[28:29], v15 offset:24608
    ds_read_b64_tr_b16 a[30:31], v15 offset:28704
    ds_read_b64_tr_b16 a[32:33], v15 offset:32768
    ds_read_b64_tr_b16 a[34:35], v15 offset:36864
    ds_read_b64_tr_b16 a[36:37], v15 offset:32800
    ds_read_b64_tr_b16 a[38:39], v15 offset:36896
    s_waitcnt vmcnt(20)
    s_barrier
    ds_read_b64_tr_b16 a[40:41], v15 offset:40960
    ds_read_b64_tr_b16 a[42:43], v15 offset:45056
    ds_read_b64_tr_b16 a[44:45], v15 offset:40992
    ds_read_b64_tr_b16 a[46:47], v15 offset:45088
    ds_read_b64_tr_b16 a[48:49], v15 offset:49152
    ds_read_b64_tr_b16 a[50:51], v15 offset:53248
    ds_read_b64_tr_b16 a[52:53], v15 offset:49184
    ds_read_b64_tr_b16 a[54:55], v15 offset:53280
    ds_read_b64_tr_b16 a[56:57], v15 offset:57344
    ds_read_b64_tr_b16 a[58:59], v15 offset:61440
    ds_read_b64_tr_b16 a[60:61], v15 offset:57376
    ds_read_b64_tr_b16 a[62:63], v15 offset:61472
    ds_read_b64_tr_b16 a[64:65], v16 offset:0
    ds_read_b64_tr_b16 a[66:67], v16 offset:4096
    ds_read_b64_tr_b16 a[68:69], v16 offset:32
    ds_read_b64_tr_b16 a[70:71], v16 offset:4128
    ds_read_b64_tr_b16 a[72:73], v16 offset:8192
    ds_read_b64_tr_b16 a[74:75], v16 offset:12288
    ds_read_b64_tr_b16 a[76:77], v16 offset:8224
    ds_read_b64_tr_b16 a[78:79], v16 offset:12320
    s_waitcnt vmcnt(10)
    s_barrier
    ds_read_b64_tr_b16 a[80:81], v16 offset:16384
    ds_read_b64_tr_b16 a[82:83], v16 offset:20480
    ds_read_b64_tr_b16 a[84:85], v16 offset:16416
    ds_read_b64_tr_b16 a[86:87], v16 offset:20512
    ds_read_b64_tr_b16 a[88:89], v16 offset:24576
    ds_read_b64_tr_b16 a[90:91], v16 offset:28672
    ds_read_b64_tr_b16 a[92:93], v16 offset:24608
    ds_read_b64_tr_b16 a[94:95], v16 offset:28704
    ds_read_b64_tr_b16 a[96:97], v16 offset:32768
    ds_read_b64_tr_b16 a[98:99], v16 offset:36864
    ds_read_b64_tr_b16 a[100:101], v16 offset:32800
    ds_read_b64_tr_b16 a[102:103], v16 offset:36896
    ds_read_b64_tr_b16 a[104:105], v16 offset:40960
    ds_read_b64_tr_b16 a[106:107], v16 offset:45056
    ds_read_b64_tr_b16 a[108:109], v16 offset:40992
    ds_read_b64_tr_b16 a[110:111], v16 offset:45088
    ds_read_b64_tr_b16 a[112:113], v16 offset:49152
    ds_read_b64_tr_b16 a[114:115], v16 offset:53248
    ds_read_b64_tr_b16 a[116:117], v16 offset:49184
    ds_read_b64_tr_b16 a[118:119], v16 offset:53280
    s_waitcnt vmcnt(0)
    s_barrier
    ds_read_b64_tr_b16 a[120:121], v16 offset:57344
    ds_read_b64_tr_b16 a[122:123], v16 offset:61440
    ds_read_b64_tr_b16 a[124:125], v16 offset:57376
    ds_read_b64_tr_b16 a[126:127], v16 offset:61472
    ds_read_b64_tr_b16 a[128:129], v17 offset:0
    ds_read_b64_tr_b16 a[130:131], v17 offset:4096
    ds_read_b64_tr_b16 a[132:133], v17 offset:32
    ds_read_b64_tr_b16 a[134:135], v17 offset:4128
    ds_read_b64_tr_b16 a[136:137], v17 offset:8192
    ds_read_b64_tr_b16 a[138:139], v17 offset:12288
    ds_read_b64_tr_b16 a[140:141], v17 offset:8224
    ds_read_b64_tr_b16 a[142:143], v17 offset:12320
    ds_read_b64_tr_b16 a[144:145], v17 offset:16384
    ds_read_b64_tr_b16 a[146:147], v17 offset:20480
    ds_read_b64_tr_b16 a[148:149], v17 offset:16416
    ds_read_b64_tr_b16 a[150:151], v17 offset:20512
    ds_read_b64_tr_b16 a[152:153], v17 offset:24576
    ds_read_b64_tr_b16 a[154:155], v17 offset:28672
    ds_read_b64_tr_b16 a[156:157], v17 offset:24608
    ds_read_b64_tr_b16 a[158:159], v17 offset:28704
    s_waitcnt lgkmcnt(0)
    s_barrier
    v_lshrrev_b32 v8, 2, v0
    v_mul_u32_u24 v4, 1280, v8
    v_lshrrev_b32 v8, 4, v0
    v_and_b32 v8, 2, v8
    v_and_b32 v9, 3, v0
    v_xor_b32 v8, v8, v9
    v_lshl_add_u32 v4, v8, 4, v4
    v_lshrrev_b32 v8, 2, v2
    v_and_b32 v8, 2, v8
    v_xor_b32 v8, v8, v3
    v_lshlrev_b32 v14, 6, v2
    v_lshl_add_u32 v14, v8, 4, v14
    v_mov_b32 v9, 40
bi_18:
    s_sub_u32 s88, s88, 1
    s_cbranch_scc1 k_end
    global_load_dword v8, v9, s[6:7] sc1
    s_waitcnt vmcnt(0)
    v_cmp_eq_u32 vcc, 0, v8
    s_cbranch_vccnz bi_18
    s_mov_b32 s54, 0
    v_mul_u32_u24 v6, 4, v0
    v_add_u32 v6, s54, v6
    v_add_u32 v6, 69730304, v6
    v_mov_b32 v7, 1
bw_19:
    s_sub_u32 s88, s88, 1
    s_cbranch_scc1 k_end
    buffer_load_dword v12, v6, s[16:19], 0 offen sc1
    s_waitcnt vmcnt(0)
bk_20:
    v_cmp_lt_u32 vcc, v12, v7
    s_cbranch_vccnz bw_19
    s_mul_i32 s34, s40, 40960
    s_mul_i32 s28, s11, 320
    s_add_u32 s34, s34, s28
    s_add_u32 s34, s34, 71303168
    s_mul_i32 s35, s11, 10240
    s_lshl_b32 s36, s41, 24
    s_lshl_b32 s28, s40, 18
    s_add_u32 s36, s36, s28
    s_lshl_b32 s28, s42, 13
    s_add_u32 s36, s36, s28
    s_mov_b32 s12, 0
    s_add_u32 m0, s35, 0
    s_add_u32 s28, s34, 0
    buffer_load_dwordx4 v4, s[16:19], s28 offen sc1 lds
    s_add_u32 m0, s35, 1024
    s_add_u32 s28, s34, 20480
    buffer_load_dwordx4 v4, s[16:19], s28 offen sc1 lds
    s_add_u32 m0, s35, 2048
    s_add_u32 s28, s34, 64
    buffer_load_dwordx4 v4, s[16:19], s28 offen sc1 lds
    s_add_u32 m0, s35, 3072
    s_add_u32 s28, s34, 20544
    buffer_load_dwordx4 v4, s[16:19], s28 offen sc1 lds
    s_add_u32 m0, s35, 4096
    s_add_u32 s28, s34, 128
    buffer_load_dwordx4 v4, s[16:19], s28 offen sc1 lds
    s_add_u32 m0, s35, 5120
    s_add_u32 s28, s34, 20608
    buffer_load_dwordx4 v4, s[16:19], s28 offen sc1 lds
    s_add_u32 m0, s35, 6144
    s_add_u32 s28, s34, 192
    buffer_load_dwordx4 v4, s[16:19], s28 offen sc1 lds
    s_add_u32 m0, s35, 7168
    s_add_u32 s28, s34, 20672
    buffer_load_dwordx4 v4, s[16:19], s28 offen sc1 lds
    s_add_u32 m0, s35, 8192
    s_add_u32 s28, s34, 256
    buffer_load_dwordx4 v4, s[16:19], s28 offen sc1 lds
    s_add_u32 m0, s35, 9216
    s_add_u32 s28, s34, 20736
    buffer_load_dwordx4 v4, s[16:19], s28 offen sc1 lds
    s_add_u32 s34, s34, 81920
    s_add_u32 s35, s35, 40960
    s_cmp_ge_u32 s35, 122880
    s_cselect_b32 s28, 122880, 0
    s_sub_u32 s35, s35, s28
    s_lshl_b32 s29, s11, 1
    s_add_u32 s29, s29, s40
    s_lshl_b32 s29, s29, 5
    s_add_u32 s29, s29, s9
    s_mul_i32 s29, s29, 1280
    s_add_u32 s29, s29, 71303168
    s_mov_b32 m0, 131072
    v_lshlrev_b32 v8, 2, v0
    buffer_load_dwordx4 v1, s[16:19], s29 offen sc1 lds
    buffer_load_dword v8, s[16:19], s29 offen offset:1024 sc1 lds
    s_add_u32 s29, s29, 327680
    buffer_load_dwordx4 v1, s[16:19], s29 offen sc1 lds
    buffer_load_dword v8, s[16:19], s29 offen offset:1024 sc1 lds
    s_add_u32 s29, s29, 327680
    buffer_load_dwordx4 v1, s[16:19], s29 offen sc1 lds
    buffer_load_dword v8, s[16:19], s29 offen offset:1024 sc1 lds
    s_add_u32 s29, s29, 327680
    buffer_load_dwordx4 v1, s[16:19], s29 offen sc1 lds
    buffer_load_dword v8, s[16:19], s29 offen offset:1024 sc1 lds
    s_add_u32 s29, s29, 327680
    buffer_load_dwordx4 v1, s[16:19], s29 offen sc1 lds
    buffer_load_dword v8, s[16:19], s29 offen offset:1024 sc1 lds
    s_add_u32 s29, s29, 327680
    buffer_load_dwordx4 v1, s[16:19], s29 offen sc1 lds
    buffer_load_dword v8, s[16:19], s29 offen offset:1024 sc1 lds
    s_add_u32 s29, s29, 327680
    buffer_load_dwordx4 v1, s[16:19], s29 offen sc1 lds
    buffer_load_dword v8, s[16:19], s29 offen offset:1024 sc1 lds
    s_add_u32 s29, s29, 327680
    buffer_load_dwordx4 v1, s[16:19], s29 offen sc1 lds
    buffer_load_dword v8, s[16:19], s29 offen offset:1024 sc1 lds
    s_add_u32 s29, s29, 327680
    s_add_u32 m0, s35, 0
    s_add_u32 s28, s34, 0
    buffer_load_dwordx4 v4, s[16:19], s28 offen sc1 lds
    s_add_u32 m0, s35, 1024
    s_add_u32 s28, s34, 20480
    buffer_load_dwordx4 v4, s[16:19], s28 offen sc1 lds
    s_add_u32 m0, s35, 2048
    s_add_u32 s28, s34, 64
    buffer_load_dwordx4 v4, s[16:19], s28 offen sc1 lds
    s_add_u32 m0, s35, 3072
    s_add_u32 s28, s34, 20544
    buffer_load_dwordx4 v4, s[16:19], s28 offen sc1 lds
    s_add_u32 m0, s35, 4096
    s_add_u32 s28, s34, 128
    buffer_load_dwordx4 v4, s[16:19], s28 offen sc1 lds
    s_add_u32 m0, s35, 5120
    s_add_u32 s28, s34, 20608
    buffer_load_dwordx4 v4, s[16:19], s28 offen sc1 lds
    s_add_u32 m0, s35, 6144
    s_add_u32 s28, s34, 192
    buffer_load_dwordx4 v4, s[16:19], s28 offen sc1 lds
    s_add_u32 m0, s35, 7168
    s_add_u32 s28, s34, 20672
    buffer_load_dwordx4 v4, s[16:19], s28 offen sc1 lds
    s_add_u32 m0, s35, 8192
    s_add_u32 s28, s34, 256
    buffer_load_dwordx4 v4, s[16:19], s28 offen sc1 lds
    s_add_u32 m0, s35, 9216
    s_add_u32 s28, s34, 20736
    buffer_load_dwordx4 v4, s[16:19], s28 offen sc1 lds
    s_add_u32 s34, s34, 81920
    s_add_u32 s35, s35, 40960
    s_cmp_ge_u32 s35, 122880
    s_cselect_b32 s28, 122880, 0
    s_sub_u32 s35, s35, s28
    s_mov_b64 exec, 0
    buffer_store_dword v8, v0, s[16:19], s39 offen
    buffer_store_dword v8, v0, s[16:19], s39 offen
    buffer_store_dword v8, v0, s[16:19], s39 offen
    s_mov_b64 exec, -1
    s_mov_b32 s37, 0
    s_mov_b64 s[44:45], 0
    s_cmp_eq_u32 s41, 1
    s_cbranch_scc1 t1v_16
    s_lshl_b32 s28, s11, 10
    s_add_u32 s36, s36, s28
    s_sub_u32 s36, s36, 524288
    s_waitcnt vmcnt(29)
    s_branch t1l_21x
t1l_21:
    s_waitcnt vmcnt(16)
t1l_21x:
    s_barrier
    v_add_u32 v5, s37, v14
    ds_read_b128 v[22:25], v5 offset:0
    ds_read_b128 v[26:29], v5 offset:1024
    ds_read_b128 v[30:33], v5 offset:2048
    ds_read_b128 v[34:37], v5 offset:3072
    ds_read_b128 v[38:41], v5 offset:4096
    ds_read_b128 v[42:45], v5 offset:5120
    ds_read_b128 v[46:49], v5 offset:6144
    ds_read_b128 v[50:53], v5 offset:7168
    s_max_u32 s28, s12, 3
    s_sub_u32 s28, s28, 3
    v_mov_b32 v8, s28
    s_waitcnt lgkmcnt(6)
    v_mfma_f32_16x16x32_bf16 v[54:57], a[0:3], v[22:25], 0
    v_mfma_f32_16x16x32_bf16 v[58:61], a[4:7], v[22:25], 0
    ds_read_b128 v[22:25], v5 offset:8192
    v_mfma_f32_16x16x32_bf16 v[62:65], a[0:3], v[26:29], 0
    v_mfma_f32_16x16x32_bf16 v[66:69], a[4:7], v[26:29], 0
    ds_read_b128 v[26:29], v5 offset:9216
    s_waitcnt lgkmcnt(6)
    v_mfma_f32_16x16x32_bf16 v[54:57], a[8:11], v[30:33], v[54:57]
    s_add_u32 m0, s35, 0
    s_add_u32 s28, s34, 0
    buffer_load_dwordx4 v4, s[16:19], s28 offen sc1 lds
    v_mfma_f32_16x16x32_bf16 v[58:61], a[12:15], v[30:33], v[58:61]
    ds_read_b128 v[30:33], v5 offset:10240
    v_mfma_f32_16x16x32_bf16 v[62:65], a[8:11], v[34:37], v[62:65]
    v_mfma_f32_16x16x32_bf16 v[66:69], a[12:15], v[34:37], v[66:69]
    ds_read_b128 v[34:37], v5 offset:11264
    s_waitcnt lgkmcnt(6)
    v_mfma_f32_16x16x32_bf16 v[54:57], a[16:19], v[38:41], v[54:57]
    s_add_u32 m0, s35, 1024
    s_add_u32 s28, s34, 20480
    buffer_load_dwordx4 v4, s[16:19], s28 offen sc1 lds
    v_mfma_f32_16x16x32_bf16 v[58:61], a[20:23], v[38:41], v[58:61]
    ds_read_b128 v[38:41], v5 offset:12288
    v_mfma_f32_16x16x32_bf16 v[62:65], a[16:19], v[42:45], v[62:65]
    v_mfma_f32_16x16x32_bf16 v[66:69], a[20:23], v[42:45], v[66:69]
    ds_read_b128 v[42:45], v5 offset:13312
    s_waitcnt lgkmcnt(6)
    v_mfma_f32_16x16x32_bf16 v[54:57], a[24:27], v[46:49], v[54:57]
    s_add_u32 m0, s35, 2048
    s_add_u32 s28, s34, 64
    buffer_load_dwordx4 v4, s[16:19], s28 offen sc1 lds
    v_mfma_f32_16x16x32_bf16 v[58:61], a[28:31], v[46:49], v[58:61]
    ds_read_b128 v[46:49], v5 offset:14336
    v_mfma_f32_16x16x32_bf16 v[62:65], a[24:27], v[50:53], v[62:65]
    v_mfma_f32_16x16x32_bf16 v[66:69], a[28:31], v[50:53], v[66:69]
    ds_read_b128 v[50:53], v5 offset:15360
    s_waitcnt lgkmcnt(6)
    v_mfma_f32_16x16x32_bf16 v[54:57], a[32:35], v[22:25], v[54:57]
    s_add_u32 m0, s35, 3072
    s_add_u32 s28, s34, 20544
    buffer_load_dwordx4 v4, s[16:19], s28 offen sc1 lds
    v_mfma_f32_16x16x32_bf16 v[58:61], a[36:39], v[22:25], v[58:61]
    ds_read_b128 v[22:25], v5 offset:16384
    v_mfma_f32_16x16x32_bf16 v[62:65], a[32:35], v[26:29], v[62:65]
    v_mfma_f32_16x16x32_bf16 v[66:69], a[36:39], v[26:29], v[66:69]
    ds_read_b128 v[26:29], v5 offset:17408
    s_waitcnt lgkmcnt(6)
    v_mfma_f32_16x16x32_bf16 v[54:57], a[40:43], v[30:33], v[54:57]
    s_add_u32 m0, s35, 4096
    s_add_u32 s28, s34, 128
    buffer_load_dwordx4 v4, s[16:19], s28 offen sc1 lds
    v_mfma_f32_16x16x32_bf16 v[58:61], a[44:47], v[30:33], v[58:61]
    ds_read_b128 v[30:33], v5 offset:18432
    v_mfma_f32_16x16x32_bf16 v[62:65], a[40:43], v[34:37], v[62:65]
    v_mfma_f32_16x16x32_bf16 v[66:69], a[44:47], v[34:37], v[66:69]
    ds_read_b128 v[34:37], v5 offset:19456
    s_waitcnt lgkmcnt(6)
    v_mfma_f32_16x16x32_bf16 v[54:57], a[48:51], v[38:41], v[54:57]
    s_add_u32 m0, s35, 5120
    s_add_u32 s28, s34, 20608
    buffer_load_dwordx4 v4, s[16:19], s28 offen sc1 lds
    v_mfma_f32_16x16x32_bf16 v[58:61], a[52:55], v[38:41], v[58:61]
    ds_read_b128 v[38:41], v5 offset:20480
    v_mfma_f32_16x16x32_bf16 v[62:65], a[48:51], v[42:45], v[62:65]
    v_mfma_f32_16x16x32_bf16 v[66:69], a[52:55], v[42:45], v[66:69]
    ds_read_b128 v[42:45], v5 offset:21504
    s_waitcnt lgkmcnt(6)
    v_mfma_f32_16x16x32_bf16 v[54:57], a[56:59], v[46:49], v[54:57]
    s_add_u32 m0, s35, 6144
    s_add_u32 s28, s34, 192
    buffer_load_dwordx4 v4, s[16:19], s28 offen sc1 lds
    v_mfma_f32_16x16x32_bf16 v[58:61], a[60:63], v[46:49], v[58:61]
    ds_read_b128 v[46:49], v5 offset:22528
    v_mfma_f32_16x16x32_bf16 v[62:65], a[56:59], v[50:53], v[62:65]
    v_mfma_f32_16x16x32_bf16 v[66:69], a[60:63], v[50:53], v[66:69]
    ds_read_b128 v[50:53], v5 offset:23552
    s_waitcnt lgkmcnt(6)
    v_mfma_f32_16x16x32_bf16 v[54:57], a[64:67], v[22:25], v[54:57]
    s_add_u32 m0, s35, 7168
    s_add_u32 s28, s34, 20672
    buffer_load_dwordx4 v4, s[16:19], s28 offen sc1 lds
    v_mfma_f32_16x16x32_bf16 v[58:61], a[68:71], v[22:25], v[58:61]
    ds_read_b128 v[22:25], v5 offset:24576
    v_mfma_f32_16x16x32_bf16 v[62:65], a[64:67], v[26:29], v[62:65]
    v_mfma_f32_16x16x32_bf16 v[66:69], a[68:71], v[26:29], v[66:69]
    ds_read_b128 v[26:29], v5 offset:25600
    s_waitcnt lgkmcnt(6)
    v_mfma_f32_16x16x32_bf16 v[54:57], a[72:75], v[30:33], v[54:57]
    s_add_u32 m0, s35, 8192
    s_add_u32 s28, s34, 256
    buffer_load_dwordx4 v4, s[16:19], s28 offen sc1 lds
    v_mfma_f32_16x16x32_bf16 v[58:61], a[76:79], v[30:33], v[58:61]
    ds_read_b128 v[30:33], v5 offset:26624
    v_mfma_f32_16x16x32_bf16 v[62:65], a[72:75], v[34:37], v[62:65]
    v_mfma_f32_16x16x32_bf16 v[66:69], a[76:79], v[34:37], v[66:69]
    ds_read_b128 v[34:37], v5 offset:27648
    s_waitcnt lgkmcnt(6)
    v_mfma_f32_16x16x32_bf16 v[54:57], a[80:83], v[38:41], v[54:57]
    s_add_u32 m0, s35, 9216
    s_add_u32 s28, s34, 20736
    buffer_load_dwordx4 v4, s[16:19], s28 offen sc1 lds
    v_mfma_f32_16x16x32_bf16 v[58:61], a[84:87], v[38:41], v[58:61]
    ds_read_b128 v[38:41], v5 offset:28672
    v_mfma_f32_16x16x32_bf16 v[62:65], a[80:83], v[42:45], v[62:65]
    v_mfma_f32_16x16x32_bf16 v[66:69], a[84:87], v[42:45], v[66:69]
    ds_read_b128 v[42:45], v5 offset:29696
    s_waitcnt lgkmcnt(6)
    v_mfma_f32_16x16x32_bf16 v[54:57], a[88:91], v[46:49], v[54:57]
    s_add_u32 s34, s34, 81920
    s_add_u32 s35, s35, 40960
    s_cmp_ge_u32 s35, 122880
    s_cselect_b32 s28, 122880, 0
    s_sub_u32 s35, s35, s28
    v_mfma_f32_16x16x32_bf16 v[58:61], a[92:95], v[46:49], v[58:61]
    ds_read_b128 v[46:49], v5 offset:30720
    v_mfma_f32_16x16x32_bf16 v[62:65], a[88:91], v[50:53], v[62:65]
    v_mfma_f32_16x16x32_bf16 v[66:69], a[92:95], v[50:53], v[66:69]
    ds_read_b128 v[50:53], v5 offset:31744
    s_waitcnt lgkmcnt(6)
    v_mfma_f32_16x16x32_bf16 v[54:57], a[96:99], v[22:25], v[54:57]
    s_mov_b64 exec, s[14:15]
    buffer_store_dword v8, v0, s[16:19], s39 offen sc1
    s_mov_b64 exec, -1
    s_add_u32 s28, s36, 4096
    v_mfma_f32_16x16x32_bf16 v[58:61], a[100:103], v[22:25], v[58:61]
    ds_read_b128 v[22:25], v5 offset:32768
    v_mfma_f32_16x16x32_bf16 v[62:65], a[96:99], v[26:29], v[62:65]
    v_mfma_f32_16x16x32_bf16 v[66:69], a[100:103], v[26:29], v[66:69]
    ds_read_b128 v[26:29], v5 offset:33792
    s_waitcnt lgkmcnt(6)
    v_mfma_f32_16x16x32_bf16 v[54:57], a[104:107], v[30:33], v[54:57]
    s_mov_b64 exec, s[44:45]
    buffer_store_dwordx4 v[70:73], v1, s[16:19], s36 offen sc1
    s_mov_b64 exec, -1
    v_mfma_f32_16x16x32_bf16 v[58:61], a[108:111], v[30:33], v[58:61]
    ds_read_b128 v[30:33], v5 offset:34816
    v_mfma_f32_16x16x32_bf16 v[62:65], a[104:107], v[34:37], v[62:65]
    v_mfma_f32_16x16x32_bf16 v[66:69], a[108:111], v[34:37], v[66:69]
    ds_read_b128 v[34:37], v5 offset:35840
    s_waitcnt lgkmcnt(6)
    v_mfma_f32_16x16x32_bf16 v[54:57], a[112:115], v[38:41], v[54:57]
    s_mov_b64 exec, s[44:45]
    buffer_store_dwordx4 v[74:77], v1, s[16:19], s28 offen sc1
    s_mov_b64 exec, -1
    s_mov_b64 s[44:45], -1
    v_mfma_f32_16x16x32_bf16 v[58:61], a[116:119], v[38:41], v[58:61]
    ds_read_b128 v[38:41], v5 offset:36864
    v_mfma_f32_16x16x32_bf16 v[62:65], a[112:115], v[42:45], v[62:65]
    v_mfma_f32_16x16x32_bf16 v[66:69], a[116:119], v[42:45], v[66:69]
    ds_read_b128 v[42:45], v5 offset:37888
    s_waitcnt lgkmcnt(6)
    v_mfma_f32_16x16x32_bf16 v[54:57], a[120:123], v[46:49], v[54:57]
    v_mfma_f32_16x16x32_bf16 v[58:61], a[124:127], v[46:49], v[58:61]
    ds_read_b128 v[46:49], v5 offset:38912
    v_mfma_f32_16x16x32_bf16 v[62:65], a[120:123], v[50:53], v[62:65]
    v_mfma_f32_16x16x32_bf16 v[66:69], a[124:127], v[50:53], v[66:69]
    ds_read_b128 v[50:53], v5 offset:39936
    s_waitcnt lgkmcnt(6)
    v_mfma_f32_16x16x32_bf16 v[54:57], a[128:131], v[22:25], v[54:57]
    v_mfma_f32_16x16x32_bf16 v[58:61], a[132:135], v[22:25], v[58:61]
    v_mfma_f32_16x16x32_bf16 v[62:65], a[128:131], v[26:29], v[62:65]
    v_mfma_f32_16x16x32_bf16 v[66:69], a[132:135], v[26:29], v[66:69]
    s_waitcnt lgkmcnt(4)
    v_mfma_f32_16x16x32_bf16 v[54:57], a[136:139], v[30:33], v[54:57]
    v_mfma_f32_16x16x32_bf16 v[58:61], a[140:143], v[30:33], v[58:61]
    v_mfma_f32_16x16x32_bf16 v[62:65], a[136:139], v[34:37], v[62:65]
    v_mfma_f32_16x16x32_bf16 v[66:69], a[140:143], v[34:37], v[66:69]
    s_waitcnt lgkmcnt(2)
    v_mfma_f32_16x16x32_bf16 v[54:57], a[144:147], v[38:41], v[54:57]
    v_mfma_f32_16x16x32_bf16 v[58:61], a[148:151], v[38:41], v[58:61]
    v_mfma_f32_16x16x32_bf16 v[62:65], a[144:147], v[42:45], v[62:65]
    v_mfma_f32_16x16x32_bf16 v[66:69], a[148:151], v[42:45], v[66:69]
    s_waitcnt lgkmcnt(0)
    v_mfma_f32_16x16x32_bf16 v[54:57], a[152:155], v[46:49], v[54:57]
    v_mfma_f32_16x16x32_bf16 v[58:61], a[156:159], v[46:49], v[58:61]
    v_mfma_f32_16x16x32_bf16 v[62:65], a[152:155], v[50:53], v[62:65]
    v_mfma_f32_16x16x32_bf16 v[66:69], a[156:159], v[50:53], v[66:69]
    s_add_u32 s37, s37, 40960
    s_cmp_eq_u32 s37, 122880
    s_cselect_b32 s37, 0, s37
    s_add_u32 s36, s36, 524288
    s_nop 3
    v_cvt_pk_bf16_f32 v70, v54, v55
    v_cvt_pk_bf16_f32 v71, v56, v57
    v_cvt_pk_bf16_f32 v72, v58, v59
    v_cvt_pk_bf16_f32 v73, v60, v61
    v_cvt_pk_bf16_f32 v74, v62, v63
    v_cvt_pk_bf16_f32 v75, v64, v65
    v_cvt_pk_bf16_f32 v76, v66, v67
    v_cvt_pk_bf16_f32 v77, v68, v69
    s_add_u32 s12, s12, 1
    s_cmp_lt_u32 s12, 32
    s_cbranch_scc1 t1l_21
    s_add_u32 s28, s36, 4096
    buffer_store_dwordx4 v[70:73], v1, s[16:19], s36 offen sc1
    buffer_store_dwordx4 v[74:77], v1, s[16:19], s28 offen sc1
    s_branch t1d_17
t1v_16:
    s_lshl_b32 s28, s11, 11
    s_add_u32 s36, s36, s28
    s_sub_u32 s36, s36, 524288
    s_waitcnt vmcnt(29)
    s_branch t1l_22x
t1l_22:
    s_waitcnt vmcnt(16)
t1l_22x:
    s_barrier
    v_add_u32 v5, s37, v14
    ds_read_b128 v[22:25], v5 offset:0
    ds_read_b128 v[26:29], v5 offset:1024
    ds_read_b128 v[30:33], v5 offset:2048
    ds_read_b128 v[34:37], v5 offset:3072
    ds_read_b128 v[38:41], v5 offset:4096
    ds_read_b128 v[42:45], v5 offset:5120
    ds_read_b128 v[46:49], v5 offset:6144
    ds_read_b128 v[50:53], v5 offset:7168
    s_max_u32 s28, s12, 3
    s_sub_u32 s28, s28, 3
    v_mov_b32 v8, s28
    s_waitcnt lgkmcnt(6)
    v_mfma_f32_16x16x32_bf16 v[54:57], v[22:25], a[0:3], 0
    v_mfma_f32_16x16x32_bf16 v[58:61], v[22:25], a[4:7], 0
    ds_read_b128 v[22:25], v5 offset:8192
    v_mfma_f32_16x16x32_bf16 v[62:65], v[26:29], a[0:3], 0
    v_mfma_f32_16x16x32_bf16 v[66:69], v[26:29], a[4:7], 0
    ds_read_b128 v[26:29], v5 offset:9216
    s_waitcnt lgkmcnt(6)
    v_mfma_f32_16x16x32_bf16 v[54:57], v[30:33], a[8:11], v[54:57]
    s_add_u32 m0, s35, 0
    s_add_u32 s28, s34, 0
    buffer_load_dwordx4 v4, s[16:19], s28 offen sc1 lds
    v_mfma_f32_16x16x32_bf16 v[58:61], v[30:33], a[12:15], v[58:61]
    ds_read_b128 v[30:33], v5 offset:10240
    v_mfma_f32_16x16x32_bf16 v[62:65], v[34:37], a[8:11], v[62:65]
    v_mfma_f32_16x16x32_bf16 v[66:69], v[34:37], a[12:15], v[66:69]
    ds_read_b128 v[34:37], v5 offset:11264
    s_waitcnt lgkmcnt(6)
    v_mfma_f32_16x16x32_bf16 v[54:57], v[38:41], a[16:19], v[54:57]
    s_add_u32 m0, s35, 1024
    s_add_u32 s28, s34, 20480
    buffer_load_dwordx4 v4, s[16:19], s28 offen sc1 lds
    v_mfma_f32_16x16x32_bf16 v[58:61], v[38:41], a[20:23], v[58:61]
    ds_read_b128 v[38:41], v5 offset:12288
    v_mfma_f32_16x16x32_bf16 v[62:65], v[42:45], a[16:19], v[62:65]
    v_mfma_f32_16x16x32_bf16 v[66:69], v[42:45], a[20:23], v[66:69]
    ds_read_b128 v[42:45], v5 offset:13312
    s_waitcnt lgkmcnt(6)
    v_mfma_f32_16x16x32_bf16 v[54:57], v[46:49], a[24:27], v[54:57]
    s_add_u32 m0, s35, 2048
    s_add_u32 s28, s34, 64
    buffer_load_dwordx4 v4, s[16:19], s28 offen sc1 lds
    v_mfma_f32_16x16x32_bf16 v[58:61], v[46:49], a[28:31], v[58:61]
    ds_read_b128 v[46:49], v5 offset:14336
    v_mfma_f32_16x16x32_bf16 v[62:65], v[50:53], a[24:27], v[62:65]
    v_mfma_f32_16x16x32_bf16 v[66:69], v[50:53], a[28:31], v[66:69]
    ds_read_b128 v[50:53], v5 offset:15360
    s_waitcnt lgkmcnt(6)
    v_mfma_f32_16x16x32_bf16 v[54:57], v[22:25], a[32:35], v[54:57]
    s_add_u32 m0, s35, 3072
    s_add_u32 s28, s34, 20544
    buffer_load_dwordx4 v4, s[16:19], s28 offen sc1 lds
    v_mfma_f32_16x16x32_bf16 v[58:61], v[22:25], a[36:39], v[58:61]
    ds_read_b128 v[22:25], v5 offset:16384
    v_mfma_f32_16x16x32_bf16 v[62:65], v[26:29], a[32:35], v[62:65]
    v_mfma_f32_16x16x32_bf16 v[66:69], v[26:29], a[36:39], v[66:69]
    ds_read_b128 v[26:29], v5 offset:17408
    s_waitcnt lgkmcnt(6)
    v_mfma_f32_16x16x32_bf16 v[54:57], v[30:33], a[40:43], v[54:57]
    s_add_u32 m0, s35, 4096
    s_add_u32 s28, s34, 128
    buffer_load_dwordx4 v4, s[16:19], s28 offen sc1 lds
    v_mfma_f32_16x16x32_bf16 v[58:61], v[30:33], a[44:47], v[58:61]
    ds_read_b128 v[30:33], v5 offset:18432
    v_mfma_f32_16x16x32_bf16 v[62:65], v[34:37], a[40:43], v[62:65]
    v_mfma_f32_16x16x32_bf16 v[66:69], v[34:37], a[44:47], v[66:69]
    ds_read_b128 v[34:37], v5 offset:19456
    s_waitcnt lgkmcnt(6)
    v_mfma_f32_16x16x32_bf16 v[54:57], v[38:41], a[48:51], v[54:57]
    s_add_u32 m0, s35, 5120
    s_add_u32 s28, s34, 20608
    buffer_load_dwordx4 v4, s[16:19], s28 offen sc1 lds
    v_mfma_f32_16x16x32_bf16 v[58:61], v[38:41], a[52:55], v[58:61]
    ds_read_b128 v[38:41], v5 offset:20480
    v_mfma_f32_16x16x32_bf16 v[62:65], v[42:45], a[48:51], v[62:65]
    v_mfma_f32_16x16x32_bf16 v[66:69], v[42:45], a[52:55], v[66:69]
    ds_read_b128 v[42:45], v5 offset:21504
    s_waitcnt lgkmcnt(6)
    v_mfma_f32_16x16x32_bf16 v[54:57], v[46:49], a[56:59], v[54:57]
    s_add_u32 m0, s35, 6144
    s_add_u32 s28, s34, 192
    buffer_load_dwordx4 v4, s[16:19], s28 offen sc1 lds
    v_mfma_f32_16x16x32_bf16 v[58:61], v[46:49], a[60:63], v[58:61]
    ds_read_b128 v[46:49], v5 offset:22528
    v_mfma_f32_16x16x32_bf16 v[62:65], v[50:53], a[56:59], v[62:65]
    v_mfma_f32_16x16x32_bf16 v[66:69], v[50:53], a[60:63], v[66:69]
    ds_read_b128 v[50:53], v5 offset:23552
    s_waitcnt lgkmcnt(6)
    v_mfma_f32_16x16x32_bf16 v[54:57], v[22:25], a[64:67], v[54:57]
    s_add_u32 m0, s35, 7168
    s_add_u32 s28, s34, 20672
    buffer_load_dwordx4 v4, s[16:19], s28 offen sc1 lds
    v_mfma_f32_16x16x32_bf16 v[58:61], v[22:25], a[68:71], v[58:61]
    ds_read_b128 v[22:25], v5 offset:24576
    v_mfma_f32_16x16x32_bf16 v[62:65], v[26:29], a[64:67], v[62:65]
    v_mfma_f32_16x16x32_bf16 v[66:69], v[26:29], a[68:71], v[66:69]
    ds_read_b128 v[26:29], v5 offset:25600
    s_waitcnt lgkmcnt(6)
    v_mfma_f32_16x16x32_bf16 v[54:57], v[30:33], a[72:75], v[54:57]
    s_add_u32 m0, s35, 8192
    s_add_u32 s28, s34, 256
    buffer_load_dwordx4 v4, s[16:19], s28 offen sc1 lds
    v_mfma_f32_16x16x32_bf16 v[58:61], v[30:33], a[76:79], v[58:61]
    ds_read_b128 v[30:33], v5 offset:26624
    v_mfma_f32_16x16x32_bf16 v[62:65], v[34:37], a[72:75], v[62:65]
    v_mfma_f32_16x16x32_bf16 v[66:69], v[34:37], a[76:79], v[66:69]
    ds_read_b128 v[34:37], v5 offset:27648
    s_waitcnt lgkmcnt(6)
    v_mfma_f32_16x16x32_bf16 v[54:57], v[38:41], a[80:83], v[54:57]
    s_add_u32 m0, s35, 9216
    s_add_u32 s28, s34, 20736
    buffer_load_dwordx4 v4, s[16:19], s28 offen sc1 lds
    v_mfma_f32_16x16x32_bf16 v[58:61], v[38:41], a[84:87], v[58:61]
    ds_read_b128 v[38:41], v5 offset:28672
    v_mfma_f32_16x16x32_bf16 v[62:65], v[42:45], a[80:83], v[62:65]
    v_mfma_f32_16x16x32_bf16 v[66:69], v[42:45], a[84:87], v[66:69]
    ds_read_b128 v[42:45], v5 offset:29696
    s_waitcnt lgkmcnt(6)
    v_mfma_f32_16x16x32_bf16 v[54:57], v[46:49], a[88:91], v[54:57]
    s_add_u32 s34, s34, 81920
    s_add_u32 s35, s35, 40960
    s_cmp_ge_u32 s35, 122880
    s_cselect_b32 s28, 122880, 0
    s_sub_u32 s35, s35, s28
    v_mfma_f32_16x16x32_bf16 v[58:61], v[46:49], a[92:95], v[58:61]
    ds_read_b128 v[46:49], v5 offset:30720
    v_mfma_f32_16x16x32_bf16 v[62:65], v[50:53], a[88:91], v[62:65]
    v_mfma_f32_16x16x32_bf16 v[66:69], v[50:53], a[92:95], v[66:69]
    ds_read_b128 v[50:53], v5 offset:31744
    s_waitcnt lgkmcnt(6)
    v_mfma_f32_16x16x32_bf16 v[54:57], v[22:25], a[96:99], v[54:57]
    s_mov_b64 exec, s[14:15]
    buffer_store_dword v8, v0, s[16:19], s39 offen sc1
    s_mov_b64 exec, -1
    s_add_u32 s28, s36, 1024
    v_mfma_f32_16x16x32_bf16 v[58:61], v[22:25], a[100:103], v[58:61]
    ds_read_b128 v[22:25], v5 offset:32768
    v_mfma_f32_16x16x32_bf16 v[62:65], v[26:29], a[96:99], v[62:65]
    v_mfma_f32_16x16x32_bf16 v[66:69], v[26:29], a[100:103], v[66:69]
    ds_read_b128 v[26:29], v5 offset:33792
    s_waitcnt lgkmcnt(6)
    v_mfma_f32_16x16x32_bf16 v[54:57], v[30:33], a[104:107], v[54:57]
    s_mov_b64 exec, s[44:45]
    buffer_store_dwordx4 v[70:73], v1, s[16:19], s36 offen sc1
    s_mov_b64 exec, -1
    v_mfma_f32_16x16x32_bf16 v[58:61], v[30:33], a[108:111], v[58:61]
    ds_read_b128 v[30:33], v5 offset:34816
    v_mfma_f32_16x16x32_bf16 v[62:65], v[34:37], a[104:107], v[62:65]
    v_mfma_f32_16x16x32_bf16 v[66:69], v[34:37], a[108:111], v[66:69]
    ds_read_b128 v[34:37], v5 offset:35840
    s_waitcnt lgkmcnt(6)
    v_mfma_f32_16x16x32_bf16 v[54:57], v[38:41], a[112:115], v[54:57]
    s_mov_b64 exec, s[44:45]
    buffer_store_dwordx4 v[74:77], v1, s[16:19], s28 offen sc1
    s_mov_b64 exec, -1
    s_mov_b64 s[44:45], -1
    v_mfma_f32_16x16x32_bf16 v[58:61], v[38:41], a[116:119], v[58:61]
    ds_read_b128 v[38:41], v5 offset:36864
    v_mfma_f32_16x16x32_bf16 v[62:65], v[42:45], a[112:115], v[62:65]
    v_mfma_f32_16x16x32_bf16 v[66:69], v[42:45], a[116:119], v[66:69]
    ds_read_b128 v[42:45], v5 offset:37888
    s_waitcnt lgkmcnt(6)
    v_mfma_f32_16x16x32_bf16 v[54:57], v[46:49], a[120:123], v[54:57]
    v_mfma_f32_16x16x32_bf16 v[58:61], v[46:49], a[124:127], v[58:61]
    ds_read_b128 v[46:49], v5 offset:38912
    v_mfma_f32_16x16x32_bf16 v[62:65], v[50:53], a[120:123], v[62:65]
    v_mfma_f32_16x16x32_bf16 v[66:69], v[50:53], a[124:127], v[66:69]
    ds_read_b128 v[50:53], v5 offset:39936
    s_waitcnt lgkmcnt(6)
    v_mfma_f32_16x16x32_bf16 v[54:57], v[22:25], a[128:131], v[54:57]
    v_mfma_f32_16x16x32_bf16 v[58:61], v[22:25], a[132:135], v[58:61]
    v_mfma_f32_16x16x32_bf16 v[62:65], v[26:29], a[128:131], v[62:65]
    v_mfma_f32_16x16x32_bf16 v[66:69], v[26:29], a[132:135], v[66:69]
    s_waitcnt lgkmcnt(4)
    v_mfma_f32_16x16x32_bf16 v[54:57], v[30:33], a[136:139], v[54:57]
    v_mfma_f32_16x16x32_bf16 v[58:61], v[30:33], a[140:143], v[58:61]
    v_mfma_f32_16x16x32_bf16 v[62:65], v[34:37], a[136:139], v[62:65]
    v_mfma_f32_16x16x32_bf16 v[66:69], v[34:37], a[140:143], v[66:69]
    s_waitcnt lgkmcnt(2)
    v_mfma_f32_16x16x32_bf16 v[54:57], v[38:41], a[144:147], v[54:57]
    v_mfma_f32_16x16x32_bf16 v[58:61], v[38:41], a[148:151], v[58:61]
    v_mfma_f32_16x16x32_bf16 v[62:65], v[42:45], a[144:147], v[62:65]
    v_mfma_f32_16x16x32_bf16 v[66:69], v[42:45], a[148:151], v[66:69]
    s_waitcnt lgkmcnt(0)
    v_mfma_f32_16x16x32_bf16 v[54:57], v[46:49], a[152:155], v[54:57]
    v_mfma_f32_16x16x32_bf16 v[58:61], v[46:49], a[156:159], v[58:61]
    v_mfma_f32_16x16x32_bf16 v[62:65], v[50:53], a[152:155], v[62:65]
    v_mfma_f32_16x16x32_bf16 v[66:69], v[50:53], a[156:159], v[66:69]
    s_add_u32 s37, s37, 40960
    s_cmp_eq_u32 s37, 122880
    s_cselect_b32 s37, 0, s37
    s_add_u32 s36, s36, 524288
    s_nop 3
    v_cvt_pk_bf16_f32 v70, v54, v55
    v_cvt_pk_bf16_f32 v71, v56, v57
    v_cvt_pk_bf16_f32 v72, v62, v63
    v_cvt_pk_bf16_f32 v73, v64, v65
    v_cvt_pk_bf16_f32 v74, v58, v59
    v_cvt_pk_bf16_f32 v75, v60, v61
    v_cvt_pk_bf16_f32 v76, v66, v67
    v_cvt_pk_bf16_f32 v77, v68, v69
    s_add_u32 s12, s12, 1
    s_cmp_lt_u32 s12, 32
    s_cbranch_scc1 t1l_22
    s_add_u32 s28, s36, 1024
    buffer_store_dwordx4 v[70:73], v1, s[16:19], s36 offen sc1
    buffer_store_dwordx4 v[74:77], v1, s[16:19], s28 offen sc1
    s_branch t1d_17
t1d_17:
    s_waitcnt vmcnt(0)
    s_barrier
    v_mov_b32 v8, s12
    s_mov_b64 exec, s[14:15]
    buffer_store_dword v8, v0, s[16:19], s39 offen sc1
    s_mov_b64 exec, -1
    s_cmp_lt_u32 s10, 0
    s_cbranch_scc1 role_23
    s_cmp_ge_u32 s10, 32
    s_cbranch_scc1 role_23
    s_sub_u32 s39, s10, 0
    s_lshl_b32 s39, s39, 2
    s_add_u32 s39, s39, 69731584
    s_and_b32 s40, s11, 1
    s_lshr_b32 s41, s11, 1
    s_lshl_b32 s34, s10, 13
    s_lshr_b32 s28, s10, 1
    s_lshl_b32 s35, s28, 14
    s_and_b32 s28, s10, 1
    s_lshl_b32 s28, s28, 12
    s_add_u32 s35, s35, s28
    s_add_u32 s35, s35, 50331648
    s_lshl_b32 s36, s40, 17
    s_lshl_b32 s28, s10, 12
    s_add_u32 s36, s36, s28
    s_lshl_b32 s28, s41, 11
    s_add_u32 s36, s36, s28
    s_add_u32 s36, s36, 117440512
    v_lshrrev_b32 v166, 2, v0
    v_lshlrev_b32 v166, 3, v166
    v_and_b32 v10, 1, v0
    v_lshl_add_u32 v166, v10, 7, v166
    v_and_b32 v10, 1, v3
    v_lshlrev_b32 v167, 7, v10
    v_lshl_add_u32 v167, v2, 3, v167
    s_lshl_b32 s28, s41, 10
    s_add_u32 s28, s28, 2048
    v_add_u32 v167, s28, v167
    s_mov_b32 s44, 0x3e0293ee
    s_mov_b32 s45, 0x3e0293ee
    v_mov_b32 v11, 0xf149f2ca
    s_lshl_b32 s28, s40, 4
    v_add_u32 v10, s28, v2
    v_lshl_add_u32 v9, v3, 2, 0
    v_cmp_gt_u32 vcc, v9, v10
    s_nop 1
    v_cndmask_b32 v102, 0, v11, vcc
    v_lshl_add_u32 v9, v3, 2, 1
    v_cmp_gt_u32 vcc, v9, v10
    s_nop 1
    v_cndmask_b32 v103, 0, v11, vcc
    v_lshl_add_u32 v9, v3, 2, 2
    v_cmp_gt_u32 vcc, v9, v10
    s_nop 1
    v_cndmask_b32 v104, 0, v11, vcc
    v_lshl_add_u32 v9, v3, 2, 3
    v_cmp_gt_u32 vcc, v9, v10
    s_nop 1
    v_cndmask_b32 v105, 0, v11, vcc
    v_lshl_add_u32 v9, v3, 2, 16
    v_cmp_gt_u32 vcc, v9, v10
    s_nop 1
    v_cndmask_b32 v106, 0, v11, vcc
    v_lshl_add_u32 v9, v3, 2, 17
    v_cmp_gt_u32 vcc, v9, v10
    s_nop 1
    v_cndmask_b32 v107, 0, v11, vcc
    v_lshl_add_u32 v9, v3, 2, 18
    v_cmp_gt_u32 vcc, v9, v10
    s_nop 1
    v_cndmask_b32 v108, 0, v11, vcc
    v_lshl_add_u32 v9, v3, 2, 19
    v_cmp_gt_u32 vcc, v9, v10
    s_nop 1
    v_cndmask_b32 v109, 0, v11, vcc
    v_cmp_lt_u32 vcc, 1, v3
    s_nop 1
    v_cndmask_b32 v110, 0, v11, vcc
    v_cndmask_b32 v111, 0, v11, vcc
    v_cndmask_b32 v112, 0, v11, vcc
    v_cndmask_b32 v113, 0, v11, vcc
    v_mov_b32 v134, 0x3f803f80
    v_mov_b32 v135, 0x3f803f80
    v_mov_b32 v136, 0x3f803f80
    v_mov_b32 v137, 0x3f803f80
    v_mov_b32 v9, 36
bi_24:
    s_sub_u32 s88, s88, 1
    s_cbranch_scc1 k_end
    global_load_dword v8, v9, s[6:7] sc1
    s_waitcnt vmcnt(0)
    v_cmp_eq_u32 vcc, 0, v8
    s_cbranch_vccnz bi_24
    v_readfirstlane_b32 s28, v8
    s_and_b32 s28, s28, 2
    s_lshl_b32 s28, s28, 12
    s_add_u32 s35, s35, s28
    s_lshl_b32 s54, s10, 2
    v_mul_u32_u24 v6, 128, v0
    v_add_u32 v6, s54, v6
    v_add_u32 v6, 69730560, v6
    s_mov_b32 s28, 32
    v_mov_b32 v7, s28
    v_cmp_gt_u32 vcc, 6, v0
    s_nop 1
    v_cndmask_b32 v7, 0, v7, vcc
bw_25:
    s_sub_u32 s88, s88, 1
    s_cbranch_scc1 k_end
    s_mov_b64 exec, 63
    buffer_load_dword v12, v6, s[16:19], 0 offen sc1
    s_mov_b64 exec, -1
    s_waitcnt vmcnt(0)
bk_26:
    v_cmp_lt_u32 vcc, v12, v7
    s_cbranch_vccnz bw_25
    v_mul_u32_u24 v6, 128, v0
    v_add_u32 v6, s54, v6
    v_add_u32 v6, 69731328, v6
    s_mov_b32 s12, 0
    s_lshl_b32 s28, s40, 12
    s_add_u32 s28, s28, s34
    s_add_u32 s28, s28, 33554432
    buffer_load_dwordx4 v[14:17], v1, s[16:19], s28 offen offset:0 sc1
    buffer_load_dwordx4 v[18:21], v1, s[16:19], s28 offen offset:1024 sc1
    buffer_load_dwordx4 v[22:25], v1, s[16:19], s28 offen offset:2048 sc1
    buffer_load_dwordx4 v[26:29], v1, s[16:19], s28 offen offset:3072 sc1
    s_lshl_b32 s29, s11, 11
    s_add_u32 m0, s29, 4096
    s_add_u32 s28, s34, s29
    buffer_load_dwordx4 v1, s[16:19], s28 offen offset:0 sc1 lds
    buffer_load_dwordx4 v1, s[16:19], s28 offen offset:1024 sc1 lds
    s_lshl_b32 s28, s41, 12
    s_add_u32 s28, s28, s34
    s_add_u32 s28, s28, 16777216
    buffer_load_dwordx4 v[62:65], v1, s[16:19], s28 offen offset:0 sc1
    buffer_load_dwordx4 v[66:69], v1, s[16:19], s28 offen offset:1024 sc1
    buffer_load_dwordx4 v[70:73], v1, s[16:19], s28 offen offset:2048 sc1
    buffer_load_dwordx4 v[74:77], v1, s[16:19], s28 offen offset:3072 sc1
    s_add_u32 s28, s12, 1
    v_mov_b32 v7, s28
    v_cmp_gt_u32 vcc, 2, v0
    s_nop 1
    v_cndmask_b32 v7, 0, v7, vcc
    s_mov_b64 exec, 3
    buffer_load_dword v12, v6, s[16:19], 0 offen sc1
    s_mov_b64 exec, -1
    s_waitcnt vmcnt(0)
    s_barrier
att_27:
    ds_read_b128 v[30:33], v1 offset:4096
    ds_read_b128 v[46:49], v1 offset:8192
    ds_read_b128 v[34:37], v1 offset:5120
    ds_read_b128 v[50:53], v1 offset:9216
    ds_read_b128 v[38:41], v1 offset:6144
    ds_read_b128 v[54:57], v1 offset:10240
    ds_read_b128 v[42:45], v1 offset:7168
    ds_read_b128 v[58:61], v1 offset:11264
    s_waitcnt lgkmcnt(6)
    v_mfma_f32_16x16x32_bf16 v[114:117], v[30:33], v[14:17], v[102:105]
    v_mfma_f32_16x16x32_bf16 v[118:121], v[46:49], v[14:17], v[106:109]
    s_waitcnt lgkmcnt(4)
    v_mfma_f32_16x16x32_bf16 v[114:117], v[34:37], v[18:21], v[114:117]
    v_mfma_f32_16x16x32_bf16 v[118:121], v[50:53], v[18:21], v[118:121]
    s_waitcnt lgkmcnt(2)
    v_mfma_f32_16x16x32_bf16 v[114:117], v[38:41], v[22:25], v[114:117]
    v_mfma_f32_16x16x32_bf16 v[118:121], v[54:57], v[22:25], v[118:121]
    s_waitcnt lgkmcnt(0)
    v_mfma_f32_16x16x32_bf16 v[114:117], v[42:45], v[26:29], v[114:117]
    v_mfma_f32_16x16x32_bf16 v[118:121], v[58:61], v[26:29], v[118:121]
    s_branch bk_29
bw_28:
    s_sub_u32 s88, s88, 1
    s_cbranch_scc1 k_end
    s_mov_b64 exec, 3
    buffer_load_dword v12, v6, s[16:19], 0 offen sc1
    s_mov_b64 exec, -1
    s_waitcnt vmcnt(0)
bk_29:
    v_cmp_lt_u32 vcc, v12, v7
    s_cbranch_vccnz bw_28
    s_and_b32 s28, s11, 1
    s_lshl_b32 m0, s28, 10
    s_add_u32 s28, s35, m0
    buffer_load_dwordx4 v1, s[16:19], s28 offen sc1 lds
    buffer_load_dwordx2 v[78:79], v167, s[16:19], s35 offen offset:0 sc1
    buffer_load_dwordx2 v[80:81], v167, s[16:19], s35 offen offset:256 sc1
    buffer_load_dwordx2 v[82:83], v167, s[16:19], s35 offen offset:512 sc1
    buffer_load_dwordx2 v[84:85], v167, s[16:19], s35 offen offset:768 sc1
    s_add_u32 s12, s12, 1
    s_add_u32 s34, s34, 0x40000
    s_cmp_eq_u32 s12, 64
    s_cselect_b64 exec, 0, -1
    s_lshl_b32 s28, s40, 12
    s_add_u32 s28, s28, s34
    s_add_u32 s28, s28, 33554432
    buffer_load_dwordx4 v[170:173], v1, s[16:19], s28 offen offset:0 sc1
    buffer_load_dwordx4 v[174:177], v1, s[16:19], s28 offen offset:1024 sc1
    buffer_load_dwordx4 v[178:181], v1, s[16:19], s28 offen offset:2048 sc1
    buffer_load_dwordx4 v[182:185], v1, s[16:19], s28 offen offset:3072 sc1
    s_lshl_b32 s29, s11, 11
    s_add_u32 m0, s29, 12288
    s_add_u32 s28, s34, s29
    buffer_load_dwordx4 v1, s[16:19], s28 offen offset:0 sc1 lds
    buffer_load_dwordx4 v1, s[16:19], s28 offen offset:1024 sc1 lds
    s_lshl_b32 s28, s41, 12
    s_add_u32 s28, s28, s34
    s_add_u32 s28, s28, 16777216
    buffer_load_dwordx4 v[186:189], v1, s[16:19], s28 offen offset:0 sc1
    buffer_load_dwordx4 v[190:193], v1, s[16:19], s28 offen offset:1024 sc1
    buffer_load_dwordx4 v[194:197], v1, s[16:19], s28 offen offset:2048 sc1
    buffer_load_dwordx4 v[198:201], v1, s[16:19], s28 offen offset:3072 sc1
    s_mov_b64 exec, -1
    v_max3_f32 v8, v114, v115, v116
    v_max3_f32 v8, v8, v117, v118
    v_max3_f32 v8, v8, v119, v120
    v_max_f32 v8, v8, v121
    s_waitcnt vmcnt(14)
    s_barrier
    ds_read_b64_tr_b16 v[86:87], v166 offset:0
    ds_read_b64_tr_b16 v[88:89], v166 offset:256
    ds_read_b64_tr_b16 v[90:91], v166 offset:512
    ds_read_b64_tr_b16 v[92:93], v166 offset:768
    ds_read_b64_tr_b16 v[94:95], v166 offset:1024
    ds_read_b64_tr_b16 v[96:97], v166 offset:1280
    ds_read_b64_tr_b16 v[98:99], v166 offset:1536
    ds_read_b64_tr_b16 v[100:101], v166 offset:1792
    s_waitcnt lgkmcnt(6)
    v_mfma_f32_16x16x32_bf16 v[122:125], v[86:89], v[14:17], v[110:113]
    s_waitcnt lgkmcnt(4)
    v_mfma_f32_16x16x32_bf16 v[122:125], v[90:93], v[18:21], v[122:125]
    s_waitcnt lgkmcnt(2)
    v_mfma_f32_16x16x32_bf16 v[122:125], v[94:97], v[22:25], v[122:125]
    s_waitcnt lgkmcnt(0)
    v_mfma_f32_16x16x32_bf16 v[122:125], v[98:101], v[26:29], v[122:125]
    s_add_u32 s28, s12, 1
    v_mov_b32 v7, s28
    v_cmp_gt_u32 vcc, 2, v0
    s_nop 1
    v_cndmask_b32 v7, 0, v7, vcc
    s_nop 2
    v_max3_f32 v8, v8, v122, v123
    v_max3_f32 v8, v8, v124, v125
    v_mov_b32 v9, v8
    s_nop 1
    v_permlane16_swap_b32 v8, v9
    v_max_f32 v8, v8, v9
    v_mov_b32 v9, v8
    s_nop 1
    v_permlane32_swap_b32 v8, v9
    v_max_f32 v8, v8, v9
    v_mul_f32 v10, s44, v8
    v_pk_fma_f32 v[114:115], v[114:115], s[44:45], v[10:11] op_sel_hi:[1,1,0] neg_lo:[0,0,1] neg_hi:[0,0,1]
    v_pk_fma_f32 v[116:117], v[116:117], s[44:45], v[10:11] op_sel_hi:[1,1,0] neg_lo:[0,0,1] neg_hi:[0,0,1]
    v_pk_fma_f32 v[118:119], v[118:119], s[44:45], v[10:11] op_sel_hi:[1,1,0] neg_lo:[0,0,1] neg_hi:[0,0,1]
    v_pk_fma_f32 v[120:121], v[120:121], s[44:45], v[10:11] op_sel_hi:[1,1,0] neg_lo:[0,0,1] neg_hi:[0,0,1]
    v_pk_fma_f32 v[122:123], v[122:123], s[44:45], v[10:11] op_sel_hi:[1,1,0] neg_lo:[0,0,1] neg_hi:[0,0,1]
    v_pk_fma_f32 v[124:125], v[124:125], s[44:45], v[10:11] op_sel_hi:[1,1,0] neg_lo:[0,0,1] neg_hi:[0,0,1]
    v_exp_f32 v114, v114
    v_exp_f32 v115, v115
    v_exp_f32 v116, v116
    v_exp_f32 v117, v117
    v_exp_f32 v118, v118
    v_exp_f32 v119, v119
    v_exp_f32 v120, v120
    v_exp_f32 v121, v121
    v_exp_f32 v122, v122
    v_exp_f32 v123, v123
    v_exp_f32 v124, v124
    v_exp_f32 v125, v125
    v_cvt_pk_bf16_f32 v126, v114, v115
    v_cvt_pk_bf16_f32 v127, v116, v117
    v_cvt_pk_bf16_f32 v128, v118, v119
    v_cvt_pk_bf16_f32 v129, v120, v121
    v_cvt_pk_bf16_f32 v130, v122, v123
    v_cvt_pk_bf16_f32 v131, v124, v125
    s_waitcnt vmcnt(10)
    v_mfma_f32_16x16x32_bf16 v[138:141], v[134:137], v[126:129], 0
    v_mfma_f32_16x16x32_bf16 v[142:145], v[62:65], v[126:129], 0
    v_mfma_f32_16x16x32_bf16 v[146:149], v[66:69], v[126:129], 0
    v_mfma_f32_16x16x32_bf16 v[150:153], v[70:73], v[126:129], 0
    v_mfma_f32_16x16x32_bf16 v[154:157], v[74:77], v[126:129], 0
    v_mfma_f32_16x16x16_bf16 v[138:141], v[134:135], v[130:131], v[138:141]
    v_mfma_f32_16x16x16_bf16 v[142:145], v[78:79], v[130:131], v[142:145]
    v_mfma_f32_16x16x16_bf16 v[146:149], v[80:81], v[130:131], v[146:149]
    v_mfma_f32_16x16x16_bf16 v[150:153], v[82:83], v[130:131], v[150:153]
    v_mfma_f32_16x16x16_bf16 v[154:157], v[84:85], v[130:131], v[154:157]
    v_rcp_f32 v10, v138
    s_nop 6
    v_pk_mul_f32 v[142:143], v[142:143], v[10:11] op_sel_hi:[1,0]
    v_pk_mul_f32 v[144:145], v[144:145], v[10:11] op_sel_hi:[1,0]
    v_pk_mul_f32 v[146:147], v[146:147], v[10:11] op_sel_hi:[1,0]
    v_pk_mul_f32 v[148:149], v[148:149], v[10:11] op_sel_hi:[1,0]
    v_pk_mul_f32 v[150:151], v[150:151], v[10:11] op_sel_hi:[1,0]
    v_pk_mul_f32 v[152:153], v[152:153], v[10:11] op_sel_hi:[1,0]
    v_pk_mul_f32 v[154:155], v[154:155], v[10:11] op_sel_hi:[1,0]
    v_pk_mul_f32 v[156:157], v[156:157], v[10:11] op_sel_hi:[1,0]
    v_cvt_pk_bf16_f32 v158, v142, v143
    v_cvt_pk_bf16_f32 v159, v144, v145
    v_cvt_pk_bf16_f32 v160, v146, v147
    v_cvt_pk_bf16_f32 v161, v148, v149
    v_cvt_pk_bf16_f32 v162, v150, v151
    v_cvt_pk_bf16_f32 v163, v152, v153
    v_cvt_pk_bf16_f32 v164, v154, v155
    v_cvt_pk_bf16_f32 v165, v156, v157
    buffer_store_dwordx4 v[158:161], v1, s[16:19], s36 offen offset:0 sc1
    buffer_store_dwordx4 v[162:165], v1, s[16:19], s36 offen offset:1024 sc1
    s_mov_b64 exec, 3
    buffer_load_dword v12, v6, s[16:19], 0 offen sc1
    s_mov_b64 exec, -1
    s_add_u32 s36, s36, 262144
    s_add_u32 s35, s35, 0x40000
    s_and_b32 s28, s12, 7
    s_cselect_b32 s28, 0, 0x2000
    s_xor_b32 s35, s35, s28
    s_waitcnt vmcnt(0)
    s_barrier
    v_mov_b32 v8, s12
    s_mov_b64 exec, s[14:15]
    buffer_store_dword v8, v0, s[16:19], s39 offen sc1
    s_mov_b64 exec, -1
    ds_read_b128 v[30:33], v1 offset:12288
    ds_read_b128 v[46:49], v1 offset:16384
    ds_read_b128 v[34:37], v1 offset:13312
    ds_read_b128 v[50:53], v1 offset:17408
    ds_read_b128 v[38:41], v1 offset:14336
    ds_read_b128 v[54:57], v1 offset:18432
    ds_read_b128 v[42:45], v1 offset:15360
    ds_read_b128 v[58:61], v1 offset:19456
    s_waitcnt lgkmcnt(6)
    v_mfma_f32_16x16x32_bf16 v[114:117], v[30:33], v[170:173], v[102:105]
    v_mfma_f32_16x16x32_bf16 v[118:121], v[46:49], v[170:173], v[106:109]
    s_waitcnt lgkmcnt(4)
    v_mfma_f32_16x16x32_bf16 v[114:117], v[34:37], v[174:177], v[114:117]
    v_mfma_f32_16x16x32_bf16 v[118:121], v[50:53], v[174:177], v[118:121]
    s_waitcnt lgkmcnt(2)
    v_mfma_f32_16x16x32_bf16 v[114:117], v[38:41], v[178:181], v[114:117]
    v_mfma_f32_16x16x32_bf16 v[118:121], v[54:57], v[178:181], v[118:121]
    s_waitcnt lgkmcnt(0)
    v_mfma_f32_16x16x32_bf16 v[114:117], v[42:45], v[182:185], v[114:117]
    v_mfma_f32_16x16x32_bf16 v[118:121], v[58:61], v[182:185], v[118:121]
    s_branch bk_32
bw_31:
    s_sub_u32 s88, s88, 1
    s_cbranch_scc1 k_end
    s_mov_b64 exec, 3
    buffer_load_dword v12, v6, s[16:19], 0 offen sc1
    s_mov_b64 exec, -1
    s_waitcnt vmcnt(0)
bk_32:
    v_cmp_lt_u32 vcc, v12, v7
    s_cbranch_vccnz bw_31
    s_and_b32 s28, s11, 1
    s_lshl_b32 m0, s28, 10
    s_add_u32 s28, s35, m0
    buffer_load_dwordx4 v1, s[16:19], s28 offen sc1 lds
    buffer_load_dwordx2 v[78:79], v167, s[16:19], s35 offen offset:0 sc1
    buffer_load_dwordx2 v[80:81], v167, s[16:19], s35 offen offset:256 sc1
    buffer_load_dwordx2 v[82:83], v167, s[16:19], s35 offen offset:512 sc1
    buffer_load_dwordx2 v[84:85], v167, s[16:19], s35 offen offset:768 sc1
    s_add_u32 s12, s12, 1
    s_add_u32 s34, s34, 0x40000
    s_cmp_eq_u32 s12, 64
    s_cselect_b64 exec, 0, -1
    s_lshl_b32 s28, s40, 12
    s_add_u32 s28, s28, s34
    s_add_u32 s28, s28, 33554432
    buffer_load_dwordx4 v[14:17], v1, s[16:19], s28 offen offset:0 sc1
    buffer_load_dwordx4 v[18:21], v1, s[16:19], s28 offen offset:1024 sc1
    buffer_load_dwordx4 v[22:25], v1, s[16:19], s28 offen offset:2048 sc1
    buffer_load_dwordx4 v[26:29], v1, s[16:19], s28 offen offset:3072 sc1
    s_lshl_b32 s29, s11, 11
    s_add_u32 m0, s29, 4096
    s_add_u32 s28, s34, s29
    buffer_load_dwordx4 v1, s[16:19], s28 offen offset:0 sc1 lds
    buffer_load_dwordx4 v1, s[16:19], s28 offen offset:1024 sc1 lds
    s_lshl_b32 s28, s41, 12
    s_add_u32 s28, s28, s34
    s_add_u32 s28, s28, 16777216
    buffer_load_dwordx4 v[62:65], v1, s[16:19], s28 offen offset:0 sc1
    buffer_load_dwordx4 v[66:69], v1, s[16:19], s28 offen offset:1024 sc1
    buffer_load_dwordx4 v[70:73], v1, s[16:19], s28 offen offset:2048 sc1
    buffer_load_dwordx4 v[74:77], v1, s[16:19], s28 offen offset:3072 sc1
    s_mov_b64 exec, -1
    v_max3_f32 v8, v114, v115, v116
    v_max3_f32 v8, v8, v117, v118
    v_max3_f32 v8, v8, v119, v120
    v_max_f32 v8, v8, v121
    s_waitcnt vmcnt(14)
    s_barrier
    ds_read_b64_tr_b16 v[86:87], v166 offset:0
    ds_read_b64_tr_b16 v[88:89], v166 offset:256
    ds_read_b64_tr_b16 v[90:91], v166 offset:512
    ds_read_b64_tr_b16 v[92:93], v166 offset:768
    ds_read_b64_tr_b16 v[94:95], v166 offset:1024
    ds_read_b64_tr_b16 v[96:97], v166 offset:1280
    ds_read_b64_tr_b16 v[98:99], v166 offset:1536
    ds_read_b64_tr_b16 v[100:101], v166 offset:1792
    s_waitcnt lgkmcnt(6)
    v_mfma_f32_16x16x32_bf16 v[122:125], v[86:89], v[170:173], v[110:113]
    s_waitcnt lgkmcnt(4)
    v_mfma_f32_16x16x32_bf16 v[122:125], v[90:93], v[174:177], v[122:125]
    s_waitcnt lgkmcnt(2)
    v_mfma_f32_16x16x32_bf16 v[122:125], v[94:97], v[178:181], v[122:125]
    s_waitcnt lgkmcnt(0)
    v_mfma_f32_16x16x32_bf16 v[122:125], v[98:101], v[182:185], v[122:125]
    s_add_u32 s28, s12, 1
    v_mov_b32 v7, s28
    v_cmp_gt_u32 vcc, 2, v0
    s_nop 1
    v_cndmask_b32 v7, 0, v7, vcc
    s_nop 2
    v_max3_f32 v8, v8, v122, v123
    v_max3_f32 v8, v8, v124, v125
    v_mov_b32 v9, v8
    s_nop 1
    v_permlane16_swap_b32 v8, v9
    v_max_f32 v8, v8, v9
    v_mov_b32 v9, v8
    s_nop 1
    v_permlane32_swap_b32 v8, v9
    v_max_f32 v8, v8, v9
    v_mul_f32 v10, s44, v8
    v_pk_fma_f32 v[114:115], v[114:115], s[44:45], v[10:11] op_sel_hi:[1,1,0] neg_lo:[0,0,1] neg_hi:[0,0,1]
    v_pk_fma_f32 v[116:117], v[116:117], s[44:45], v[10:11] op_sel_hi:[1,1,0] neg_lo:[0,0,1] neg_hi:[0,0,1]
    v_pk_fma_f32 v[118:119], v[118:119], s[44:45], v[10:11] op_sel_hi:[1,1,0] neg_lo:[0,0,1] neg_hi:[0,0,1]
    v_pk_fma_f32 v[120:121], v[120:121], s[44:45], v[10:11] op_sel_hi:[1,1,0] neg_lo:[0,0,1] neg_hi:[0,0,1]
    v_pk_fma_f32 v[122:123], v[122:123], s[44:45], v[10:11] op_sel_hi:[1,1,0] neg_lo:[0,0,1] neg_hi:[0,0,1]
    v_pk_fma_f32 v[124:125], v[124:125], s[44:45], v[10:11] op_sel_hi:[1,1,0] neg_lo:[0,0,1] neg_hi:[0,0,1]
    v_exp_f32 v114, v114
    v_exp_f32 v115, v115
    v_exp_f32 v116, v116
    v_exp_f32 v117, v117
    v_exp_f32 v118, v118
    v_exp_f32 v119, v119
    v_exp_f32 v120, v120
    v_exp_f32 v121, v121
    v_exp_f32 v122, v122
    v_exp_f32 v123, v123
    v_exp_f32 v124, v124
    v_exp_f32 v125, v125
    v_cvt_pk_bf16_f32 v126, v114, v115
    v_cvt_pk_bf16_f32 v127, v116, v117
    v_cvt_pk_bf16_f32 v128, v118, v119
    v_cvt_pk_bf16_f32 v129, v120, v121
    v_cvt_pk_bf16_f32 v130, v122, v123
    v_cvt_pk_bf16_f32 v131, v124, v125
    s_waitcnt vmcnt(10)
    v_mfma_f32_16x16x32_bf16 v[138:141], v[134:137], v[126:129], 0
    v_mfma_f32_16x16x32_bf16 v[142:145], v[186:189], v[126:129], 0
    v_mfma_f32_16x16x32_bf16 v[146:149], v[190:193], v[126:129], 0
    v_mfma_f32_16x16x32_bf16 v[150:153], v[194:197], v[126:129], 0
    v_mfma_f32_16x16x32_bf16 v[154:157], v[198:201], v[126:129], 0
    v_mfma_f32_16x16x16_bf16 v[138:141], v[134:135], v[130:131], v[138:141]
    v_mfma_f32_16x16x16_bf16 v[142:145], v[78:79], v[130:131], v[142:145]
    v_mfma_f32_16x16x16_bf16 v[146:149], v[80:81], v[130:131], v[146:149]
    v_mfma_f32_16x16x16_bf16 v[150:153], v[82:83], v[130:131], v[150:153]
    v_mfma_f32_16x16x16_bf16 v[154:157], v[84:85], v[130:131], v[154:157]
    v_rcp_f32 v10, v138
    s_nop 6
    v_pk_mul_f32 v[142:143], v[142:143], v[10:11] op_sel_hi:[1,0]
    v_pk_mul_f32 v[144:145], v[144:145], v[10:11] op_sel_hi:[1,0]
    v_pk_mul_f32 v[146:147], v[146:147], v[10:11] op_sel_hi:[1,0]
    v_pk_mul_f32 v[148:149], v[148:149], v[10:11] op_sel_hi:[1,0]
    v_pk_mul_f32 v[150:151], v[150:151], v[10:11] op_sel_hi:[1,0]
    v_pk_mul_f32 v[152:153], v[152:153], v[10:11] op_sel_hi:[1,0]
    v_pk_mul_f32 v[154:155], v[154:155], v[10:11] op_sel_hi:[1,0]
    v_pk_mul_f32 v[156:157], v[156:157], v[10:11] op_sel_hi:[1,0]
    v_cvt_pk_bf16_f32 v158, v142, v143
    v_cvt_pk_bf16_f32 v159, v144, v145
    v_cvt_pk_bf16_f32 v160, v146, v147
    v_cvt_pk_bf16_f32 v161, v148, v149
    v_cvt_pk_bf16_f32 v162, v150, v151
    v_cvt_pk_bf16_f32 v163, v152, v153
    v_cvt_pk_bf16_f32 v164, v154, v155
    v_cvt_pk_bf16_f32 v165, v156, v157
    buffer_store_dwordx4 v[158:161], v1, s[16:19], s36 offen offset:0 sc1
    buffer_store_dwordx4 v[162:165], v1, s[16:19], s36 offen offset:1024 sc1
    s_mov_b64 exec, 3
    buffer_load_dword v12, v6, s[16:19], 0 offen sc1
    s_mov_b64 exec, -1
    s_add_u32 s36, s36, 262144
    s_add_u32 s35, s35, 0x40000
    s_and_b32 s28, s12, 7
    s_cselect_b32 s28, 0, 0x2000
    s_xor_b32 s35, s35, s28
    s_waitcnt vmcnt(0)
    s_barrier
    v_mov_b32 v8, s12
    s_mov_b64 exec, s[14:15]
    buffer_store_dword v8, v0, s[16:19], s39 offen sc1
    s_mov_b64 exec, -1
    s_cmp_lt_u32 s12, 64
    s_cbranch_scc1 att_27
    s_branch k_end
role_23:
    s_cmp_lt_u32 s10, 32
    s_cbranch_scc1 role_34
    s_cmp_ge_u32 s10, 160
    s_cbranch_scc1 role_34
    s_cmp_ge_u32 s9, 20
    s_cbranch_scc1 role_34
    s_sub_u32 s28, s8, 3
    s_and_b32 s40, s28, 1
    s_lshr_b32 s42, s28, 1
    s_mov_b32 s41, s9
    s_lshl_b32 s39, s28, 5
    s_add_u32 s39, s39, s9
    s_lshl_b32 s39, s39, 2
    s_add_u32 s39, s39, 69731840
    s_mul_i32 s52, s9, 410
    s_lshr_b32 s52, s52, 8
    s_lshl_b32 s34, s9, 6
    s_load_dwordx2 s[20:21], s[0:1], 40
    s_waitcnt lgkmcnt(0)
    s_mov_b32 s22, 5242880
    s_mov_b32 s23, 0x20000
    v_lshrrev_b32 v8, 4, v0
    v_and_b32 v9, 15, v0
    v_lshlrev_b32 v10, 2, v8
    v_xor_b32 v9, v9, v10
    s_mov_b32 s28, 1280
    v_mul_lo_u32 v14, v8, s28
    v_lshrrev_b32 v10, 2, v9
    s_mov_b32 s28, 1310720
    v_mul_lo_u32 v10, v10, s28
    v_add_u32 v14, v14, v10
    v_and_b32 v9, 3, v9
    v_lshl_add_u32 v14, v9, 4, v14
    v_lshrrev_b32 v8, 2, v0
    v_lshlrev_b32 v15, 8, v8
    v_and_b32 v8, 3, v8
    v_xor_b32 v8, s11, v8
    v_lshl_add_u32 v15, v8, 6, v15
    v_and_b32 v8, 3, v0
    v_lshl_add_u32 v15, v8, 4, v15
    v_add_u32 v16, 0x10000, v15
    v_add_u32 v17, 0x20000, v15
    s_lshl_b32 s29, s11, 11
    s_lshr_b32 s30, s11, 1
    s_and_b32 s31, s11, 1
    s_lshl_b32 s30, s30, 4
    s_lshl_b32 s31, s31, 3
    s_add_u32 s30, s30, s31
    s_mul_i32 s30, s30, 1280
    s_add_u32 s30, s30, s34
    s_mul_i32 s32, s52, 40960
    s_barrier
    s_add_u32 m0, s29, 0
    s_add_u32 s28, s30, s32
    buffer_load_dwordx4 v14, s[20:23], s28 offen lds
    s_add_u32 m0, s29, 1024
    s_add_u32 s28, s30, s32
    s_add_u32 s28, s28, 5120
    buffer_load_dwordx4 v14, s[20:23], s28 offen lds
    s_add_u32 s32, s32, 40960
    s_cmp_eq_u32 s32, 1310720
    s_cselect_b32 s32, 0, s32
    s_add_u32 m0, s29, 8192
    s_add_u32 s28, s30, s32
    buffer_load_dwordx4 v14, s[20:23], s28 offen lds
    s_add_u32 m0, s29, 9216
    s_add_u32 s28, s30, s32
    s_add_u32 s28, s28, 5120
    buffer_load_dwordx4 v14, s[20:23], s28 offen lds
    s_add_u32 s32, s32, 40960
    s_cmp_eq_u32 s32, 1310720
    s_cselect_b32 s32, 0, s32
    s_add_u32 m0, s29, 16384
    s_add_u32 s28, s30, s32
    buffer_load_dwordx4 v14, s[20:23], s28 offen lds
    s_add_u32 m0, s29, 17408
    s_add_u32 s28, s30, s32
    s_add_u32 s28, s28, 5120
    buffer_load_dwordx4 v14, s[20:23], s28 offen lds
    s_add_u32 s32, s32, 40960
    s_cmp_eq_u32 s32, 1310720
    s_cselect_b32 s32, 0, s32
    s_add_u32 m0, s29, 24576
    s_add_u32 s28, s30, s32
    buffer_load_dwordx4 v14, s[20:23], s28 offen lds
    s_add_u32 m0, s29, 25600
    s_add_u32 s28, s30, s32
    s_add_u32 s28, s28, 5120
    buffer_load_dwordx4 v14, s[20:23], s28 offen lds
    s_add_u32 s32, s32, 40960
    s_cmp_eq_u32 s32, 1310720
    s_cselect_b32 s32, 0, s32
    s_add_u32 m0, s29, 32768
    s_add_u32 s28, s30, s32
    buffer_load_dwordx4 v14, s[20:23], s28 offen lds
    s_add_u32 m0, s29, 33792
    s_add_u32 s28, s30, s32
    s_add_u32 s28, s28, 5120
    buffer_load_dwordx4 v14, s[20:23], s28 offen lds
    s_add_u32 s32, s32, 40960
    s_cmp_eq_u32 s32, 1310720
    s_cselect_b32 s32, 0, s32
    s_add_u32 m0, s29, 40960
    s_add_u32 s28, s30, s32
    buffer_load_dwordx4 v14, s[20:23], s28 offen lds
    s_add_u32 m0, s29, 41984
    s_add_u32 s28, s30, s32
    s_add_u32 s28, s28, 5120
    buffer_load_dwordx4 v14, s[20:23], s28 offen lds
    s_add_u32 s32, s32, 40960
    s_cmp_eq_u32 s32, 1310720
    s_cselect_b32 s32, 0, s32
    s_add_u32 m0, s29, 49152
    s_add_u32 s28, s30, s32
    buffer_load_dwordx4 v14, s[20:23], s28 offen lds
    s_add_u32 m0, s29, 50176
    s_add_u32 s28, s30, s32
    s_add_u32 s28, s28, 5120
    buffer_load_dwordx4 v14, s[20:23], s28 offen lds
    s_add_u32 s32, s32, 40960
    s_cmp_eq_u32 s32, 1310720
    s_cselect_b32 s32, 0, s32
    s_add_u32 m0, s29, 57344
    s_add_u32 s28, s30, s32
    buffer_load_dwordx4 v14, s[20:23], s28 offen lds
    s_add_u32 m0, s29, 58368
    s_add_u32 s28, s30, s32
    s_add_u32 s28, s28, 5120
    buffer_load_dwordx4 v14, s[20:23], s28 offen lds
    s_add_u32 s32, s32, 40960
    s_cmp_eq_u32 s32, 1310720
    s_cselect_b32 s32, 0, s32
    s_add_u32 m0, s29, 65536
    s_add_u32 s28, s30, s32
    buffer_load_dwordx4 v14, s[20:23], s28 offen lds
    s_add_u32 m0, s29, 66560
    s_add_u32 s28, s30, s32
    s_add_u32 s28, s28, 5120
    buffer_load_dwordx4 v14, s[20:23], s28 offen lds
    s_add_u32 s32, s32, 40960
    s_cmp_eq_u32 s32, 1310720
    s_cselect_b32 s32, 0, s32
    s_add_u32 m0, s29, 73728
    s_add_u32 s28, s30, s32
    buffer_load_dwordx4 v14, s[20:23], s28 offen lds
    s_add_u32 m0, s29, 74752
    s_add_u32 s28, s30, s32
    s_add_u32 s28, s28, 5120
    buffer_load_dwordx4 v14, s[20:23], s28 offen lds
    s_add_u32 s32, s32, 40960
    s_cmp_eq_u32 s32, 1310720
    s_cselect_b32 s32, 0, s32
    s_add_u32 m0, s29, 81920
    s_add_u32 s28, s30, s32
    buffer_load_dwordx4 v14, s[20:23], s28 offen lds
    s_add_u32 m0, s29, 82944
    s_add_u32 s28, s30, s32
    s_add_u32 s28, s28, 5120
    buffer_load_dwordx4 v14, s[20:23], s28 offen lds
    s_add_u32 s32, s32, 40960
    s_cmp_eq_u32 s32, 1310720
    s_cselect_b32 s32, 0, s32
    s_add_u32 m0, s29, 90112
    s_add_u32 s28, s30, s32
    buffer_load_dwordx4 v14, s[20:23], s28 offen lds
    s_add_u32 m0, s29, 91136
    s_add_u32 s28, s30, s32
    s_add_u32 s28, s28, 5120
    buffer_load_dwordx4 v14, s[20:23], s28 offen lds
    s_add_u32 s32, s32, 40960
    s_cmp_eq_u32 s32, 1310720
    s_cselect_b32 s32, 0, s32
    s_add_u32 m0, s29, 98304
    s_add_u32 s28, s30, s32
    buffer_load_dwordx4 v14, s[20:23], s28 offen lds
    s_add_u32 m0, s29, 99328
    s_add_u32 s28, s30, s32
    s_add_u32 s28, s28, 5120
    buffer_load_dwordx4 v14, s[20:23], s28 offen lds
    s_add_u32 s32, s32, 40960
    s_cmp_eq_u32 s32, 1310720
    s_cselect_b32 s32, 0, s32
    s_add_u32 m0, s29, 106496
    s_add_u32 s28, s30, s32
    buffer_load_dwordx4 v14, s[20:23], s28 offen lds
    s_add_u32 m0, s29, 107520
    s_add_u32 s28, s30, s32
    s_add_u32 s28, s28, 5120
    buffer_load_dwordx4 v14, s[20:23], s28 offen lds
    s_add_u32 s32, s32, 40960
    s_cmp_eq_u32 s32, 1310720
    s_cselect_b32 s32, 0, s32
    s_add_u32 m0, s29, 114688
    s_add_u32 s28, s30, s32
    buffer_load_dwordx4 v14, s[20:23], s28 offen lds
    s_add_u32 m0, s29, 115712
    s_add_u32 s28, s30, s32
    s_add_u32 s28, s28, 5120
    buffer_load_dwordx4 v14, s[20:23], s28 offen lds
    s_add_u32 s32, s32, 40960
    s_cmp_eq_u32 s32, 1310720
    s_cselect_b32 s32, 0, s32
    s_add_u32 m0, s29, 122880
    s_add_u32 s28, s30, s32
    buffer_load_dwordx4 v14, s[20:23], s28 offen lds
    s_add_u32 m0, s29, 123904
    s_add_u32 s28, s30, s32
    s_add_u32 s28, s28, 5120
    buffer_load_dwordx4 v14, s[20:23], s28 offen lds
    s_add_u32 s32, s32, 40960
    s_cmp_eq_u32 s32, 1310720
    s_cselect_b32 s32, 0, s32
    s_add_u32 m0, s29, 131072
    s_add_u32 s28, s30, s32
    buffer_load_dwordx4 v14, s[20:23], s28 offen lds
    s_add_u32 m0, s29, 132096
    s_add_u32 s28, s30, s32
    s_add_u32 s28, s28, 5120
    buffer_load_dwordx4 v14, s[20:23], s28 offen lds
    s_add_u32 s32, s32, 40960
    s_cmp_eq_u32 s32, 1310720
    s_cselect_b32 s32, 0, s32
    s_add_u32 m0, s29, 139264
    s_add_u32 s28, s30, s32
    buffer_load_dwordx4 v14, s[20:23], s28 offen lds
    s_add_u32 m0, s29, 140288
    s_add_u32 s28, s30, s32
    s_add_u32 s28, s28, 5120
    buffer_load_dwordx4 v14, s[20:23], s28 offen lds
    s_add_u32 s32, s32, 40960
    s_cmp_eq_u32 s32, 1310720
    s_cselect_b32 s32, 0, s32
    s_add_u32 m0, s29, 147456
    s_add_u32 s28, s30, s32
    buffer_load_dwordx4 v14, s[20:23], s28 offen lds
    s_add_u32 m0, s29, 148480
    s_add_u32 s28, s30, s32
    s_add_u32 s28, s28, 5120
    buffer_load_dwordx4 v14, s[20:23], s28 offen lds
    s_add_u32 s32, s32, 40960
    s_cmp_eq_u32 s32, 1310720
    s_cselect_b32 s32, 0, s32
    s_add_u32 m0, s29, 155648
    s_add_u32 s28, s30, s32
    buffer_load_dwordx4 v14, s[20:23], s28 offen lds
    s_add_u32 m0, s29, 156672
    s_add_u32 s28, s30, s32
    s_add_u32 s28, s28, 5120
    buffer_load_dwordx4 v14, s[20:23], s28 offen lds
    s_add_u32 s32, s32, 40960
    s_cmp_eq_u32 s32, 1310720
    s_cselect_b32 s32, 0, s32
    s_waitcnt vmcnt(30)
    s_barrier
    ds_read_b64_tr_b16 a[0:1], v15 offset:0
    ds_read_b64_tr_b16 a[2:3], v15 offset:4096
    ds_read_b64_tr_b16 a[4:5], v15 offset:8
    ds_read_b64_tr_b16 a[6:7], v15 offset:4104
    ds_read_b64_tr_b16 a[8:9], v15 offset:8192
    ds_read_b64_tr_b16 a[10:11], v15 offset:12288
    ds_read_b64_tr_b16 a[12:13], v15 offset:8200
    ds_read_b64_tr_b16 a[14:15], v15 offset:12296
    ds_read_b64_tr_b16 a[16:17], v15 offset:16384
    ds_read_b64_tr_b16 a[18:19], v15 offset:20480
    ds_read_b64_tr_b16 a[20:21], v15 offset:16392
    ds_read_b64_tr_b16 a[22:23], v15 offset:20488
    ds_read_b64_tr_b16 a[24:25], v15 offset:24576
    ds_read_b64_tr_b16 a[26:27], v15 offset:28672
    ds_read_b64_tr_b16 a[28:29], v15 offset:24584
    ds_read_b64_tr_b16 a[30:31], v15 offset:28680
    ds_read_b64_tr_b16 a[32:33], v15 offset:32768
    ds_read_b64_tr_b16 a[34:35], v15 offset:36864
    ds_read_b64_tr_b16 a[36:37], v15 offset:32776
    ds_read_b64_tr_b16 a[38:39], v15 offset:36872
    s_waitcnt vmcnt(20)
    s_barrier
    ds_read_b64_tr_b16 a[40:41], v15 offset:40960
    ds_read_b64_tr_b16 a[42:43], v15 offset:45056
    ds_read_b64_tr_b16 a[44:45], v15 offset:40968
    ds_read_b64_tr_b16 a[46:47], v15 offset:45064
    ds_read_b64_tr_b16 a[48:49], v15 offset:49152
    ds_read_b64_tr_b16 a[50:51], v15 offset:53248
    ds_read_b64_tr_b16 a[52:53], v15 offset:49160
    ds_read_b64_tr_b16 a[54:55], v15 offset:53256
    ds_read_b64_tr_b16 a[56:57], v15 offset:57344
    ds_read_b64_tr_b16 a[58:59], v15 offset:61440
    ds_read_b64_tr_b16 a[60:61], v15 offset:57352
    ds_read_b64_tr_b16 a[62:63], v15 offset:61448
    ds_read_b64_tr_b16 a[64:65], v16 offset:0
    ds_read_b64_tr_b16 a[66:67], v16 offset:4096
    ds_read_b64_tr_b16 a[68:69], v16 offset:8
    ds_read_b64_tr_b16 a[70:71], v16 offset:4104
    ds_read_b64_tr_b16 a[72:73], v16 offset:8192
    ds_read_b64_tr_b16 a[74:75], v16 offset:12288
    ds_read_b64_tr_b16 a[76:77], v16 offset:8200
    ds_read_b64_tr_b16 a[78:79], v16 offset:12296
    s_waitcnt vmcnt(10)
    s_barrier
    ds_read_b64_tr_b16 a[80:81], v16 offset:16384
    ds_read_b64_tr_b16 a[82:83], v16 offset:20480
    ds_read_b64_tr_b16 a[84:85], v16 offset:16392
    ds_read_b64_tr_b16 a[86:87], v16 offset:20488
    ds_read_b64_tr_b16 a[88:89], v16 offset:24576
    ds_read_b64_tr_b16 a[90:91], v16 offset:28672
    ds_read_b64_tr_b16 a[92:93], v16 offset:24584
    ds_read_b64_tr_b16 a[94:95], v16 offset:28680
    ds_read_b64_tr_b16 a[96:97], v16 offset:32768
    ds_read_b64_tr_b16 a[98:99], v16 offset:36864
    ds_read_b64_tr_b16 a[100:101], v16 offset:32776
    ds_read_b64_tr_b16 a[102:103], v16 offset:36872
    ds_read_b64_tr_b16 a[104:105], v16 offset:40960
    ds_read_b64_tr_b16 a[106:107], v16 offset:45056
    ds_read_b64_tr_b16 a[108:109], v16 offset:40968
    ds_read_b64_tr_b16 a[110:111], v16 offset:45064
    ds_read_b64_tr_b16 a[112:113], v16 offset:49152
    ds_read_b64_tr_b16 a[114:115], v16 offset:53248
    ds_read_b64_tr_b16 a[116:117], v16 offset:49160
    ds_read_b64_tr_b16 a[118:119], v16 offset:53256
    s_waitcnt vmcnt(0)
    s_barrier
    ds_read_b64_tr_b16 a[120:121], v16 offset:57344
    ds_read_b64_tr_b16 a[122:123], v16 offset:61440
    ds_read_b64_tr_b16 a[124:125], v16 offset:57352
    ds_read_b64_tr_b16 a[126:127], v16 offset:61448
    ds_read_b64_tr_b16 a[128:129], v17 offset:0
    ds_read_b64_tr_b16 a[130:131], v17 offset:4096
    ds_read_b64_tr_b16 a[132:133], v17 offset:8
    ds_read_b64_tr_b16 a[134:135], v17 offset:4104
    ds_read_b64_tr_b16 a[136:137], v17 offset:8192
    ds_read_b64_tr_b16 a[138:139], v17 offset:12288
    ds_read_b64_tr_b16 a[140:141], v17 offset:8200
    ds_read_b64_tr_b16 a[142:143], v17 offset:12296
    ds_read_b64_tr_b16 a[144:145], v17 offset:16384
    ds_read_b64_tr_b16 a[146:147], v17 offset:20480
    ds_read_b64_tr_b16 a[148:149], v17 offset:16392
    ds_read_b64_tr_b16 a[150:151], v17 offset:20488
    ds_read_b64_tr_b16 a[152:153], v17 offset:24576
    ds_read_b64_tr_b16 a[154:155], v17 offset:28672
    ds_read_b64_tr_b16 a[156:157], v17 offset:24584
    ds_read_b64_tr_b16 a[158:159], v17 offset:28680
    s_waitcnt lgkmcnt(0)
    s_barrier
    s_add_u32 m0, s29, 0
    s_add_u32 s28, s30, s32
    buffer_load_dwordx4 v14, s[20:23], s28 offen lds
    s_add_u32 m0, s29, 1024
    s_add_u32 s28, s30, s32
    s_add_u32 s28, s28, 5120
    buffer_load_dwordx4 v14, s[20:23], s28 offen lds
    s_add_u32 s32, s32, 40960
    s_cmp_eq_u32 s32, 1310720
    s_cselect_b32 s32, 0, s32
    s_add_u32 m0, s29, 8192
    s_add_u32 s28, s30, s32
    buffer_load_dwordx4 v14, s[20:23], s28 offen lds
    s_add_u32 m0, s29, 9216
    s_add_u32 s28, s30, s32
    s_add_u32 s28, s28, 5120
    buffer_load_dwordx4 v14, s[20:23], s28 offen lds
    s_add_u32 s32, s32, 40960
    s_cmp_eq_u32 s32, 1310720
    s_cselect_b32 s32, 0, s32
    s_add_u32 m0, s29, 16384
    s_add_u32 s28, s30, s32
    buffer_load_dwordx4 v14, s[20:23], s28 offen lds
    s_add_u32 m0, s29, 17408
    s_add_u32 s28, s30, s32
    s_add_u32 s28, s28, 5120
    buffer_load_dwordx4 v14, s[20:23], s28 offen lds
    s_add_u32 s32, s32, 40960
    s_cmp_eq_u32 s32, 1310720
    s_cselect_b32 s32, 0, s32
    s_add_u32 m0, s29, 24576
    s_add_u32 s28, s30, s32
    buffer_load_dwordx4 v14, s[20:23], s28 offen lds
    s_add_u32 m0, s29, 25600
    s_add_u32 s28, s30, s32
    s_add_u32 s28, s28, 5120
    buffer_load_dwordx4 v14, s[20:23], s28 offen lds
    s_add_u32 s32, s32, 40960
    s_cmp_eq_u32 s32, 1310720
    s_cselect_b32 s32, 0, s32
    s_add_u32 m0, s29, 32768
    s_add_u32 s28, s30, s32
    buffer_load_dwordx4 v14, s[20:23], s28 offen lds
    s_add_u32 m0, s29, 33792
    s_add_u32 s28, s30, s32
    s_add_u32 s28, s28, 5120
    buffer_load_dwordx4 v14, s[20:23], s28 offen lds
    s_add_u32 s32, s32, 40960
    s_cmp_eq_u32 s32, 1310720
    s_cselect_b32 s32, 0, s32
    s_add_u32 m0, s29, 40960
    s_add_u32 s28, s30, s32
    buffer_load_dwordx4 v14, s[20:23], s28 offen lds
    s_add_u32 m0, s29, 41984
    s_add_u32 s28, s30, s32
    s_add_u32 s28, s28, 5120
    buffer_load_dwordx4 v14, s[20:23], s28 offen lds
    s_add_u32 s32, s32, 40960
    s_cmp_eq_u32 s32, 1310720
    s_cselect_b32 s32, 0, s32
    s_add_u32 m0, s29, 49152
    s_add_u32 s28, s30, s32
    buffer_load_dwordx4 v14, s[20:23], s28 offen lds
    s_add_u32 m0, s29, 50176
    s_add_u32 s28, s30, s32
    s_add_u32 s28, s28, 5120
    buffer_load_dwordx4 v14, s[20:23], s28 offen lds
    s_add_u32 s32, s32, 40960
    s_cmp_eq_u32 s32, 1310720
    s_cselect_b32 s32, 0, s32
    s_add_u32 m0, s29, 57344
    s_add_u32 s28, s30, s32
    buffer_load_dwordx4 v14, s[20:23], s28 offen lds
    s_add_u32 m0, s29, 58368
    s_add_u32 s28, s30, s32
    s_add_u32 s28, s28, 5120
    buffer_load_dwordx4 v14, s[20:23], s28 offen lds
    s_add_u32 s32, s32, 40960
    s_cmp_eq_u32 s32, 1310720
    s_cselect_b32 s32, 0, s32
    s_add_u32 m0, s29, 65536
    s_add_u32 s28, s30, s32
    buffer_load_dwordx4 v14, s[20:23], s28 offen lds
    s_add_u32 m0, s29, 66560
    s_add_u32 s28, s30, s32
    s_add_u32 s28, s28, 5120
    buffer_load_dwordx4 v14, s[20:23], s28 offen lds
    s_add_u32 s32, s32, 40960
    s_cmp_eq_u32 s32, 1310720
    s_cselect_b32 s32, 0, s32
    s_add_u32 m0, s29, 73728
    s_add_u32 s28, s30, s32
    buffer_load_dwordx4 v14, s[20:23], s28 offen lds
    s_add_u32 m0, s29, 74752
    s_add_u32 s28, s30, s32
    s_add_u32 s28, s28, 5120
    buffer_load_dwordx4 v14, s[20:23], s28 offen lds
    s_add_u32 s32, s32, 40960
    s_cmp_eq_u32 s32, 1310720
    s_cselect_b32 s32, 0, s32
    s_add_u32 m0, s29, 81920
    s_add_u32 s28, s30, s32
    buffer_load_dwordx4 v14, s[20:23], s28 offen lds
    s_add_u32 m0, s29, 82944
    s_add_u32 s28, s30, s32
    s_add_u32 s28, s28, 5120
    buffer_load_dwordx4 v14, s[20:23], s28 offen lds
    s_add_u32 s32, s32, 40960
    s_cmp_eq_u32 s32, 1310720
    s_cselect_b32 s32, 0, s32
    s_add_u32 m0, s29, 90112
    s_add_u32 s28, s30, s32
    buffer_load_dwordx4 v14, s[20:23], s28 offen lds
    s_add_u32 m0, s29, 91136
    s_add_u32 s28, s30, s32
    s_add_u32 s28, s28, 5120
    buffer_load_dwordx4 v14, s[20:23], s28 offen lds
    s_add_u32 s32, s32, 40960
    s_cmp_eq_u32 s32, 1310720
    s_cselect_b32 s32, 0, s32
    s_waitcnt vmcnt(14)
    s_barrier
    ds_read_b64_tr_b16 a[160:161], v15 offset:0
    ds_read_b64_tr_b16 a[162:163], v15 offset:4096
    ds_read_b64_tr_b16 a[164:165], v15 offset:8
    ds_read_b64_tr_b16 a[166:167], v15 offset:4104
    ds_read_b64_tr_b16 a[168:169], v15 offset:8192
    ds_read_b64_tr_b16 a[170:171], v15 offset:12288
    ds_read_b64_tr_b16 a[172:173], v15 offset:8200
    ds_read_b64_tr_b16 a[174:175], v15 offset:12296
    ds_read_b64_tr_b16 a[176:177], v15 offset:16384
    ds_read_b64_tr_b16 a[178:179], v15 offset:20480
    ds_read_b64_tr_b16 a[180:181], v15 offset:16392
    ds_read_b64_tr_b16 a[182:183], v15 offset:20488
    ds_read_b64_tr_b16 a[184:185], v15 offset:24576
    ds_read_b64_tr_b16 a[186:187], v15 offset:28672
    ds_read_b64_tr_b16 a[188:189], v15 offset:24584
    ds_read_b64_tr_b16 a[190:191], v15 offset:28680
    ds_read_b64_tr_b16 a[192:193], v15 offset:32768
    ds_read_b64_tr_b16 a[194:195], v15 offset:36864
    ds_read_b64_tr_b16 a[196:197], v15 offset:32776
    ds_read_b64_tr_b16 a[198:199], v15 offset:36872
    s_waitcnt vmcnt(4)
    s_barrier
    ds_read_b64_tr_b16 a[200:201], v15 offset:40960
    ds_read_b64_tr_b16 a[202:203], v15 offset:45056
    ds_read_b64_tr_b16 a[204:205], v15 offset:40968
    ds_read_b64_tr_b16 a[206:207], v15 offset:45064
    ds_read_b64_tr_b16 a[208:209], v15 offset:49152
    ds_read_b64_tr_b16 a[210:211], v15 offset:53248
    ds_read_b64_tr_b16 a[212:213], v15 offset:49160
    ds_read_b64_tr_b16 a[214:215], v15 offset:53256
    ds_read_b64_tr_b16 a[216:217], v15 offset:57344
    ds_read_b64_tr_b16 a[218:219], v15 offset:61440
    ds_read_b64_tr_b16 a[220:221], v15 offset:57352
    ds_read_b64_tr_b16 a[222:223], v15 offset:61448
    ds_read_b64_tr_b16 a[224:225], v16 offset:0
    ds_read_b64_tr_b16 a[226:227], v16 offset:4096
    ds_read_b64_tr_b16 a[228:229], v16 offset:8
    ds_read_b64_tr_b16 a[230:231], v16 offset:4104
    ds_read_b64_tr_b16 a[232:233], v16 offset:8192
    ds_read_b64_tr_b16 a[234:235], v16 offset:12288
    ds_read_b64_tr_b16 a[236:237], v16 offset:8200
    ds_read_b64_tr_b16 a[238:239], v16 offset:12296
    s_waitcnt vmcnt(0)
    s_barrier
    ds_read_b64_tr_b16 a[240:241], v16 offset:16384
    ds_read_b64_tr_b16 a[242:243], v16 offset:20480
    ds_read_b64_tr_b16 a[244:245], v16 offset:16392
    ds_read_b64_tr_b16 a[246:247], v16 offset:20488
    ds_read_b64_tr_b16 a[248:249], v16 offset:24576
    ds_read_b64_tr_b16 a[250:251], v16 offset:28672
    ds_read_b64_tr_b16 a[252:253], v16 offset:24584
    ds_read_b64_tr_b16 a[254:255], v16 offset:28680
    s_waitcnt lgkmcnt(0)
    s_barrier
    s_load_dwordx2 s[24:25], s[0:1], 0
    s_waitcnt lgkmcnt(0)
    s_mov_b32 s26, 2621440
    s_mov_b32 s27, 0x20000
    s_lshl_b32 s29, s42, 1
    s_add_u32 s29, s29, s40
    s_lshl_b32 s34, s29, 17
    s_lshl_b32 s28, s11, 15
    s_add_u32 s34, s34, s28
    s_add_u32 s34, s34, 117440512
    s_lshl_b32 s52, s52, 10
    s_mul_i32 s36, s29, 20
    s_add_u32 s36, s36, s9
    s_lshl_b32 s36, s36, 10
    s_add_u32 s36, s36, 75497472
    s_mul_i32 s37, s29, 20480
    s_lshl_b32 s28, s9, 6
    s_add_u32 s37, s37, s28
    s_mul_i32 s38, s29, 2560
    s_lshl_b32 s28, s9, 7
    s_add_u32 s38, s38, s28
    s_add_u32 s38, s38, 83886080
    v_mul_u32_u24 v17, 1280, v2
    v_lshl_add_u32 v17, v3, 4, v17
    v_lshlrev_b32 v18, 3, v2
    s_lshl_b32 s28, s11, 11
    v_add_u32 v19, s28, v1
    s_mov_b32 s12, s42
    s_lshl_b32 s54, s11, 5
    v_mul_u32_u24 v6, 4, v0
    v_add_u32 v6, s54, v6
    v_add_u32 v6, 69731584, v6
    s_add_u32 s28, s12, 1
    v_mov_b32 v7, s28
    v_cmp_gt_u32 vcc, 8, v0
    s_nop 1
    v_cndmask_b32 v7, 0, v7, vcc
    s_mov_b64 exec, 255
    buffer_load_dword v12, v6, s[16:19], 0 offen sc1
    s_mov_b64 exec, -1
    s_waitcnt vmcnt(0)
w_35:
    buffer_load_dwordx4 v[22:25], v17, s[24:27], s37 offen
    s_branch bk_37
bw_36:
    s_sub_u32 s88, s88, 1
    s_cbranch_scc1 k_end
    s_mov_b64 exec, 255
    buffer_load_dword v12, v6, s[16:19], 0 offen sc1
    s_mov_b64 exec, -1
    s_waitcnt vmcnt(0)
bk_37:
    v_cmp_lt_u32 vcc, v12, v7
    s_cbranch_vccnz bw_36
    s_mov_b32 s29, s52
    s_add_u32 s28, s34, s29
    buffer_load_dwordx4 v[78:81], v1, s[16:19], s28 offen sc1
    s_add_u32 s29, s29, 1024
    s_and_b32 s29, s29, 0x7fff
    s_add_u32 s28, s34, s29
    buffer_load_dwordx4 v[82:85], v1, s[16:19], s28 offen sc1
    s_add_u32 s29, s29, 1024
    s_and_b32 s29, s29, 0x7fff
    s_add_u32 s28, s34, s29
    buffer_load_dwordx4 v[86:89], v1, s[16:19], s28 offen sc1
    s_add_u32 s29, s29, 1024
    s_and_b32 s29, s29, 0x7fff
    s_add_u32 s28, s34, s29
    buffer_load_dwordx4 v[90:93], v1, s[16:19], s28 offen sc1
    s_add_u32 s29, s29, 1024
    s_and_b32 s29, s29, 0x7fff
    s_add_u32 s28, s34, s29
    buffer_load_dwordx4 v[94:97], v1, s[16:19], s28 offen sc1
    s_add_u32 s29, s29, 1024
    s_and_b32 s29, s29, 0x7fff
    s_add_u32 s28, s34, s29
    buffer_load_dwordx4 v[98:101], v1, s[16:19], s28 offen sc1
    s_add_u32 s29, s29, 1024
    s_and_b32 s29, s29, 0x7fff
    s_add_u32 s28, s34, s29
    buffer_load_dwordx4 v[102:105], v1, s[16:19], s28 offen sc1
    s_add_u32 s29, s29, 1024
    s_and_b32 s29, s29, 0x7fff
    s_add_u32 s28, s34, s29
    buffer_load_dwordx4 v[106:109], v1, s[16:19], s28 offen sc1
    s_add_u32 s29, s29, 1024
    s_and_b32 s29, s29, 0x7fff
    s_add_u32 s28, s34, s29
    buffer_load_dwordx4 v[110:113], v1, s[16:19], s28 offen sc1
    s_add_u32 s29, s29, 1024
    s_and_b32 s29, s29, 0x7fff
    s_add_u32 s28, s34, s29
    buffer_load_dwordx4 v[114:117], v1, s[16:19], s28 offen sc1
    s_add_u32 s29, s29, 1024
    s_and_b32 s29, s29, 0x7fff
    s_add_u32 s28, s34, s29
    buffer_load_dwordx4 v[118:121], v1, s[16:19], s28 offen sc1
    s_add_u32 s29, s29, 1024
    s_and_b32 s29, s29, 0x7fff
    s_add_u32 s28, s34, s29
    buffer_load_dwordx4 v[122:125], v1, s[16:19], s28 offen sc1
    s_add_u32 s29, s29, 1024
    s_and_b32 s29, s29, 0x7fff
    s_add_u32 s28, s34, s29
    buffer_load_dwordx4 v[126:129], v1, s[16:19], s28 offen sc1
    s_add_u32 s29, s29, 1024
    s_and_b32 s29, s29, 0x7fff
    s_add_u32 s28, s34, s29
    buffer_load_dwordx4 v[130:133], v1, s[16:19], s28 offen sc1
    s_add_u32 s29, s29, 1024
    s_and_b32 s29, s29, 0x7fff
    s_add_u32 s28, s34, s29
    buffer_load_dwordx4 v[134:137], v1, s[16:19], s28 offen sc1
    s_add_u32 s29, s29, 1024
    s_and_b32 s29, s29, 0x7fff
    s_add_u32 s28, s34, s29
    buffer_load_dwordx4 v[138:141], v1, s[16:19], s28 offen sc1
    s_add_u32 s29, s29, 1024
    s_and_b32 s29, s29, 0x7fff
    s_add_u32 s28, s34, s29
    buffer_load_dwordx4 v[142:145], v1, s[16:19], s28 offen sc1
    s_add_u32 s29, s29, 1024
    s_and_b32 s29, s29, 0x7fff
    s_add_u32 s28, s34, s29
    buffer_load_dwordx4 v[146:149], v1, s[16:19], s28 offen sc1
    s_add_u32 s29, s29, 1024
    s_and_b32 s29, s29, 0x7fff
    s_add_u32 s28, s34, s29
    buffer_load_dwordx4 v[150:153], v1, s[16:19], s28 offen sc1
    s_add_u32 s29, s29, 1024
    s_and_b32 s29, s29, 0x7fff
    s_add_u32 s28, s34, s29
    buffer_load_dwordx4 v[154:157], v1, s[16:19], s28 offen sc1
    s_add_u32 s29, s29, 1024
    s_and_b32 s29, s29, 0x7fff
    s_add_u32 s28, s34, s29
    buffer_load_dwordx4 v[158:161], v1, s[16:19], s28 offen sc1
    s_add_u32 s29, s29, 1024
    s_and_b32 s29, s29, 0x7fff
    s_add_u32 s28, s34, s29
    buffer_load_dwordx4 v[162:165], v1, s[16:19], s28 offen sc1
    s_add_u32 s29, s29, 1024
    s_and_b32 s29, s29, 0x7fff
    s_add_u32 s28, s34, s29
    buffer_load_dwordx4 v[166:169], v1, s[16:19], s28 offen sc1
    s_add_u32 s29, s29, 1024
    s_and_b32 s29, s29, 0x7fff
    s_add_u32 s28, s34, s29
    buffer_load_dwordx4 v[170:173], v1, s[16:19], s28 offen sc1
    s_add_u32 s29, s29, 1024
    s_and_b32 s29, s29, 0x7fff
    s_add_u32 s28, s34, s29
    buffer_load_dwordx4 v[174:177], v1, s[16:19], s28 offen sc1
    s_add_u32 s29, s29, 1024
    s_and_b32 s29, s29, 0x7fff
    s_add_u32 s28, s34, s29
    buffer_load_dwordx4 v[178:181], v1, s[16:19], s28 offen sc1
    s_add_u32 s29, s29, 1024
    s_and_b32 s29, s29, 0x7fff
    s_add_u32 s28, s34, s29
    buffer_load_dwordx4 v[182:185], v1, s[16:19], s28 offen sc1
    s_add_u32 s29, s29, 1024
    s_and_b32 s29, s29, 0x7fff
    s_add_u32 s28, s34, s29
    buffer_load_dwordx4 v[186:189], v1, s[16:19], s28 offen sc1
    s_add_u32 s29, s29, 1024
    s_and_b32 s29, s29, 0x7fff
    s_add_u32 s28, s34, s29
    buffer_load_dwordx4 v[190:193], v1, s[16:19], s28 offen sc1
    s_add_u32 s29, s29, 1024
    s_and_b32 s29, s29, 0x7fff
    s_add_u32 s28, s34, s29
    buffer_load_dwordx4 v[194:197], v1, s[16:19], s28 offen sc1
    s_add_u32 s29, s29, 1024
    s_and_b32 s29, s29, 0x7fff
    s_add_u32 s28, s34, s29
    buffer_load_dwordx4 v[198:201], v1, s[16:19], s28 offen sc1
    s_add_u32 s29, s29, 1024
    s_and_b32 s29, s29, 0x7fff
    s_add_u32 s28, s34, s29
    buffer_load_dwordx4 v[202:205], v1, s[16:19], s28 offen sc1
    s_waitcnt vmcnt(31)
    v_mfma_f32_16x16x32_bf16 v[54:57], a[0:3], v[78:81], 0
    v_mfma_f32_16x16x32_bf16 v[58:61], a[4:7], v[78:81], 0
    s_waitcnt vmcnt(30)
    v_mfma_f32_16x16x32_bf16 v[54:57], a[8:11], v[82:85], v[54:57]
    v_mfma_f32_16x16x32_bf16 v[58:61], a[12:15], v[82:85], v[58:61]
    s_waitcnt vmcnt(29)
    v_mfma_f32_16x16x32_bf16 v[54:57], a[16:19], v[86:89], v[54:57]
    v_mfma_f32_16x16x32_bf16 v[58:61], a[20:23], v[86:89], v[58:61]
    s_waitcnt vmcnt(28)
    v_mfma_f32_16x16x32_bf16 v[54:57], a[24:27], v[90:93], v[54:57]
    v_mfma_f32_16x16x32_bf16 v[58:61], a[28:31], v[90:93], v[58:61]
    s_waitcnt vmcnt(27)
    v_mfma_f32_16x16x32_bf16 v[54:57], a[32:35], v[94:97], v[54:57]
    v_mfma_f32_16x16x32_bf16 v[58:61], a[36:39], v[94:97], v[58:61]
    s_waitcnt vmcnt(26)
    v_mfma_f32_16x16x32_bf16 v[54:57], a[40:43], v[98:101], v[54:57]
    v_mfma_f32_16x16x32_bf16 v[58:61], a[44:47], v[98:101], v[58:61]
    s_waitcnt vmcnt(25)
    v_mfma_f32_16x16x32_bf16 v[54:57], a[48:51], v[102:105], v[54:57]
    v_mfma_f32_16x16x32_bf16 v[58:61], a[52:55], v[102:105], v[58:61]
    s_waitcnt vmcnt(24)
    v_mfma_f32_16x16x32_bf16 v[54:57], a[56:59], v[106:109], v[54:57]
    v_mfma_f32_16x16x32_bf16 v[58:61], a[60:63], v[106:109], v[58:61]
    s_waitcnt vmcnt(23)
    v_mfma_f32_16x16x32_bf16 v[54:57], a[64:67], v[110:113], v[54:57]
    v_mfma_f32_16x16x32_bf16 v[58:61], a[68:71], v[110:113], v[58:61]
    s_waitcnt vmcnt(22)
    v_mfma_f32_16x16x32_bf16 v[54:57], a[72:75], v[114:117], v[54:57]
    v_mfma_f32_16x16x32_bf16 v[58:61], a[76:79], v[114:117], v[58:61]
    s_waitcnt vmcnt(21)
    v_mfma_f32_16x16x32_bf16 v[54:57], a[80:83], v[118:121], v[54:57]
    v_mfma_f32_16x16x32_bf16 v[58:61], a[84:87], v[118:121], v[58:61]
    s_waitcnt vmcnt(20)
    v_mfma_f32_16x16x32_bf16 v[54:57], a[88:91], v[122:125], v[54:57]
    v_mfma_f32_16x16x32_bf16 v[58:61], a[92:95], v[122:125], v[58:61]
    s_waitcnt vmcnt(19)
    v_mfma_f32_16x16x32_bf16 v[54:57], a[96:99], v[126:129], v[54:57]
    v_mfma_f32_16x16x32_bf16 v[58:61], a[100:103], v[126:129], v[58:61]
    s_waitcnt vmcnt(18)
    v_mfma_f32_16x16x32_bf16 v[54:57], a[104:107], v[130:133], v[54:57]
    v_mfma_f32_16x16x32_bf16 v[58:61], a[108:111], v[130:133], v[58:61]
    s_waitcnt vmcnt(17)
    v_mfma_f32_16x16x32_bf16 v[54:57], a[112:115], v[134:137], v[54:57]
    v_mfma_f32_16x16x32_bf16 v[58:61], a[116:119], v[134:137], v[58:61]
    s_waitcnt vmcnt(16)
    v_mfma_f32_16x16x32_bf16 v[54:57], a[120:123], v[138:141], v[54:57]
    v_mfma_f32_16x16x32_bf16 v[58:61], a[124:127], v[138:141], v[58:61]
    s_waitcnt vmcnt(15)
    v_mfma_f32_16x16x32_bf16 v[54:57], a[128:131], v[142:145], v[54:57]
    v_mfma_f32_16x16x32_bf16 v[58:61], a[132:135], v[142:145], v[58:61]
    s_waitcnt vmcnt(14)
    v_mfma_f32_16x16x32_bf16 v[54:57], a[136:139], v[146:149], v[54:57]
    v_mfma_f32_16x16x32_bf16 v[58:61], a[140:143], v[146:149], v[58:61]
    s_waitcnt vmcnt(13)
    v_mfma_f32_16x16x32_bf16 v[54:57], a[144:147], v[150:153], v[54:57]
    v_mfma_f32_16x16x32_bf16 v[58:61], a[148:151], v[150:153], v[58:61]
    s_waitcnt vmcnt(12)
    v_mfma_f32_16x16x32_bf16 v[54:57], a[152:155], v[154:157], v[54:57]
    v_mfma_f32_16x16x32_bf16 v[58:61], a[156:159], v[154:157], v[58:61]
    s_waitcnt vmcnt(11)
    v_mfma_f32_16x16x32_bf16 v[54:57], a[160:163], v[158:161], v[54:57]
    v_mfma_f32_16x16x32_bf16 v[58:61], a[164:167], v[158:161], v[58:61]
    s_waitcnt vmcnt(10)
    v_mfma_f32_16x16x32_bf16 v[54:57], a[168:171], v[162:165], v[54:57]
    v_mfma_f32_16x16x32_bf16 v[58:61], a[172:175], v[162:165], v[58:61]
    s_waitcnt vmcnt(9)
    v_mfma_f32_16x16x32_bf16 v[54:57], a[176:179], v[166:169], v[54:57]
    v_mfma_f32_16x16x32_bf16 v[58:61], a[180:183], v[166:169], v[58:61]
    s_waitcnt vmcnt(8)
    v_mfma_f32_16x16x32_bf16 v[54:57], a[184:187], v[170:173], v[54:57]
    v_mfma_f32_16x16x32_bf16 v[58:61], a[188:191], v[170:173], v[58:61]
    s_waitcnt vmcnt(7)
    v_mfma_f32_16x16x32_bf16 v[54:57], a[192:195], v[174:177], v[54:57]
    v_mfma_f32_16x16x32_bf16 v[58:61], a[196:199], v[174:177], v[58:61]
    s_waitcnt vmcnt(6)
    v_mfma_f32_16x16x32_bf16 v[54:57], a[200:203], v[178:181], v[54:57]
    v_mfma_f32_16x16x32_bf16 v[58:61], a[204:207], v[178:181], v[58:61]
    s_waitcnt vmcnt(5)
    v_mfma_f32_16x16x32_bf16 v[54:57], a[208:211], v[182:185], v[54:57]
    v_mfma_f32_16x16x32_bf16 v[58:61], a[212:215], v[182:185], v[58:61]
    s_waitcnt vmcnt(4)
    v_mfma_f32_16x16x32_bf16 v[54:57], a[216:219], v[186:189], v[54:57]
    v_mfma_f32_16x16x32_bf16 v[58:61], a[220:223], v[186:189], v[58:61]
    s_waitcnt vmcnt(3)
    v_mfma_f32_16x16x32_bf16 v[54:57], a[224:227], v[190:193], v[54:57]
    v_mfma_f32_16x16x32_bf16 v[58:61], a[228:231], v[190:193], v[58:61]
    s_waitcnt vmcnt(2)
    v_mfma_f32_16x16x32_bf16 v[54:57], a[232:235], v[194:197], v[54:57]
    v_mfma_f32_16x16x32_bf16 v[58:61], a[236:239], v[194:197], v[58:61]
    s_waitcnt vmcnt(1)
    v_mfma_f32_16x16x32_bf16 v[54:57], a[240:243], v[198:201], v[54:57]
    v_mfma_f32_16x16x32_bf16 v[58:61], a[244:247], v[198:201], v[58:61]
    s_waitcnt vmcnt(0)
    v_mfma_f32_16x16x32_bf16 v[54:57], a[248:251], v[202:205], v[54:57]
    v_mfma_f32_16x16x32_bf16 v[58:61], a[252:255], v[202:205], v[58:61]
    s_cmp_eq_u32 s11, 0
    s_cbranch_scc1 wl_38
    s_nop 5
    ds_write_b128 v19, v[54:57]
    ds_write_b128 v19, v[58:61] offset:1024
    s_waitcnt lgkmcnt(0)
    s_barrier
    s_branch wj_39
wl_38:
    v_and_b32 v63, 0xffff0000, v22
    v_lshlrev_b32 v62, 16, v22
    v_and_b32 v65, 0xffff0000, v23
    v_lshlrev_b32 v64, 16, v23
    v_and_b32 v67, 0xffff0000, v24
    v_lshlrev_b32 v66, 16, v24
    v_and_b32 v69, 0xffff0000, v25
    v_lshlrev_b32 v68, 16, v25
    s_barrier
    ds_read_b128 v[86:89], v1 offset:2048
    ds_read_b128 v[90:93], v1 offset:3072
    ds_read_b128 v[94:97], v1 offset:4096
    ds_read_b128 v[98:101], v1 offset:5120
    ds_read_b128 v[102:105], v1 offset:6144
    ds_read_b128 v[106:109], v1 offset:7168
    s_waitcnt lgkmcnt(4)
    v_pk_add_f32 v[54:55], v[54:55], v[86:87]
    v_pk_add_f32 v[56:57], v[56:57], v[88:89]
    v_pk_add_f32 v[58:59], v[58:59], v[90:91]
    v_pk_add_f32 v[60:61], v[60:61], v[92:93]
    s_waitcnt lgkmcnt(0)
    v_pk_add_f32 v[94:95], v[94:95], v[102:103]
    v_pk_add_f32 v[96:97], v[96:97], v[104:105]
    v_pk_add_f32 v[98:99], v[98:99], v[106:107]
    v_pk_add_f32 v[100:101], v[100:101], v[108:109]
    v_pk_add_f32 v[54:55], v[54:55], v[94:95]
    v_pk_add_f32 v[56:57], v[56:57], v[96:97]
    v_pk_add_f32 v[58:59], v[58:59], v[98:99]
    v_pk_add_f32 v[60:61], v[60:61], v[100:101]
    v_cvt_pk_bf16_f32 v78, v54, v55
    v_cvt_pk_bf16_f32 v79, v56, v57
    v_cvt_pk_bf16_f32 v80, v58, v59
    v_cvt_pk_bf16_f32 v81, v60, v61
    v_and_b32 v55, 0xffff0000, v78
    v_lshlrev_b32 v54, 16, v78
    v_and_b32 v57, 0xffff0000, v79
    v_lshlrev_b32 v56, 16, v79
    v_and_b32 v59, 0xffff0000, v80
    v_lshlrev_b32 v58, 16, v80
    v_and_b32 v61, 0xffff0000, v81
    v_lshlrev_b32 v60, 16, v81
    v_pk_add_f32 v[54:55], v[54:55], v[62:63]
    v_pk_add_f32 v[56:57], v[56:57], v[64:65]
    v_pk_add_f32 v[58:59], v[58:59], v[66:67]
    v_pk_add_f32 v[60:61], v[60:61], v[68:69]
    v_cvt_pk_bf16_f32 v78, v54, v55
    v_cvt_pk_bf16_f32 v79, v56, v57
    v_cvt_pk_bf16_f32 v80, v58, v59
    v_cvt_pk_bf16_f32 v81, v60, v61
    buffer_store_dwordx4 v[78:81], v1, s[16:19], s36 offen sc1
    v_and_b32 v55, 0xffff0000, v78
    v_lshlrev_b32 v54, 16, v78
    v_and_b32 v57, 0xffff0000, v79
    v_lshlrev_b32 v56, 16, v79
    v_and_b32 v59, 0xffff0000, v80
    v_lshlrev_b32 v58, 16, v80
    v_and_b32 v61, 0xffff0000, v81
    v_lshlrev_b32 v60, 16, v81
    v_add_f32 v62, v54, v55
    v_mul_f32 v63, v54, v54
    v_fmac_f32 v63, v55, v55
    v_add_f32 v62, v62, v56
    v_fmac_f32 v63, v56, v56
    v_add_f32 v62, v62, v57
    v_fmac_f32 v63, v57, v57
    v_add_f32 v62, v62, v58
    v_fmac_f32 v63, v58, v58
    v_add_f32 v62, v62, v59
    v_fmac_f32 v63, v59, v59
    v_add_f32 v62, v62, v60
    v_fmac_f32 v63, v60, v60
    v_add_f32 v62, v62, v61
    v_fmac_f32 v63, v61, v61
    v_mov_b32 v64, v62
    v_mov_b32 v65, v63
    s_nop 1
    v_permlane16_swap_b32 v62, v64
    v_permlane16_swap_b32 v63, v65
    v_add_f32 v62, v62, v64
    v_add_f32 v63, v63, v65
    v_mov_b32 v64, v62
    v_mov_b32 v65, v63
    s_nop 1
    v_permlane32_swap_b32 v62, v64
    v_permlane32_swap_b32 v63, v65
    v_add_f32 v62, v62, v64
    v_add_f32 v63, v63, v65
    s_mov_b64 exec, 0xffff
    buffer_store_dwordx2 v[62:63], v18, s[16:19], s38 offen sc1
    s_mov_b64 exec, -1
wj_39:
    s_add_u32 s34, s34, 524288
    s_add_u32 s36, s36, 81920
    s_add_u32 s37, s37, 81920
    s_add_u32 s38, s38, 10240
    s_add_u32 s12, s12, 2
    s_add_u32 s28, s12, 1
    v_mov_b32 v7, s28
    v_cmp_gt_u32 vcc, 8, v0
    s_nop 1
    v_cndmask_b32 v7, 0, v7, vcc
    s_mov_b64 exec, 255
    buffer_load_dword v12, v6, s[16:19], 0 offen sc1
    s_mov_b64 exec, -1
    s_waitcnt vmcnt(0)
    s_barrier
    v_mov_b32 v8, s12
    s_mov_b64 exec, s[14:15]
    buffer_store_dword v8, v0, s[16:19], s39 offen sc1
    s_mov_b64 exec, -1
    s_cmp_lt_u32 s12, 64
    s_cbranch_scc1 w_35
    s_branch k_end
role_34:
    s_cmp_lt_u32 s10, 160
    s_cbranch_scc1 role_40
    s_cmp_ge_u32 s10, 188
    s_cbranch_scc1 role_40
    s_sub_u32 s41, s10, 160
    s_cmp_ge_u32 s41, 14
    s_cselect_b32 s40, 1, 0
    s_mul_i32 s28, s40, 14
    s_sub_u32 s41, s41, s28
    s_sub_u32 s39, s10, 160
    s_lshl_b32 s39, s39, 2
    s_add_u32 s39, s39, 69732864
    s_load_dwordx2 s[20:21], s[0:1], 80
    s_waitcnt lgkmcnt(0)
    s_mov_b32 s22, 2211840
    s_mov_b32 s23, 0x20000
    s_lshl_b32 s34, s41, 8
    v_lshrrev_b32 v8, 4, v0
    v_and_b32 v9, 15, v0
    v_lshlrev_b32 v10, 2, v8
    v_xor_b32 v9, v9, v10
    s_mov_b32 s28, 3456
    v_mul_lo_u32 v14, v8, s28
    v_lshl_add_u32 v14, v9, 4, v14
    v_lshrrev_b32 v8, 2, v0
    v_lshlrev_b32 v15, 8, v8
    v_and_b32 v8, 3, v8
    v_xor_b32 v8, s11, v8
    v_lshl_add_u32 v15, v8, 6, v15
    v_and_b32 v8, 3, v0
    v_lshl_add_u32 v15, v8, 4, v15
    v_add_u32 v16, 0x10000, v15
    v_add_u32 v17, 0x20000, v15
    s_lshl_b32 s29, s11, 11
    s_lshr_b32 s30, s11, 1
    s_and_b32 s31, s11, 1
    s_lshl_b32 s30, s30, 2
    s_lshl_b32 s31, s31, 4
    s_add_u32 s30, s30, s31
    s_mul_i32 s30, s30, 3456
    s_add_u32 s30, s30, s34
    s_barrier
    s_add_u32 m0, s29, 0
    s_add_u32 s28, s30, 0
    buffer_load_dwordx4 v14, s[20:23], s28 offen lds
    s_add_u32 m0, s29, 1024
    s_add_u32 s28, s30, 27648
    buffer_load_dwordx4 v14, s[20:23], s28 offen lds
    s_add_u32 m0, s29, 8192
    s_add_u32 s28, s30, 110592
    buffer_load_dwordx4 v14, s[20:23], s28 offen lds
    s_add_u32 m0, s29, 9216
    s_add_u32 s28, s30, 138240
    buffer_load_dwordx4 v14, s[20:23], s28 offen lds
    s_add_u32 m0, s29, 16384
    s_add_u32 s28, s30, 221184
    buffer_load_dwordx4 v14, s[20:23], s28 offen lds
    s_add_u32 m0, s29, 17408
    s_add_u32 s28, s30, 248832
    buffer_load_dwordx4 v14, s[20:23], s28 offen lds
    s_add_u32 m0, s29, 24576
    s_add_u32 s28, s30, 331776
    buffer_load_dwordx4 v14, s[20:23], s28 offen lds
    s_add_u32 m0, s29, 25600
    s_add_u32 s28, s30, 359424
    buffer_load_dwordx4 v14, s[20:23], s28 offen lds
    s_add_u32 m0, s29, 32768
    s_add_u32 s28, s30, 442368
    buffer_load_dwordx4 v14, s[20:23], s28 offen lds
    s_add_u32 m0, s29, 33792
    s_add_u32 s28, s30, 470016
    buffer_load_dwordx4 v14, s[20:23], s28 offen lds
    s_add_u32 m0, s29, 40960
    s_add_u32 s28, s30, 552960
    buffer_load_dwordx4 v14, s[20:23], s28 offen lds
    s_add_u32 m0, s29, 41984
    s_add_u32 s28, s30, 580608
    buffer_load_dwordx4 v14, s[20:23], s28 offen lds
    s_add_u32 m0, s29, 49152
    s_add_u32 s28, s30, 663552
    buffer_load_dwordx4 v14, s[20:23], s28 offen lds
    s_add_u32 m0, s29, 50176
    s_add_u32 s28, s30, 691200
    buffer_load_dwordx4 v14, s[20:23], s28 offen lds
    s_add_u32 m0, s29, 57344
    s_add_u32 s28, s30, 774144
    buffer_load_dwordx4 v14, s[20:23], s28 offen lds
    s_add_u32 m0, s29, 58368
    s_add_u32 s28, s30, 801792
    buffer_load_dwordx4 v14, s[20:23], s28 offen lds
    s_add_u32 m0, s29, 65536
    s_add_u32 s28, s30, 884736
    buffer_load_dwordx4 v14, s[20:23], s28 offen lds
    s_add_u32 m0, s29, 66560
    s_add_u32 s28, s30, 912384
    buffer_load_dwordx4 v14, s[20:23], s28 offen lds
    s_add_u32 m0, s29, 73728
    s_add_u32 s28, s30, 995328
    buffer_load_dwordx4 v14, s[20:23], s28 offen lds
    s_add_u32 m0, s29, 74752
    s_add_u32 s28, s30, 1022976
    buffer_load_dwordx4 v14, s[20:23], s28 offen lds
    s_add_u32 m0, s29, 81920
    s_add_u32 s28, s30, 1105920
    buffer_load_dwordx4 v14, s[20:23], s28 offen lds
    s_add_u32 m0, s29, 82944
    s_add_u32 s28, s30, 1133568
    buffer_load_dwordx4 v14, s[20:23], s28 offen lds
    s_add_u32 m0, s29, 90112
    s_add_u32 s28, s30, 1216512
    buffer_load_dwordx4 v14, s[20:23], s28 offen lds
    s_add_u32 m0, s29, 91136
    s_add_u32 s28, s30, 1244160
    buffer_load_dwordx4 v14, s[20:23], s28 offen lds
    s_add_u32 m0, s29, 98304
    s_add_u32 s28, s30, 1327104
    buffer_load_dwordx4 v14, s[20:23], s28 offen lds
    s_add_u32 m0, s29, 99328
    s_add_u32 s28, s30, 1354752
    buffer_load_dwordx4 v14, s[20:23], s28 offen lds
    s_add_u32 m0, s29, 106496
    s_add_u32 s28, s30, 1437696
    buffer_load_dwordx4 v14, s[20:23], s28 offen lds
    s_add_u32 m0, s29, 107520
    s_add_u32 s28, s30, 1465344
    buffer_load_dwordx4 v14, s[20:23], s28 offen lds
    s_add_u32 m0, s29, 114688
    s_add_u32 s28, s30, 1548288
    buffer_load_dwordx4 v14, s[20:23], s28 offen lds
    s_add_u32 m0, s29, 115712
    s_add_u32 s28, s30, 1575936
    buffer_load_dwordx4 v14, s[20:23], s28 offen lds
    s_add_u32 m0, s29, 122880
    s_add_u32 s28, s30, 1658880
    buffer_load_dwordx4 v14, s[20:23], s28 offen lds
    s_add_u32 m0, s29, 123904
    s_add_u32 s28, s30, 1686528
    buffer_load_dwordx4 v14, s[20:23], s28 offen lds
    s_add_u32 m0, s29, 131072
    s_add_u32 s28, s30, 1769472
    buffer_load_dwordx4 v14, s[20:23], s28 offen lds
    s_add_u32 m0, s29, 132096
    s_add_u32 s28, s30, 1797120
    buffer_load_dwordx4 v14, s[20:23], s28 offen lds
    s_add_u32 m0, s29, 139264
    s_add_u32 s28, s30, 1880064
    buffer_load_dwordx4 v14, s[20:23], s28 offen lds
    s_add_u32 m0, s29, 140288
    s_add_u32 s28, s30, 1907712
    buffer_load_dwordx4 v14, s[20:23], s28 offen lds
    s_add_u32 m0, s29, 147456
    s_add_u32 s28, s30, 1990656
    buffer_load_dwordx4 v14, s[20:23], s28 offen lds
    s_add_u32 m0, s29, 148480
    s_add_u32 s28, s30, 2018304
    buffer_load_dwordx4 v14, s[20:23], s28 offen lds
    s_add_u32 m0, s29, 155648
    s_add_u32 s28, s30, 2101248
    buffer_load_dwordx4 v14, s[20:23], s28 offen lds
    s_add_u32 m0, s29, 156672
    s_add_u32 s28, s30, 2128896
    buffer_load_dwordx4 v14, s[20:23], s28 offen lds
    s_waitcnt vmcnt(30)
    s_barrier
    ds_read_b64_tr_b16 a[0:1], v15 offset:0
    ds_read_b64_tr_b16 a[2:3], v15 offset:4096
    ds_read_b64_tr_b16 a[4:5], v15 offset:8
    ds_read_b64_tr_b16 a[6:7], v15 offset:4104
    ds_read_b64_tr_b16 a[8:9], v15 offset:8192
    ds_read_b64_tr_b16 a[10:11], v15 offset:12288
    ds_read_b64_tr_b16 a[12:13], v15 offset:8200
    ds_read_b64_tr_b16 a[14:15], v15 offset:12296
    ds_read_b64_tr_b16 a[16:17], v15 offset:16384
    ds_read_b64_tr_b16 a[18:19], v15 offset:20480
    ds_read_b64_tr_b16 a[20:21], v15 offset:16392
    ds_read_b64_tr_b16 a[22:23], v15 offset:20488
    ds_read_b64_tr_b16 a[24:25], v15 offset:24576
    ds_read_b64_tr_b16 a[26:27], v15 offset:28672
    ds_read_b64_tr_b16 a[28:29], v15 offset:24584
    ds_read_b64_tr_b16 a[30:31], v15 offset:28680
    ds_read_b64_tr_b16 a[32:33], v15 offset:32768
    ds_read_b64_tr_b16 a[34:35], v15 offset:36864
    ds_read_b64_tr_b16 a[36:37], v15 offset:32776
    ds_read_b64_tr_b16 a[38:39], v15 offset:36872
    s_waitcnt vmcnt(20)
    s_barrier
    ds_read_b64_tr_b16 a[40:41], v15 offset:40960
    ds_read_b64_tr_b16 a[42:43], v15 offset:45056
    ds_read_b64_tr_b16 a[44:45], v15 offset:40968
    ds_read_b64_tr_b16 a[46:47], v15 offset:45064
    ds_read_b64_tr_b16 a[48:49], v15 offset:49152
    ds_read_b64_tr_b16 a[50:51], v15 offset:53248
    ds_read_b64_tr_b16 a[52:53], v15 offset:49160
    ds_read_b64_tr_b16 a[54:55], v15 offset:53256
    ds_read_b64_tr_b16 a[56:57], v15 offset:57344
    ds_read_b64_tr_b16 a[58:59], v15 offset:61440
    ds_read_b64_tr_b16 a[60:61], v15 offset:57352
    ds_read_b64_tr_b16 a[62:63], v15 offset:61448
    ds_read_b64_tr_b16 a[64:65], v16 offset:0
    ds_read_b64_tr_b16 a[66:67], v16 offset:4096
    ds_read_b64_tr_b16 a[68:69], v16 offset:8
    ds_read_b64_tr_b16 a[70:71], v16 offset:4104
    ds_read_b64_tr_b16 a[72:73], v16 offset:8192
    ds_read_b64_tr_b16 a[74:75], v16 offset:12288
    ds_read_b64_tr_b16 a[76:77], v16 offset:8200
    ds_read_b64_tr_b16 a[78:79], v16 offset:12296
    s_waitcnt vmcnt(10)
    s_barrier
    ds_read_b64_tr_b16 a[80:81], v16 offset:16384
    ds_read_b64_tr_b16 a[82:83], v16 offset:20480
    ds_read_b64_tr_b16 a[84:85], v16 offset:16392
    ds_read_b64_tr_b16 a[86:87], v16 offset:20488
    ds_read_b64_tr_b16 a[88:89], v16 offset:24576
    ds_read_b64_tr_b16 a[90:91], v16 offset:28672
    ds_read_b64_tr_b16 a[92:93], v16 offset:24584
    ds_read_b64_tr_b16 a[94:95], v16 offset:28680
    ds_read_b64_tr_b16 a[96:97], v16 offset:32768
    ds_read_b64_tr_b16 a[98:99], v16 offset:36864
    ds_read_b64_tr_b16 a[100:101], v16 offset:32776
    ds_read_b64_tr_b16 a[102:103], v16 offset:36872
    ds_read_b64_tr_b16 a[104:105], v16 offset:40960
    ds_read_b64_tr_b16 a[106:107], v16 offset:45056
    ds_read_b64_tr_b16 a[108:109], v16 offset:40968
    ds_read_b64_tr_b16 a[110:111], v16 offset:45064
    ds_read_b64_tr_b16 a[112:113], v16 offset:49152
    ds_read_b64_tr_b16 a[114:115], v16 offset:53248
    ds_read_b64_tr_b16 a[116:117], v16 offset:49160
    ds_read_b64_tr_b16 a[118:119], v16 offset:53256
    s_waitcnt vmcnt(0)
    s_barrier
    ds_read_b64_tr_b16 a[120:121], v16 offset:57344
    ds_read_b64_tr_b16 a[122:123], v16 offset:61440
    ds_read_b64_tr_b16 a[124:125], v16 offset:57352
    ds_read_b64_tr_b16 a[126:127], v16 offset:61448
    ds_read_b64_tr_b16 a[128:129], v17 offset:0
    ds_read_b64_tr_b16 a[130:131], v17 offset:4096
    ds_read_b64_tr_b16 a[132:133], v17 offset:8
    ds_read_b64_tr_b16 a[134:135], v17 offset:4104
    ds_read_b64_tr_b16 a[136:137], v17 offset:8192
    ds_read_b64_tr_b16 a[138:139], v17 offset:12288
    ds_read_b64_tr_b16 a[140:141], v17 offset:8200
    ds_read_b64_tr_b16 a[142:143], v17 offset:12296
    ds_read_b64_tr_b16 a[144:145], v17 offset:16384
    ds_read_b64_tr_b16 a[146:147], v17 offset:20480
    ds_read_b64_tr_b16 a[148:149], v17 offset:16392
    ds_read_b64_tr_b16 a[150:151], v17 offset:20488
    ds_read_b64_tr_b16 a[152:153], v17 offset:24576
    ds_read_b64_tr_b16 a[154:155], v17 offset:28672
    ds_read_b64_tr_b16 a[156:157], v17 offset:24584
    ds_read_b64_tr_b16 a[158:159], v17 offset:28680
    s_waitcnt lgkmcnt(0)
    s_barrier
    s_mul_i32 s36, s40, 54
    s_lshl_b32 s28, s41, 2
    s_add_u32 s36, s36, s28
    s_add_u32 s36, s36, s11
    s_lshl_b32 s36, s36, 10
    s_add_u32 s36, s36, 100663296
    s_mov_b32 s44, 0xbdd2d3e8
    s_mov_b32 s45, 0xbdd2d3e8
    v_mov_b32 v11, 0xc0135761
    s_mov_b32 s46, 0x3acccccd
    v_mov_b32 v10, 0x3727c5ac
    v_mov_b32 v62, 0x3f803f80
    v_mov_b32 v63, 0x3f803f80
    v_mov_b32 v64, 0x3f803f80
    v_mov_b32 v65, 0x3f803f80
    s_nop 1
    v_mfma_f32_16x16x32_bf16 v[78:81], a[0:3], v[62:65], 0
    v_mfma_f32_16x16x32_bf16 v[82:85], a[4:7], v[62:65], 0
    v_mfma_f32_16x16x32_bf16 v[78:81], a[8:11], v[62:65], v[78:81]
    v_mfma_f32_16x16x32_bf16 v[82:85], a[12:15], v[62:65], v[82:85]
    v_mfma_f32_16x16x32_bf16 v[78:81], a[16:19], v[62:65], v[78:81]
    v_mfma_f32_16x16x32_bf16 v[82:85], a[20:23], v[62:65], v[82:85]
    v_mfma_f32_16x16x32_bf16 v[78:81], a[24:27], v[62:65], v[78:81]
    v_mfma_f32_16x16x32_bf16 v[82:85], a[28:31], v[62:65], v[82:85]
    v_mfma_f32_16x16x32_bf16 v[78:81], a[32:35], v[62:65], v[78:81]
    v_mfma_f32_16x16x32_bf16 v[82:85], a[36:39], v[62:65], v[82:85]
    v_mfma_f32_16x16x32_bf16 v[78:81], a[40:43], v[62:65], v[78:81]
    v_mfma_f32_16x16x32_bf16 v[82:85], a[44:47], v[62:65], v[82:85]
    v_mfma_f32_16x16x32_bf16 v[78:81], a[48:51], v[62:65], v[78:81]
    v_mfma_f32_16x16x32_bf16 v[82:85], a[52:55], v[62:65], v[82:85]
    v_mfma_f32_16x16x32_bf16 v[78:81], a[56:59], v[62:65], v[78:81]
    v_mfma_f32_16x16x32_bf16 v[82:85], a[60:63], v[62:65], v[82:85]
    v_mfma_f32_16x16x32_bf16 v[78:81], a[64:67], v[62:65], v[78:81]
    v_mfma_f32_16x16x32_bf16 v[82:85], a[68:71], v[62:65], v[82:85]
    v_mfma_f32_16x16x32_bf16 v[78:81], a[72:75], v[62:65], v[78:81]
    v_mfma_f32_16x16x32_bf16 v[82:85], a[76:79], v[62:65], v[82:85]
    v_mfma_f32_16x16x32_bf16 v[78:81], a[80:83], v[62:65], v[78:81]
    v_mfma_f32_16x16x32_bf16 v[82:85], a[84:87], v[62:65], v[82:85]
    v_mfma_f32_16x16x32_bf16 v[78:81], a[88:91], v[62:65], v[78:81]
    v_mfma_f32_16x16x32_bf16 v[82:85], a[92:95], v[62:65], v[82:85]
    v_mfma_f32_16x16x32_bf16 v[78:81], a[96:99], v[62:65], v[78:81]
    v_mfma_f32_16x16x32_bf16 v[82:85], a[100:103], v[62:65], v[82:85]
    v_mfma_f32_16x16x32_bf16 v[78:81], a[104:107], v[62:65], v[78:81]
    v_mfma_f32_16x16x32_bf16 v[82:85], a[108:111], v[62:65], v[82:85]
    v_mfma_f32_16x16x32_bf16 v[78:81], a[112:115], v[62:65], v[78:81]
    v_mfma_f32_16x16x32_bf16 v[82:85], a[116:119], v[62:65], v[82:85]
    v_mfma_f32_16x16x32_bf16 v[78:81], a[120:123], v[62:65], v[78:81]
    v_mfma_f32_16x16x32_bf16 v[82:85], a[124:127], v[62:65], v[82:85]
    v_mfma_f32_16x16x32_bf16 v[78:81], a[128:131], v[62:65], v[78:81]
    v_mfma_f32_16x16x32_bf16 v[82:85], a[132:135], v[62:65], v[82:85]
    v_mfma_f32_16x16x32_bf16 v[78:81], a[136:139], v[62:65], v[78:81]
    v_mfma_f32_16x16x32_bf16 v[82:85], a[140:143], v[62:65], v[82:85]
    v_mfma_f32_16x16x32_bf16 v[78:81], a[144:147], v[62:65], v[78:81]
    v_mfma_f32_16x16x32_bf16 v[82:85], a[148:151], v[62:65], v[82:85]
    v_mfma_f32_16x16x32_bf16 v[78:81], a[152:155], v[62:65], v[78:81]
    v_mfma_f32_16x16x32_bf16 v[82:85], a[156:159], v[62:65], v[82:85]
    v_mul_u32_u24 v17, 640, v3
    v_lshl_add_u32 v17, v2, 3, v17
    s_mul_i32 s37, s40, 2560
    s_add_u32 s37, s37, 96468992
    s_lshl_b32 s28, s41, 2
    s_add_u32 s28, s28, s11
    s_cmp_lt_u32 s28, 54
    s_cselect_b64 s[48:49], -1, 0
    s_mul_i32 s54, s40, 20
    v_mul_u32_u24 v6, 4, v0
    v_add_u32 v6, s54, v6
    v_add_u32 v6, 69732608, v6
    s_mul_i32 s35, s11, 1024
    s_mul_i32 s34, s40, 20480
    s_add_u32 s34, s34, 92274688
    s_add_u32 s34, s34, s35
    s_mul_i32 s52, s41, 91
    s_lshr_b32 s52, s52, 8
    s_mul_i32 s52, s52, 4096
    v_mov_b32 v5, v1
    s_mov_b32 s12, 0
    s_mov_b32 s55, 0
    s_add_u32 s28, s12, 1
    v_mov_b32 v7, s28
    v_cmp_gt_u32 vcc, 5, v0
    s_nop 1
    v_cndmask_b32 v7, 0, v7, vcc
b3_41:
    s_cmp_eq_u32 s55, 1
    s_cbranch_scc1 b3h_42
bw_44:
    s_sub_u32 s88, s88, 1
    s_cbranch_scc1 k_end
    s_mov_b64 exec, 31
    buffer_load_dword v12, v6, s[16:19], 0 offen sc1
    s_mov_b64 exec, -1
    s_waitcnt vmcnt(0)
bk_45:
    v_cmp_lt_u32 vcc, v12, v7
    s_cbranch_vccnz bw_44
    s_mov_b32 s29, s52
    s_add_u32 m0, s35, s29
    s_add_u32 s28, s34, s29
    buffer_load_dwordx4 v1, s[16:19], s28 offen sc1 lds
    s_add_u32 s29, s29, 4096
    s_cmp_eq_u32 s29, 20480
    s_cselect_b32 s29, 0, s29
    s_add_u32 m0, s35, s29
    s_add_u32 s28, s34, s29
    buffer_load_dwordx4 v1, s[16:19], s28 offen sc1 lds
    s_add_u32 s29, s29, 4096
    s_cmp_eq_u32 s29, 20480
    s_cselect_b32 s29, 0, s29
    s_add_u32 m0, s35, s29
    s_add_u32 s28, s34, s29
    buffer_load_dwordx4 v1, s[16:19], s28 offen sc1 lds
    s_add_u32 s29, s29, 4096
    s_cmp_eq_u32 s29, 20480
    s_cselect_b32 s29, 0, s29
    s_add_u32 m0, s35, s29
    s_add_u32 s28, s34, s29
    buffer_load_dwordx4 v1, s[16:19], s28 offen sc1 lds
    s_add_u32 s29, s29, 4096
    s_cmp_eq_u32 s29, 20480
    s_cselect_b32 s29, 0, s29
    s_add_u32 m0, s35, s29
    s_add_u32 s28, s34, s29
    buffer_load_dwordx4 v1, s[16:19], s28 offen sc1 lds
    s_add_u32 s34, s34, 40960
    s_xor_b32 s35, s35, 65536
b3h_42:
    buffer_load_dwordx2 v[86:87], v17, s[16:19], s37 offen offset:0 sc1
    buffer_load_dwordx2 v[88:89], v17, s[16:19], s37 offen offset:128 sc1
    buffer_load_dwordx2 v[90:91], v17, s[16:19], s37 offen offset:256 sc1
    buffer_load_dwordx2 v[92:93], v17, s[16:19], s37 offen offset:384 sc1
    buffer_load_dwordx2 v[94:95], v17, s[16:19], s37 offen offset:512 sc1
    s_add_u32 s12, s12, 1
    s_add_u32 s28, s12, 1
    v_mov_b32 v7, s28
    v_cmp_gt_u32 vcc, 5, v0
    s_nop 1
    v_cndmask_b32 v7, 0, v7, vcc
    s_mov_b64 exec, 31
    buffer_load_dword v12, v6, s[16:19], 0 offen sc1
    s_mov_b64 exec, -1
    s_waitcnt vmcnt(6)
    s_barrier
    ds_read_b128 v[22:25], v5 offset:0
    ds_read_b128 v[26:29], v5 offset:1024
    ds_read_b128 v[30:33], v5 offset:2048
    ds_read_b128 v[34:37], v5 offset:3072
    ds_read_b128 v[38:41], v5 offset:4096
    ds_read_b128 v[42:45], v5 offset:5120
    ds_read_b128 v[46:49], v5 offset:6144
    ds_read_b128 v[50:53], v5 offset:7168
    s_waitcnt lgkmcnt(7)
    v_mfma_f32_16x16x32_bf16 v[54:57], a[0:3], v[22:25], 0
    v_mfma_f32_16x16x32_bf16 v[58:61], a[4:7], v[22:25], 0
    ds_read_b128 v[22:25], v5 offset:8192
    s_waitcnt lgkmcnt(7)
    v_mfma_f32_16x16x32_bf16 v[54:57], a[8:11], v[26:29], v[54:57]
    v_mfma_f32_16x16x32_bf16 v[58:61], a[12:15], v[26:29], v[58:61]
    ds_read_b128 v[26:29], v5 offset:9216
    s_waitcnt lgkmcnt(7)
    v_mfma_f32_16x16x32_bf16 v[54:57], a[16:19], v[30:33], v[54:57]
    v_mfma_f32_16x16x32_bf16 v[58:61], a[20:23], v[30:33], v[58:61]
    ds_read_b128 v[30:33], v5 offset:10240
    s_waitcnt lgkmcnt(7)
    v_mfma_f32_16x16x32_bf16 v[54:57], a[24:27], v[34:37], v[54:57]
    v_mfma_f32_16x16x32_bf16 v[58:61], a[28:31], v[34:37], v[58:61]
    ds_read_b128 v[34:37], v5 offset:11264
    s_waitcnt lgkmcnt(7)
    v_mfma_f32_16x16x32_bf16 v[54:57], a[32:35], v[38:41], v[54:57]
    v_mfma_f32_16x16x32_bf16 v[58:61], a[36:39], v[38:41], v[58:61]
    ds_read_b128 v[38:41], v5 offset:12288
    s_waitcnt lgkmcnt(7)
    v_mfma_f32_16x16x32_bf16 v[54:57], a[40:43], v[42:45], v[54:57]
    v_mfma_f32_16x16x32_bf16 v[58:61], a[44:47], v[42:45], v[58:61]
    ds_read_b128 v[42:45], v5 offset:13312
    s_waitcnt lgkmcnt(7)
    v_mfma_f32_16x16x32_bf16 v[54:57], a[48:51], v[46:49], v[54:57]
    v_mfma_f32_16x16x32_bf16 v[58:61], a[52:55], v[46:49], v[58:61]
    ds_read_b128 v[46:49], v5 offset:14336
    s_waitcnt lgkmcnt(7)
    v_mfma_f32_16x16x32_bf16 v[54:57], a[56:59], v[50:53], v[54:57]
    v_mfma_f32_16x16x32_bf16 v[58:61], a[60:63], v[50:53], v[58:61]
    ds_read_b128 v[50:53], v5 offset:15360
    s_waitcnt lgkmcnt(7)
    v_mfma_f32_16x16x32_bf16 v[54:57], a[64:67], v[22:25], v[54:57]
    v_mfma_f32_16x16x32_bf16 v[58:61], a[68:71], v[22:25], v[58:61]
    ds_read_b128 v[22:25], v5 offset:16384
    s_waitcnt lgkmcnt(7)
    v_mfma_f32_16x16x32_bf16 v[54:57], a[72:75], v[26:29], v[54:57]
    v_mfma_f32_16x16x32_bf16 v[58:61], a[76:79], v[26:29], v[58:61]
    ds_read_b128 v[26:29], v5 offset:17408
    s_waitcnt lgkmcnt(7)
    v_mfma_f32_16x16x32_bf16 v[54:57], a[80:83], v[30:33], v[54:57]
    v_mfma_f32_16x16x32_bf16 v[58:61], a[84:87], v[30:33], v[58:61]
    ds_read_b128 v[30:33], v5 offset:18432
    s_waitcnt lgkmcnt(7)
    v_mfma_f32_16x16x32_bf16 v[54:57], a[88:91], v[34:37], v[54:57]
    v_mfma_f32_16x16x32_bf16 v[58:61], a[92:95], v[34:37], v[58:61]
    ds_read_b128 v[34:37], v5 offset:19456
    s_waitcnt lgkmcnt(7)
    v_mfma_f32_16x16x32_bf16 v[54:57], a[96:99], v[38:41], v[54:57]
    v_mfma_f32_16x16x32_bf16 v[58:61], a[100:103], v[38:41], v[58:61]
    s_waitcnt lgkmcnt(6)
    v_mfma_f32_16x16x32_bf16 v[54:57], a[104:107], v[42:45], v[54:57]
    v_mfma_f32_16x16x32_bf16 v[58:61], a[108:111], v[42:45], v[58:61]
    s_waitcnt lgkmcnt(5)
    v_mfma_f32_16x16x32_bf16 v[54:57], a[112:115], v[46:49], v[54:57]
    v_mfma_f32_16x16x32_bf16 v[58:61], a[116:119], v[46:49], v[58:61]
    s_waitcnt lgkmcnt(4)
    v_mfma_f32_16x16x32_bf16 v[54:57], a[120:123], v[50:53], v[54:57]
    v_mfma_f32_16x16x32_bf16 v[58:61], a[124:127], v[50:53], v[58:61]
    s_waitcnt lgkmcnt(3)
    v_mfma_f32_16x16x32_bf16 v[54:57], a[128:131], v[22:25], v[54:57]
    v_mfma_f32_16x16x32_bf16 v[58:61], a[132:135], v[22:25], v[58:61]
    s_waitcnt lgkmcnt(2)
    v_mfma_f32_16x16x32_bf16 v[54:57], a[136:139], v[26:29], v[54:57]
    v_mfma_f32_16x16x32_bf16 v[58:61], a[140:143], v[26:29], v[58:61]
    s_waitcnt lgkmcnt(1)
    v_mfma_f32_16x16x32_bf16 v[54:57], a[144:147], v[30:33], v[54:57]
    v_mfma_f32_16x16x32_bf16 v[58:61], a[148:151], v[30:33], v[58:61]
    s_waitcnt lgkmcnt(0)
    v_mfma_f32_16x16x32_bf16 v[54:57], a[152:155], v[34:37], v[54:57]
    v_mfma_f32_16x16x32_bf16 v[58:61], a[156:159], v[34:37], v[58:61]
    v_xor_b32 v5, 65536, v5
    s_waitcnt vmcnt(0)
    v_cmp_lt_u32 vcc, v12, v7
    s_mov_b32 s55, 0
    s_cbranch_vccnz b3n_43
    s_mov_b32 s29, s52
    s_add_u32 m0, s35, s29
    s_add_u32 s28, s34, s29
    buffer_load_dwordx4 v1, s[16:19], s28 offen sc1 lds
    s_add_u32 s29, s29, 4096
    s_cmp_eq_u32 s29, 20480
    s_cselect_b32 s29, 0, s29
    s_add_u32 m0, s35, s29
    s_add_u32 s28, s34, s29
    buffer_load_dwordx4 v1, s[16:19], s28 offen sc1 lds
    s_add_u32 s29, s29, 4096
    s_cmp_eq_u32 s29, 20480
    s_cselect_b32 s29, 0, s29
    s_add_u32 m0, s35, s29
    s_add_u32 s28, s34, s29
    buffer_load_dwordx4 v1, s[16:19], s28 offen sc1 lds
    s_add_u32 s29, s29, 4096
    s_cmp_eq_u32 s29, 20480
    s_cselect_b32 s29, 0, s29
    s_add_u32 m0, s35, s29
    s_add_u32 s28, s34, s29
    buffer_load_dwordx4 v1, s[16:19], s28 offen sc1 lds
    s_add_u32 s29, s29, 4096
    s_cmp_eq_u32 s29, 20480
    s_cselect_b32 s29, 0, s29
    s_add_u32 m0, s35, s29
    s_add_u32 s28, s34, s29
    buffer_load_dwordx4 v1, s[16:19], s28 offen sc1 lds
    s_add_u32 s34, s34, 40960
    s_xor_b32 s35, s35, 65536
    s_mov_b32 s55, 1
b3n_43:
    v_pk_add_f32 v[86:87], v[86:87], v[88:89]
    v_pk_add_f32 v[86:87], v[86:87], v[90:91]
    v_pk_add_f32 v[86:87], v[86:87], v[92:93]
    v_pk_add_f32 v[86:87], v[86:87], v[94:95]
    v_mov_b32 v88, v86
    v_mov_b32 v89, v87
    s_nop 1
    v_permlane16_swap_b32 v86, v88
    v_permlane16_swap_b32 v87, v89
    v_add_f32 v86, v86, v88
    v_add_f32 v87, v87, v89
    v_mov_b32 v88, v86
    v_mov_b32 v89, v87
    s_nop 1
    v_permlane32_swap_b32 v86, v88
    v_permlane32_swap_b32 v87, v89
    v_add_f32 v86, v86, v88
    v_add_f32 v87, v87, v89
    v_mul_f32 v86, s46, v86
    v_mul_f32 v87, s46, v87
    v_fma_f32 v87, -v86, v86, v87
    v_max_f32 v87, 0, v87
    v_add_f32 v88, v87, v10
    v_rsq_f32 v88, v88
    s_nop 0
    v_fma_f32 v54, -v86, v78, v54
    v_fma_f32 v55, -v86, v79, v55
    v_fma_f32 v56, -v86, v80, v56
    v_fma_f32 v57, -v86, v81, v57
    v_fma_f32 v58, -v86, v82, v58
    v_fma_f32 v59, -v86, v83, v59
    v_fma_f32 v60, -v86, v84, v60
    v_fma_f32 v61, -v86, v85, v61
    v_mul_f32 v54, v54, v88
    v_mul_f32 v55, v55, v88
    v_mul_f32 v56, v56, v88
    v_mul_f32 v57, v57, v88
    v_mul_f32 v58, v58, v88
    v_mul_f32 v59, v59, v88
    v_mul_f32 v60, v60, v88
    v_mul_f32 v61, v61, v88
    v_cvt_pk_bf16_f32 v62, v54, v55
    v_cvt_pk_bf16_f32 v63, v56, v57
    v_cvt_pk_bf16_f32 v64, v58, v59
    v_cvt_pk_bf16_f32 v65, v60, v61
    v_and_b32 v55, 0xffff0000, v62
    v_lshlrev_b32 v54, 16, v62
    v_and_b32 v57, 0xffff0000, v63
    v_lshlrev_b32 v56, 16, v63
    v_and_b32 v59, 0xffff0000, v64
    v_lshlrev_b32 v58, 16, v64
    v_and_b32 v61, 0xffff0000, v65
    v_lshlrev_b32 v60, 16, v65
    v_pk_mul_f32 v[62:63], v[54:55], v[54:55]
    v_pk_mul_f32 v[64:65], v[56:57], v[56:57]
    v_pk_mul_f32 v[66:67], v[58:59], v[58:59]
    v_pk_mul_f32 v[68:69], v[60:61], v[60:61]
    v_pk_fma_f32 v[62:63], v[62:63], s[44:45], v[10:11] op_sel:[0,0,1] op_sel_hi:[1,1,1]
    v_pk_fma_f32 v[64:65], v[64:65], s[44:45], v[10:11] op_sel:[0,0,1] op_sel_hi:[1,1,1]
    v_pk_fma_f32 v[66:67], v[66:67], s[44:45], v[10:11] op_sel:[0,0,1] op_sel_hi:[1,1,1]
    v_pk_fma_f32 v[68:69], v[68:69], s[44:45], v[10:11] op_sel:[0,0,1] op_sel_hi:[1,1,1]
    v_pk_mul_f32 v[62:63], v[62:63], v[54:55]
    v_pk_mul_f32 v[64:65], v[64:65], v[56:57]
    v_pk_mul_f32 v[66:67], v[66:67], v[58:59]
    v_pk_mul_f32 v[68:69], v[68:69], v[60:61]
    v_exp_f32 v62, v62
    v_exp_f32 v63, v63
    v_exp_f32 v64, v64
    v_exp_f32 v65, v65
    v_exp_f32 v66, v66
    v_exp_f32 v67, v67
    v_exp_f32 v68, v68
    v_exp_f32 v69, v69
    v_pk_add_f32 v[62:63], v[62:63], 1.0 op_sel_hi:[1,0]
    v_pk_add_f32 v[64:65], v[64:65], 1.0 op_sel_hi:[1,0]
    v_pk_add_f32 v[66:67], v[66:67], 1.0 op_sel_hi:[1,0]
    v_pk_add_f32 v[68:69], v[68:69], 1.0 op_sel_hi:[1,0]
    v_rcp_f32 v62, v62
    v_rcp_f32 v63, v63
    v_rcp_f32 v64, v64
    v_rcp_f32 v65, v65
    v_rcp_f32 v66, v66
    v_rcp_f32 v67, v67
    v_rcp_f32 v68, v68
    v_rcp_f32 v69, v69
    v_pk_mul_f32 v[54:55], v[54:55], v[62:63]
    v_pk_mul_f32 v[56:57], v[56:57], v[64:65]
    v_pk_mul_f32 v[58:59], v[58:59], v[66:67]
    v_pk_mul_f32 v[60:61], v[60:61], v[68:69]
    v_cvt_pk_bf16_f32 v62, v54, v55
    v_cvt_pk_bf16_f32 v63, v56, v57
    v_cvt_pk_bf16_f32 v64, v58, v59
    v_cvt_pk_bf16_f32 v65, v60, v61
    s_mov_b64 exec, s[48:49]
    buffer_store_dwordx4 v[62:65], v1, s[16:19], s36 offen sc1
    s_mov_b64 exec, -1
    s_add_u32 s36, s36, 110592
    s_add_u32 s37, s37, 5120
    s_waitcnt vmcnt(0)
    s_barrier
    v_mov_b32 v8, s12
    s_mov_b64 exec, s[14:15]
    buffer_store_dword v8, v0, s[16:19], s39 offen sc1
    s_mov_b64 exec, -1
    s_cmp_lt_u32 s12, 64
    s_cbranch_scc1 b3_41
    s_branch k_end
role_40:
    s_cmp_lt_u32 s10, 116
    s_cbranch_scc1 role_46
    s_cmp_ge_u32 s10, 126
    s_cbranch_scc1 role_46
    s_sub_u32 s41, s10, 116
    s_cmp_ge_u32 s41, 5
    s_cselect_b32 s40, 1, 0
    s_mul_i32 s28, s40, 5
    s_sub_u32 s41, s41, s28
    s_sub_u32 s39, s10, 116
    s_lshl_b32 s39, s39, 2
    s_add_u32 s39, s39, 69732352
    s_load_dwordx2 s[20:21], s[0:1], 64
    s_waitcnt lgkmcnt(0)
    s_mov_b32 s22, 819200
    s_mov_b32 s23, 0x20000
    s_lshl_b32 s34, s41, 8
    v_lshrrev_b32 v8, 4, v0
    v_and_b32 v9, 15, v0
    v_lshlrev_b32 v10, 2, v8
    v_xor_b32 v9, v9, v10
    s_mov_b32 s28, 1280
    v_mul_lo_u32 v14, v8, s28
    v_lshl_add_u32 v14, v9, 4, v14
    v_lshrrev_b32 v8, 2, v0
    v_lshlrev_b32 v15, 8, v8
    v_and_b32 v8, 3, v8
    v_xor_b32 v8, s11, v8
    v_lshl_add_u32 v15, v8, 6, v15
    v_and_b32 v8, 3, v0
    v_lshl_add_u32 v15, v8, 4, v15
    v_add_u32 v16, 0x10000, v15
    v_add_u32 v17, 0x20000, v15
    s_lshl_b32 s29, s11, 11
    s_lshr_b32 s30, s11, 1
    s_and_b32 s31, s11, 1
    s_lshl_b32 s30, s30, 2
    s_lshl_b32 s31, s31, 4
    s_add_u32 s30, s30, s31
    s_mul_i32 s30, s30, 1280
    s_add_u32 s30, s30, s34
    s_barrier
    s_add_u32 m0, s29, 0
    s_add_u32 s28, s30, 0
    buffer_load_dwordx4 v14, s[20:23], s28 offen lds
    s_add_u32 m0, s29, 1024
    s_add_u32 s28, s30, 10240
    buffer_load_dwordx4 v14, s[20:23], s28 offen lds
    s_add_u32 m0, s29, 8192
    s_add_u32 s28, s30, 40960
    buffer_load_dwordx4 v14, s[20:23], s28 offen lds
    s_add_u32 m0, s29, 9216
    s_add_u32 s28, s30, 51200
    buffer_load_dwordx4 v14, s[20:23], s28 offen lds
    s_add_u32 m0, s29, 16384
    s_add_u32 s28, s30, 81920
    buffer_load_dwordx4 v14, s[20:23], s28 offen lds
    s_add_u32 m0, s29, 17408
    s_add_u32 s28, s30, 92160
    buffer_load_dwordx4 v14, s[20:23], s28 offen lds
    s_add_u32 m0, s29, 24576
    s_add_u32 s28, s30, 122880
    buffer_load_dwordx4 v14, s[20:23], s28 offen lds
    s_add_u32 m0, s29, 25600
    s_add_u32 s28, s30, 133120
    buffer_load_dwordx4 v14, s[20:23], s28 offen lds
    s_add_u32 m0, s29, 32768
    s_add_u32 s28, s30, 163840
    buffer_load_dwordx4 v14, s[20:23], s28 offen lds
    s_add_u32 m0, s29, 33792
    s_add_u32 s28, s30, 174080
    buffer_load_dwordx4 v14, s[20:23], s28 offen lds
    s_add_u32 m0, s29, 40960
    s_add_u32 s28, s30, 204800
    buffer_load_dwordx4 v14, s[20:23], s28 offen lds
    s_add_u32 m0, s29, 41984
    s_add_u32 s28, s30, 215040
    buffer_load_dwordx4 v14, s[20:23], s28 offen lds
    s_add_u32 m0, s29, 49152
    s_add_u32 s28, s30, 245760
    buffer_load_dwordx4 v14, s[20:23], s28 offen lds
    s_add_u32 m0, s29, 50176
    s_add_u32 s28, s30, 256000
    buffer_load_dwordx4 v14, s[20:23], s28 offen lds
    s_add_u32 m0, s29, 57344
    s_add_u32 s28, s30, 286720
    buffer_load_dwordx4 v14, s[20:23], s28 offen lds
    s_add_u32 m0, s29, 58368
    s_add_u32 s28, s30, 296960
    buffer_load_dwordx4 v14, s[20:23], s28 offen lds
    s_add_u32 m0, s29, 65536
    s_add_u32 s28, s30, 327680
    buffer_load_dwordx4 v14, s[20:23], s28 offen lds
    s_add_u32 m0, s29, 66560
    s_add_u32 s28, s30, 337920
    buffer_load_dwordx4 v14, s[20:23], s28 offen lds
    s_add_u32 m0, s29, 73728
    s_add_u32 s28, s30, 368640
    buffer_load_dwordx4 v14, s[20:23], s28 offen lds
    s_add_u32 m0, s29, 74752
    s_add_u32 s28, s30, 378880
    buffer_load_dwordx4 v14, s[20:23], s28 offen lds
    s_add_u32 m0, s29, 81920
    s_add_u32 s28, s30, 409600
    buffer_load_dwordx4 v14, s[20:23], s28 offen lds
    s_add_u32 m0, s29, 82944
    s_add_u32 s28, s30, 419840
    buffer_load_dwordx4 v14, s[20:23], s28 offen lds
    s_add_u32 m0, s29, 90112
    s_add_u32 s28, s30, 450560
    buffer_load_dwordx4 v14, s[20:23], s28 offen lds
    s_add_u32 m0, s29, 91136
    s_add_u32 s28, s30, 460800
    buffer_load_dwordx4 v14, s[20:23], s28 offen lds
    s_add_u32 m0, s29, 98304
    s_add_u32 s28, s30, 491520
    buffer_load_dwordx4 v14, s[20:23], s28 offen lds
    s_add_u32 m0, s29, 99328
    s_add_u32 s28, s30, 501760
    buffer_load_dwordx4 v14, s[20:23], s28 offen lds
    s_add_u32 m0, s29, 106496
    s_add_u32 s28, s30, 532480
    buffer_load_dwordx4 v14, s[20:23], s28 offen lds
    s_add_u32 m0, s29, 107520
    s_add_u32 s28, s30, 542720
    buffer_load_dwordx4 v14, s[20:23], s28 offen lds
    s_add_u32 m0, s29, 114688
    s_add_u32 s28, s30, 573440
    buffer_load_dwordx4 v14, s[20:23], s28 offen lds
    s_add_u32 m0, s29, 115712
    s_add_u32 s28, s30, 583680
    buffer_load_dwordx4 v14, s[20:23], s28 offen lds
    s_add_u32 m0, s29, 122880
    s_add_u32 s28, s30, 614400
    buffer_load_dwordx4 v14, s[20:23], s28 offen lds
    s_add_u32 m0, s29, 123904
    s_add_u32 s28, s30, 624640
    buffer_load_dwordx4 v14, s[20:23], s28 offen lds
    s_add_u32 m0, s29, 131072
    s_add_u32 s28, s30, 655360
    buffer_load_dwordx4 v14, s[20:23], s28 offen lds
    s_add_u32 m0, s29, 132096
    s_add_u32 s28, s30, 665600
    buffer_load_dwordx4 v14, s[20:23], s28 offen lds
    s_add_u32 m0, s29, 139264
    s_add_u32 s28, s30, 696320
    buffer_load_dwordx4 v14, s[20:23], s28 offen lds
    s_add_u32 m0, s29, 140288
    s_add_u32 s28, s30, 706560
    buffer_load_dwordx4 v14, s[20:23], s28 offen lds
    s_add_u32 m0, s29, 147456
    s_add_u32 s28, s30, 737280
    buffer_load_dwordx4 v14, s[20:23], s28 offen lds
    s_add_u32 m0, s29, 148480
    s_add_u32 s28, s30, 747520
    buffer_load_dwordx4 v14, s[20:23], s28 offen lds
    s_add_u32 m0, s29, 155648
    s_add_u32 s28, s30, 778240
    buffer_load_dwordx4 v14, s[20:23], s28 offen lds
    s_add_u32 m0, s29, 156672
    s_add_u32 s28, s30, 788480
    buffer_load_dwordx4 v14, s[20:23], s28 offen lds
    s_waitcnt vmcnt(30)
    s_barrier
    ds_read_b64_tr_b16 a[0:1], v15 offset:0
    ds_read_b64_tr_b16 a[2:3], v15 offset:4096
    ds_read_b64_tr_b16 a[4:5], v15 offset:8
    ds_read_b64_tr_b16 a[6:7], v15 offset:4104
    ds_read_b64_tr_b16 a[8:9], v15 offset:8192
    ds_read_b64_tr_b16 a[10:11], v15 offset:12288
    ds_read_b64_tr_b16 a[12:13], v15 offset:8200
    ds_read_b64_tr_b16 a[14:15], v15 offset:12296
    ds_read_b64_tr_b16 a[16:17], v15 offset:16384
    ds_read_b64_tr_b16 a[18:19], v15 offset:20480
    ds_read_b64_tr_b16 a[20:21], v15 offset:16392
    ds_read_b64_tr_b16 a[22:23], v15 offset:20488
    ds_read_b64_tr_b16 a[24:25], v15 offset:24576
    ds_read_b64_tr_b16 a[26:27], v15 offset:28672
    ds_read_b64_tr_b16 a[28:29], v15 offset:24584
    ds_read_b64_tr_b16 a[30:31], v15 offset:28680
    ds_read_b64_tr_b16 a[32:33], v15 offset:32768
    ds_read_b64_tr_b16 a[34:35], v15 offset:36864
    ds_read_b64_tr_b16 a[36:37], v15 offset:32776
    ds_read_b64_tr_b16 a[38:39], v15 offset:36872
    s_waitcnt vmcnt(20)
    s_barrier
    ds_read_b64_tr_b16 a[40:41], v15 offset:40960
    ds_read_b64_tr_b16 a[42:43], v15 offset:45056
    ds_read_b64_tr_b16 a[44:45], v15 offset:40968
    ds_read_b64_tr_b16 a[46:47], v15 offset:45064
    ds_read_b64_tr_b16 a[48:49], v15 offset:49152
    ds_read_b64_tr_b16 a[50:51], v15 offset:53248
    ds_read_b64_tr_b16 a[52:53], v15 offset:49160
    ds_read_b64_tr_b16 a[54:55], v15 offset:53256
    ds_read_b64_tr_b16 a[56:57], v15 offset:57344
    ds_read_b64_tr_b16 a[58:59], v15 offset:61440
    ds_read_b64_tr_b16 a[60:61], v15 offset:57352
    ds_read_b64_tr_b16 a[62:63], v15 offset:61448
    ds_read_b64_tr_b16 a[64:65], v16 offset:0
    ds_read_b64_tr_b16 a[66:67], v16 offset:4096
    ds_read_b64_tr_b16 a[68:69], v16 offset:8
    ds_read_b64_tr_b16 a[70:71], v16 offset:4104
    ds_read_b64_tr_b16 a[72:73], v16 offset:8192
    ds_read_b64_tr_b16 a[74:75], v16 offset:12288
    ds_read_b64_tr_b16 a[76:77], v16 offset:8200
    ds_read_b64_tr_b16 a[78:79], v16 offset:12296
    s_waitcnt vmcnt(10)
    s_barrier
    ds_read_b64_tr_b16 a[80:81], v16 offset:16384
    ds_read_b64_tr_b16 a[82:83], v16 offset:20480
    ds_read_b64_tr_b16 a[84:85], v16 offset:16392
    ds_read_b64_tr_b16 a[86:87], v16 offset:20488
    ds_read_b64_tr_b16 a[88:89], v16 offset:24576
    ds_read_b64_tr_b16 a[90:91], v16 offset:28672
    ds_read_b64_tr_b16 a[92:93], v16 offset:24584
    ds_read_b64_tr_b16 a[94:95], v16 offset:28680
    ds_read_b64_tr_b16 a[96:97], v16 offset:32768
    ds_read_b64_tr_b16 a[98:99], v16 offset:36864
    ds_read_b64_tr_b16 a[100:101], v16 offset:32776
    ds_read_b64_tr_b16 a[102:103], v16 offset:36872
    ds_read_b64_tr_b16 a[104:105], v16 offset:40960
    ds_read_b64_tr_b16 a[106:107], v16 offset:45056
    ds_read_b64_tr_b16 a[108:109], v16 offset:40968
    ds_read_b64_tr_b16 a[110:111], v16 offset:45064
    ds_read_b64_tr_b16 a[112:113], v16 offset:49152
    ds_read_b64_tr_b16 a[114:115], v16 offset:53248
    ds_read_b64_tr_b16 a[116:117], v16 offset:49160
    ds_read_b64_tr_b16 a[118:119], v16 offset:53256
    s_waitcnt vmcnt(0)
    s_barrier
    ds_read_b64_tr_b16 a[120:121], v16 offset:57344
    ds_read_b64_tr_b16 a[122:123], v16 offset:61440
    ds_read_b64_tr_b16 a[124:125], v16 offset:57352
    ds_read_b64_tr_b16 a[126:127], v16 offset:61448
    ds_read_b64_tr_b16 a[128:129], v17 offset:0
    ds_read_b64_tr_b16 a[130:131], v17 offset:4096
    ds_read_b64_tr_b16 a[132:133], v17 offset:8
    ds_read_b64_tr_b16 a[134:135], v17 offset:4104
    ds_read_b64_tr_b16 a[136:137], v17 offset:8192
    ds_read_b64_tr_b16 a[138:139], v17 offset:12288
    ds_read_b64_tr_b16 a[140:141], v17 offset:8200
    ds_read_b64_tr_b16 a[142:143], v17 offset:12296
    ds_read_b64_tr_b16 a[144:145], v17 offset:16384
    ds_read_b64_tr_b16 a[146:147], v17 offset:20480
    ds_read_b64_tr_b16 a[148:149], v17 offset:16392
    ds_read_b64_tr_b16 a[150:151], v17 offset:20488
    ds_read_b64_tr_b16 a[152:153], v17 offset:24576
    ds_read_b64_tr_b16 a[154:155], v17 offset:28672
    ds_read_b64_tr_b16 a[156:157], v17 offset:24584
    ds_read_b64_tr_b16 a[158:159], v17 offset:28680
    s_waitcnt lgkmcnt(0)
    s_barrier
    s_mul_i32 s36, s40, 20
    s_lshl_b32 s28, s41, 2
    s_add_u32 s36, s36, s28
    s_add_u32 s36, s36, s11
    s_lshl_b32 s36, s36, 10
    s_add_u32 s36, s36, 88080384
    s_mov_b32 s44, 0xbdd2d3e8
    s_mov_b32 s45, 0xbdd2d3e8
    v_mov_b32 v11, 0xc0135761
    s_mov_b32 s46, 0x3acccccd
    v_mov_b32 v10, 0x3727c5ac
    v_mov_b32 v62, 0x3f803f80
    v_mov_b32 v63, 0x3f803f80
    v_mov_b32 v64, 0x3f803f80
    v_mov_b32 v65, 0x3f803f80
    s_nop 1
    v_mfma_f32_16x16x32_bf16 v[78:81], a[0:3], v[62:65], 0
    v_mfma_f32_16x16x32_bf16 v[82:85], a[4:7], v[62:65], 0
    v_mfma_f32_16x16x32_bf16 v[78:81], a[8:11], v[62:65], v[78:81]
    v_mfma_f32_16x16x32_bf16 v[82:85], a[12:15], v[62:65], v[82:85]
    v_mfma_f32_16x16x32_bf16 v[78:81], a[16:19], v[62:65], v[78:81]
    v_mfma_f32_16x16x32_bf16 v[82:85], a[20:23], v[62:65], v[82:85]
    v_mfma_f32_16x16x32_bf16 v[78:81], a[24:27], v[62:65], v[78:81]
    v_mfma_f32_16x16x32_bf16 v[82:85], a[28:31], v[62:65], v[82:85]
    v_mfma_f32_16x16x32_bf16 v[78:81], a[32:35], v[62:65], v[78:81]
    v_mfma_f32_16x16x32_bf16 v[82:85], a[36:39], v[62:65], v[82:85]
    v_mfma_f32_16x16x32_bf16 v[78:81], a[40:43], v[62:65], v[78:81]
    v_mfma_f32_16x16x32_bf16 v[82:85], a[44:47], v[62:65], v[82:85]
    v_mfma_f32_16x16x32_bf16 v[78:81], a[48:51], v[62:65], v[78:81]
    v_mfma_f32_16x16x32_bf16 v[82:85], a[52:55], v[62:65], v[82:85]
    v_mfma_f32_16x16x32_bf16 v[78:81], a[56:59], v[62:65], v[78:81]
    v_mfma_f32_16x16x32_bf16 v[82:85], a[60:63], v[62:65], v[82:85]
    v_mfma_f32_16x16x32_bf16 v[78:81], a[64:67], v[62:65], v[78:81]
    v_mfma_f32_16x16x32_bf16 v[82:85], a[68:71], v[62:65], v[82:85]
    v_mfma_f32_16x16x32_bf16 v[78:81], a[72:75], v[62:65], v[78:81]
    v_mfma_f32_16x16x32_bf16 v[82:85], a[76:79], v[62:65], v[82:85]
    v_mfma_f32_16x16x32_bf16 v[78:81], a[80:83], v[62:65], v[78:81]
    v_mfma_f32_16x16x32_bf16 v[82:85], a[84:87], v[62:65], v[82:85]
    v_mfma_f32_16x16x32_bf16 v[78:81], a[88:91], v[62:65], v[78:81]
    v_mfma_f32_16x16x32_bf16 v[82:85], a[92:95], v[62:65], v[82:85]
    v_mfma_f32_16x16x32_bf16 v[78:81], a[96:99], v[62:65], v[78:81]
    v_mfma_f32_16x16x32_bf16 v[82:85], a[100:103], v[62:65], v[82:85]
    v_mfma_f32_16x16x32_bf16 v[78:81], a[104:107], v[62:65], v[78:81]
    v_mfma_f32_16x16x32_bf16 v[82:85], a[108:111], v[62:65], v[82:85]
    v_mfma_f32_16x16x32_bf16 v[78:81], a[112:115], v[62:65], v[78:81]
    v_mfma_f32_16x16x32_bf16 v[82:85], a[116:119], v[62:65], v[82:85]
    v_mfma_f32_16x16x32_bf16 v[78:81], a[120:123], v[62:65], v[78:81]
    v_mfma_f32_16x16x32_bf16 v[82:85], a[124:127], v[62:65], v[82:85]
    v_mfma_f32_16x16x32_bf16 v[78:81], a[128:131], v[62:65], v[78:81]
    v_mfma_f32_16x16x32_bf16 v[82:85], a[132:135], v[62:65], v[82:85]
    v_mfma_f32_16x16x32_bf16 v[78:81], a[136:139], v[62:65], v[78:81]
    v_mfma_f32_16x16x32_bf16 v[82:85], a[140:143], v[62:65], v[82:85]
    v_mfma_f32_16x16x32_bf16 v[78:81], a[144:147], v[62:65], v[78:81]
    v_mfma_f32_16x16x32_bf16 v[82:85], a[148:151], v[62:65], v[82:85]
    v_mfma_f32_16x16x32_bf16 v[78:81], a[152:155], v[62:65], v[78:81]
    v_mfma_f32_16x16x32_bf16 v[82:85], a[156:159], v[62:65], v[82:85]
    v_mul_u32_u24 v17, 640, v3
    v_lshl_add_u32 v17, v2, 3, v17
    s_mul_i32 s37, s40, 2560
    s_add_u32 s37, s37, 83886080
    s_mul_i32 s35, s11, 1024
    s_mul_i32 s34, s40, 20480
    s_add_u32 s34, s34, 75497472
    s_add_u32 s34, s34, s35
    s_mul_i32 s52, s41, 256
    s_lshr_b32 s52, s52, 8
    s_mul_i32 s52, s52, 4096
    v_mov_b32 v5, v1
    s_mov_b32 s12, 0
    s_mov_b32 s55, 0
    s_and_b32 s54, s12, 1
    s_lshl_b32 s54, s54, 1
    s_add_u32 s54, s54, s40
    s_lshl_b32 s54, s54, 7
    v_mul_u32_u24 v6, 4, v0
    v_add_u32 v6, s54, v6
    v_add_u32 v6, 69731840, v6
    s_add_u32 s28, s12, 1
    v_mov_b32 v7, s28
    v_cmp_gt_u32 vcc, 20, v0
    s_nop 1
    v_cndmask_b32 v7, 0, v7, vcc
b1_47:
    s_cmp_eq_u32 s55, 1
    s_cbranch_scc1 b1h_48
bw_50:
    s_sub_u32 s88, s88, 1
    s_cbranch_scc1 k_end
    s_mov_b64 exec, 1048575
    buffer_load_dword v12, v6, s[16:19], 0 offen sc1
    s_mov_b64 exec, -1
    s_waitcnt vmcnt(0)
bk_51:
    v_cmp_lt_u32 vcc, v12, v7
    s_cbranch_vccnz bw_50
    s_mov_b32 s29, s52
    s_add_u32 m0, s35, s29
    s_add_u32 s28, s34, s29
    buffer_load_dwordx4 v1, s[16:19], s28 offen sc1 lds
    s_add_u32 s29, s29, 4096
    s_cmp_eq_u32 s29, 20480
    s_cselect_b32 s29, 0, s29
    s_add_u32 m0, s35, s29
    s_add_u32 s28, s34, s29
    buffer_load_dwordx4 v1, s[16:19], s28 offen sc1 lds
    s_add_u32 s29, s29, 4096
    s_cmp_eq_u32 s29, 20480
    s_cselect_b32 s29, 0, s29
    s_add_u32 m0, s35, s29
    s_add_u32 s28, s34, s29
    buffer_load_dwordx4 v1, s[16:19], s28 offen sc1 lds
    s_add_u32 s29, s29, 4096
    s_cmp_eq_u32 s29, 20480
    s_cselect_b32 s29, 0, s29
    s_add_u32 m0, s35, s29
    s_add_u32 s28, s34, s29
    buffer_load_dwordx4 v1, s[16:19], s28 offen sc1 lds
    s_add_u32 s29, s29, 4096
    s_cmp_eq_u32 s29, 20480
    s_cselect_b32 s29, 0, s29
    s_add_u32 m0, s35, s29
    s_add_u32 s28, s34, s29
    buffer_load_dwordx4 v1, s[16:19], s28 offen sc1 lds
    s_add_u32 s34, s34, 40960
    s_xor_b32 s35, s35, 65536
b1h_48:
    buffer_load_dwordx2 v[86:87], v17, s[16:19], s37 offen offset:0 sc1
    buffer_load_dwordx2 v[88:89], v17, s[16:19], s37 offen offset:128 sc1
    buffer_load_dwordx2 v[90:91], v17, s[16:19], s37 offen offset:256 sc1
    buffer_load_dwordx2 v[92:93], v17, s[16:19], s37 offen offset:384 sc1
    buffer_load_dwordx2 v[94:95], v17, s[16:19], s37 offen offset:512 sc1
    s_add_u32 s12, s12, 1
    s_and_b32 s54, s12, 1
    s_lshl_b32 s54, s54, 1
    s_add_u32 s54, s54, s40
    s_lshl_b32 s54, s54, 7
    v_mul_u32_u24 v6, 4, v0
    v_add_u32 v6, s54, v6
    v_add_u32 v6, 69731840, v6
    s_add_u32 s28, s12, 1
    v_mov_b32 v7, s28
    v_cmp_gt_u32 vcc, 20, v0
    s_nop 1
    v_cndmask_b32 v7, 0, v7, vcc
    s_mov_b64 exec, 1048575
    buffer_load_dword v12, v6, s[16:19], 0 offen sc1
    s_mov_b64 exec, -1
    s_waitcnt vmcnt(6)
    s_barrier
    ds_read_b128 v[22:25], v5 offset:0
    ds_read_b128 v[26:29], v5 offset:1024
    ds_read_b128 v[30:33], v5 offset:2048
    ds_read_b128 v[34:37], v5 offset:3072
    ds_read_b128 v[38:41], v5 offset:4096
    ds_read_b128 v[42:45], v5 offset:5120
    ds_read_b128 v[46:49], v5 offset:6144
    ds_read_b128 v[50:53], v5 offset:7168
    s_waitcnt lgkmcnt(7)
    v_mfma_f32_16x16x32_bf16 v[54:57], a[0:3], v[22:25], 0
    v_mfma_f32_16x16x32_bf16 v[58:61], a[4:7], v[22:25], 0
    ds_read_b128 v[22:25], v5 offset:8192
    s_waitcnt lgkmcnt(7)
    v_mfma_f32_16x16x32_bf16 v[54:57], a[8:11], v[26:29], v[54:57]
    v_mfma_f32_16x16x32_bf16 v[58:61], a[12:15], v[26:29], v[58:61]
    ds_read_b128 v[26:29], v5 offset:9216
    s_waitcnt lgkmcnt(7)
    v_mfma_f32_16x16x32_bf16 v[54:57], a[16:19], v[30:33], v[54:57]
    v_mfma_f32_16x16x32_bf16 v[58:61], a[20:23], v[30:33], v[58:61]
    ds_read_b128 v[30:33], v5 offset:10240
    s_waitcnt lgkmcnt(7)
    v_mfma_f32_16x16x32_bf16 v[54:57], a[24:27], v[34:37], v[54:57]
    v_mfma_f32_16x16x32_bf16 v[58:61], a[28:31], v[34:37], v[58:61]
    ds_read_b128 v[34:37], v5 offset:11264
    s_waitcnt lgkmcnt(7)
    v_mfma_f32_16x16x32_bf16 v[54:57], a[32:35], v[38:41], v[54:57]
    v_mfma_f32_16x16x32_bf16 v[58:61], a[36:39], v[38:41], v[58:61]
    ds_read_b128 v[38:41], v5 offset:12288
    s_waitcnt lgkmcnt(7)
    v_mfma_f32_16x16x32_bf16 v[54:57], a[40:43], v[42:45], v[54:57]
    v_mfma_f32_16x16x32_bf16 v[58:61], a[44:47], v[42:45], v[58:61]
    ds_read_b128 v[42:45], v5 offset:13312
    s_waitcnt lgkmcnt(7)
    v_mfma_f32_16x16x32_bf16 v[54:57], a[48:51], v[46:49], v[54:57]
    v_mfma_f32_16x16x32_bf16 v[58:61], a[52:55], v[46:49], v[58:61]
    ds_read_b128 v[46:49], v5 offset:14336
    s_waitcnt lgkmcnt(7)
    v_mfma_f32_16x16x32_bf16 v[54:57], a[56:59], v[50:53], v[54:57]
    v_mfma_f32_16x16x32_bf16 v[58:61], a[60:63], v[50:53], v[58:61]
    ds_read_b128 v[50:53], v5 offset:15360
    s_waitcnt lgkmcnt(7)
    v_mfma_f32_16x16x32_bf16 v[54:57], a[64:67], v[22:25], v[54:57]
    v_mfma_f32_16x16x32_bf16 v[58:61], a[68:71], v[22:25], v[58:61]
    ds_read_b128 v[22:25], v5 offset:16384
    s_waitcnt lgkmcnt(7)
    v_mfma_f32_16x16x32_bf16 v[54:57], a[72:75], v[26:29], v[54:57]
    v_mfma_f32_16x16x32_bf16 v[58:61], a[76:79], v[26:29], v[58:61]
    ds_read_b128 v[26:29], v5 offset:17408
    s_waitcnt lgkmcnt(7)
    v_mfma_f32_16x16x32_bf16 v[54:57], a[80:83], v[30:33], v[54:57]
    v_mfma_f32_16x16x32_bf16 v[58:61], a[84:87], v[30:33], v[58:61]
    ds_read_b128 v[30:33], v5 offset:18432
    s_waitcnt lgkmcnt(7)
    v_mfma_f32_16x16x32_bf16 v[54:57], a[88:91], v[34:37], v[54:57]
    v_mfma_f32_16x16x32_bf16 v[58:61], a[92:95], v[34:37], v[58:61]
    ds_read_b128 v[34:37], v5 offset:19456
    s_waitcnt lgkmcnt(7)
    v_mfma_f32_16x16x32_bf16 v[54:57], a[96:99], v[38:41], v[54:57]
    v_mfma_f32_16x16x32_bf16 v[58:61], a[100:103], v[38:41], v[58:61]
    s_waitcnt lgkmcnt(6)
    v_mfma_f32_16x16x32_bf16 v[54:57], a[104:107], v[42:45], v[54:57]
    v_mfma_f32_16x16x32_bf16 v[58:61], a[108:111], v[42:45], v[58:61]
    s_waitcnt lgkmcnt(5)
    v_mfma_f32_16x16x32_bf16 v[54:57], a[112:115], v[46:49], v[54:57]
    v_mfma_f32_16x16x32_bf16 v[58:61], a[116:119], v[46:49], v[58:61]
    s_waitcnt lgkmcnt(4)
    v_mfma_f32_16x16x32_bf16 v[54:57], a[120:123], v[50:53], v[54:57]
    v_mfma_f32_16x16x32_bf16 v[58:61], a[124:127], v[50:53], v[58:61]
    s_waitcnt lgkmcnt(3)
    v_mfma_f32_16x16x32_bf16 v[54:57], a[128:131], v[22:25], v[54:57]
    v_mfma_f32_16x16x32_bf16 v[58:61], a[132:135], v[22:25], v[58:61]
    s_waitcnt lgkmcnt(2)
    v_mfma_f32_16x16x32_bf16 v[54:57], a[136:139], v[26:29], v[54:57]
    v_mfma_f32_16x16x32_bf16 v[58:61], a[140:143], v[26:29], v[58:61]
    s_waitcnt lgkmcnt(1)
    v_mfma_f32_16x16x32_bf16 v[54:57], a[144:147], v[30:33], v[54:57]
    v_mfma_f32_16x16x32_bf16 v[58:61], a[148:151], v[30:33], v[58:61]
    s_waitcnt lgkmcnt(0)
    v_mfma_f32_16x16x32_bf16 v[54:57], a[152:155], v[34:37], v[54:57]
    v_mfma_f32_16x16x32_bf16 v[58:61], a[156:159], v[34:37], v[58:61]
    v_xor_b32 v5, 65536, v5
    s_waitcnt vmcnt(0)
    v_cmp_lt_u32 vcc, v12, v7
    s_mov_b32 s55, 0
    s_cbranch_vccnz b1n_49
    s_mov_b32 s29, s52
    s_add_u32 m0, s35, s29
    s_add_u32 s28, s34, s29
    buffer_load_dwordx4 v1, s[16:19], s28 offen sc1 lds
    s_add_u32 s29, s29, 4096
    s_cmp_eq_u32 s29, 20480
    s_cselect_b32 s29, 0, s29
    s_add_u32 m0, s35, s29
    s_add_u32 s28, s34, s29
    buffer_load_dwordx4 v1, s[16:19], s28 offen sc1 lds
    s_add_u32 s29, s29, 4096
    s_cmp_eq_u32 s29, 20480
    s_cselect_b32 s29, 0, s29
    s_add_u32 m0, s35, s29
    s_add_u32 s28, s34, s29
    buffer_load_dwordx4 v1, s[16:19], s28 offen sc1 lds
    s_add_u32 s29, s29, 4096
    s_cmp_eq_u32 s29, 20480
    s_cselect_b32 s29, 0, s29
    s_add_u32 m0, s35, s29
    s_add_u32 s28, s34, s29
    buffer_load_dwordx4 v1, s[16:19], s28 offen sc1 lds
    s_add_u32 s29, s29, 4096
    s_cmp_eq_u32 s29, 20480
    s_cselect_b32 s29, 0, s29
    s_add_u32 m0, s35, s29
    s_add_u32 s28, s34, s29
    buffer_load_dwordx4 v1, s[16:19], s28 offen sc1 lds
    s_add_u32 s34, s34, 40960
    s_xor_b32 s35, s35, 65536
    s_mov_b32 s55, 1
b1n_49:
    v_pk_add_f32 v[86:87], v[86:87], v[88:89]
    v_pk_add_f32 v[86:87], v[86:87], v[90:91]
    v_pk_add_f32 v[86:87], v[86:87], v[92:93]
    v_pk_add_f32 v[86:87], v[86:87], v[94:95]
    v_mov_b32 v88, v86
    v_mov_b32 v89, v87
    s_nop 1
    v_permlane16_swap_b32 v86, v88
    v_permlane16_swap_b32 v87, v89
    v_add_f32 v86, v86, v88
    v_add_f32 v87, v87, v89
    v_mov_b32 v88, v86
    v_mov_b32 v89, v87
    s_nop 1
    v_permlane32_swap_b32 v86, v88
    v_permlane32_swap_b32 v87, v89
    v_add_f32 v86, v86, v88
    v_add_f32 v87, v87, v89
    v_mul_f32 v86, s46, v86
    v_mul_f32 v87, s46, v87
    v_fma_f32 v87, -v86, v86, v87
    v_max_f32 v87, 0, v87
    v_add_f32 v88, v87, v10
    v_rsq_f32 v88, v88
    s_nop 0
    v_mul_f32 v87, v87, v88
    v_fma_f32 v87, v87, v88, v10
    v_rsq_f32 v87, v87
    v_fma_f32 v54, -v86, v78, v54
    v_fma_f32 v55, -v86, v79, v55
    v_fma_f32 v56, -v86, v80, v56
    v_fma_f32 v57, -v86, v81, v57
    v_fma_f32 v58, -v86, v82, v58
    v_fma_f32 v59, -v86, v83, v59
    v_fma_f32 v60, -v86, v84, v60
    v_fma_f32 v61, -v86, v85, v61
    v_mul_f32 v87, v87, v88
    v_mul_f32 v54, v54, v87
    v_mul_f32 v55, v55, v87
    v_mul_f32 v56, v56, v87
    v_mul_f32 v57, v57, v87
    v_mul_f32 v58, v58, v87
    v_mul_f32 v59, v59, v87
    v_mul_f32 v60, v60, v87
    v_mul_f32 v61, v61, v87
    v_cvt_pk_bf16_f32 v62, v54, v55
    v_cvt_pk_bf16_f32 v63, v56, v57
    v_cvt_pk_bf16_f32 v64, v58, v59
    v_cvt_pk_bf16_f32 v65, v60, v61
    v_and_b32 v55, 0xffff0000, v62
    v_lshlrev_b32 v54, 16, v62
    v_and_b32 v57, 0xffff0000, v63
    v_lshlrev_b32 v56, 16, v63
    v_and_b32 v59, 0xffff0000, v64
    v_lshlrev_b32 v58, 16, v64
    v_and_b32 v61, 0xffff0000, v65
    v_lshlrev_b32 v60, 16, v65
    v_pk_mul_f32 v[62:63], v[54:55], v[54:55]
    v_pk_mul_f32 v[64:65], v[56:57], v[56:57]
    v_pk_mul_f32 v[66:67], v[58:59], v[58:59]
    v_pk_mul_f32 v[68:69], v[60:61], v[60:61]
    v_pk_fma_f32 v[62:63], v[62:63], s[44:45], v[10:11] op_sel:[0,0,1] op_sel_hi:[1,1,1]
    v_pk_fma_f32 v[64:65], v[64:65], s[44:45], v[10:11] op_sel:[0,0,1] op_sel_hi:[1,1,1]
    v_pk_fma_f32 v[66:67], v[66:67], s[44:45], v[10:11] op_sel:[0,0,1] op_sel_hi:[1,1,1]
    v_pk_fma_f32 v[68:69], v[68:69], s[44:45], v[10:11] op_sel:[0,0,1] op_sel_hi:[1,1,1]
    v_pk_mul_f32 v[62:63], v[62:63], v[54:55]
    v_pk_mul_f32 v[64:65], v[64:65], v[56:57]
    v_pk_mul_f32 v[66:67], v[66:67], v[58:59]
    v_pk_mul_f32 v[68:69], v[68:69], v[60:61]
    v_exp_f32 v62, v62
    v_exp_f32 v63, v63
    v_exp_f32 v64, v64
    v_exp_f32 v65, v65
    v_exp_f32 v66, v66
    v_exp_f32 v67, v67
    v_exp_f32 v68, v68
    v_exp_f32 v69, v69
    v_pk_add_f32 v[62:63], v[62:63], 1.0 op_sel_hi:[1,0]
    v_pk_add_f32 v[64:65], v[64:65], 1.0 op_sel_hi:[1,0]
    v_pk_add_f32 v[66:67], v[66:67], 1.0 op_sel_hi:[1,0]
    v_pk_add_f32 v[68:69], v[68:69], 1.0 op_sel_hi:[1,0]
    v_rcp_f32 v62, v62
    v_rcp_f32 v63, v63
    v_rcp_f32 v64, v64
    v_rcp_f32 v65, v65
    v_rcp_f32 v66, v66
    v_rcp_f32 v67, v67
    v_rcp_f32 v68, v68
    v_rcp_f32 v69, v69
    v_pk_mul_f32 v[54:55], v[54:55], v[62:63]
    v_pk_mul_f32 v[56:57], v[56:57], v[64:65]
    v_pk_mul_f32 v[58:59], v[58:59], v[66:67]
    v_pk_mul_f32 v[60:61], v[60:61], v[68:69]
    v_cvt_pk_bf16_f32 v62, v54, v55
    v_cvt_pk_bf16_f32 v63, v56, v57
    v_cvt_pk_bf16_f32 v64, v58, v59
    v_cvt_pk_bf16_f32 v65, v60, v61
    buffer_store_dwordx4 v[62:65], v1, s[16:19], s36 offen sc1
    s_add_u32 s36, s36, 40960
    s_add_u32 s37, s37, 5120
    s_waitcnt vmcnt(0)
    s_barrier
    v_mov_b32 v8, s12
    s_mov_b64 exec, s[14:15]
    buffer_store_dword v8, v0, s[16:19], s39 offen sc1
    s_mov_b64 exec, -1
    s_cmp_lt_u32 s12, 64
    s_cbranch_scc1 b1_47
    s_branch k_end
role_46:
    s_cmp_lt_u32 s10, 148
    s_cbranch_scc1 role_52
    s_cmp_ge_u32 s10, 158
    s_cbranch_scc1 role_52
    s_sub_u32 s41, s10, 148
    s_cmp_ge_u32 s41, 5
    s_cselect_b32 s40, 1, 0
    s_mul_i32 s28, s40, 5
    s_sub_u32 s41, s41, s28
    s_sub_u32 s39, s10, 148
    s_lshl_b32 s39, s39, 2
    s_add_u32 s39, s39, 69732608
    s_load_dwordx2 s[20:21], s[0:1], 72
    s_waitcnt lgkmcnt(0)
    s_mov_b32 s22, 819200
    s_mov_b32 s23, 0x20000
    s_lshl_b32 s34, s41, 8
    v_lshrrev_b32 v8, 4, v0
    v_and_b32 v9, 15, v0
    v_lshlrev_b32 v10, 2, v8
    v_xor_b32 v9, v9, v10
    s_mov_b32 s28, 1280
    v_mul_lo_u32 v14, v8, s28
    v_lshl_add_u32 v14, v9, 4, v14
    v_lshrrev_b32 v8, 2, v0
    v_lshlrev_b32 v15, 8, v8
    v_and_b32 v8, 3, v8
    v_xor_b32 v8, s11, v8
    v_lshl_add_u32 v15, v8, 6, v15
    v_and_b32 v8, 3, v0
    v_lshl_add_u32 v15, v8, 4, v15
    v_add_u32 v16, 0x10000, v15
    v_add_u32 v17, 0x20000, v15
    s_lshl_b32 s29, s11, 11
    s_lshr_b32 s30, s11, 1
    s_and_b32 s31, s11, 1
    s_lshl_b32 s30, s30, 2
    s_lshl_b32 s31, s31, 4
    s_add_u32 s30, s30, s31
    s_mul_i32 s30, s30, 1280
    s_add_u32 s30, s30, s34
    s_barrier
    s_add_u32 m0, s29, 0
    s_add_u32 s28, s30, 0
    buffer_load_dwordx4 v14, s[20:23], s28 offen lds
    s_add_u32 m0, s29, 1024
    s_add_u32 s28, s30, 10240
    buffer_load_dwordx4 v14, s[20:23], s28 offen lds
    s_add_u32 m0, s29, 8192
    s_add_u32 s28, s30, 40960
    buffer_load_dwordx4 v14, s[20:23], s28 offen lds
    s_add_u32 m0, s29, 9216
    s_add_u32 s28, s30, 51200
    buffer_load_dwordx4 v14, s[20:23], s28 offen lds
    s_add_u32 m0, s29, 16384
    s_add_u32 s28, s30, 81920
    buffer_load_dwordx4 v14, s[20:23], s28 offen lds
    s_add_u32 m0, s29, 17408
    s_add_u32 s28, s30, 92160
    buffer_load_dwordx4 v14, s[20:23], s28 offen lds
    s_add_u32 m0, s29, 24576
    s_add_u32 s28, s30, 122880
    buffer_load_dwordx4 v14, s[20:23], s28 offen lds
    s_add_u32 m0, s29, 25600
    s_add_u32 s28, s30, 133120
    buffer_load_dwordx4 v14, s[20:23], s28 offen lds
    s_add_u32 m0, s29, 32768
    s_add_u32 s28, s30, 163840
    buffer_load_dwordx4 v14, s[20:23], s28 offen lds
    s_add_u32 m0, s29, 33792
    s_add_u32 s28, s30, 174080
    buffer_load_dwordx4 v14, s[20:23], s28 offen lds
    s_add_u32 m0, s29, 40960
    s_add_u32 s28, s30, 204800
    buffer_load_dwordx4 v14, s[20:23], s28 offen lds
    s_add_u32 m0, s29, 41984
    s_add_u32 s28, s30, 215040
    buffer_load_dwordx4 v14, s[20:23], s28 offen lds
    s_add_u32 m0, s29, 49152
    s_add_u32 s28, s30, 245760
    buffer_load_dwordx4 v14, s[20:23], s28 offen lds
    s_add_u32 m0, s29, 50176
    s_add_u32 s28, s30, 256000
    buffer_load_dwordx4 v14, s[20:23], s28 offen lds
    s_add_u32 m0, s29, 57344
    s_add_u32 s28, s30, 286720
    buffer_load_dwordx4 v14, s[20:23], s28 offen lds
    s_add_u32 m0, s29, 58368
    s_add_u32 s28, s30, 296960
    buffer_load_dwordx4 v14, s[20:23], s28 offen lds
    s_add_u32 m0, s29, 65536
    s_add_u32 s28, s30, 327680
    buffer_load_dwordx4 v14, s[20:23], s28 offen lds
    s_add_u32 m0, s29, 66560
    s_add_u32 s28, s30, 337920
    buffer_load_dwordx4 v14, s[20:23], s28 offen lds
    s_add_u32 m0, s29, 73728
    s_add_u32 s28, s30, 368640
    buffer_load_dwordx4 v14, s[20:23], s28 offen lds
    s_add_u32 m0, s29, 74752
    s_add_u32 s28, s30, 378880
    buffer_load_dwordx4 v14, s[20:23], s28 offen lds
    s_add_u32 m0, s29, 81920
    s_add_u32 s28, s30, 409600
    buffer_load_dwordx4 v14, s[20:23], s28 offen lds
    s_add_u32 m0, s29, 82944
    s_add_u32 s28, s30, 419840
    buffer_load_dwordx4 v14, s[20:23], s28 offen lds
    s_add_u32 m0, s29, 90112
    s_add_u32 s28, s30, 450560
    buffer_load_dwordx4 v14, s[20:23], s28 offen lds
    s_add_u32 m0, s29, 91136
    s_add_u32 s28, s30, 460800
    buffer_load_dwordx4 v14, s[20:23], s28 offen lds
    s_add_u32 m0, s29, 98304
    s_add_u32 s28, s30, 491520
    buffer_load_dwordx4 v14, s[20:23], s28 offen lds
    s_add_u32 m0, s29, 99328
    s_add_u32 s28, s30, 501760
    buffer_load_dwordx4 v14, s[20:23], s28 offen lds
    s_add_u32 m0, s29, 106496
    s_add_u32 s28, s30, 532480
    buffer_load_dwordx4 v14, s[20:23], s28 offen lds
    s_add_u32 m0, s29, 107520
    s_add_u32 s28, s30, 542720
    buffer_load_dwordx4 v14, s[20:23], s28 offen lds
    s_add_u32 m0, s29, 114688
    s_add_u32 s28, s30, 573440
    buffer_load_dwordx4 v14, s[20:23], s28 offen lds
    s_add_u32 m0, s29, 115712
    s_add_u32 s28, s30, 583680
    buffer_load_dwordx4 v14, s[20:23], s28 offen lds
    s_add_u32 m0, s29, 122880
    s_add_u32 s28, s30, 614400
    buffer_load_dwordx4 v14, s[20:23], s28 offen lds
    s_add_u32 m0, s29, 123904
    s_add_u32 s28, s30, 624640
    buffer_load_dwordx4 v14, s[20:23], s28 offen lds
    s_add_u32 m0, s29, 131072
    s_add_u32 s28, s30, 655360
    buffer_load_dwordx4 v14, s[20:23], s28 offen lds
    s_add_u32 m0, s29, 132096
    s_add_u32 s28, s30, 665600
    buffer_load_dwordx4 v14, s[20:23], s28 offen lds
    s_add_u32 m0, s29, 139264
    s_add_u32 s28, s30, 696320
    buffer_load_dwordx4 v14, s[20:23], s28 offen lds
    s_add_u32 m0, s29, 140288
    s_add_u32 s28, s30, 706560
    buffer_load_dwordx4 v14, s[20:23], s28 offen lds
    s_add_u32 m0, s29, 147456
    s_add_u32 s28, s30, 737280
    buffer_load_dwordx4 v14, s[20:23], s28 offen lds
    s_add_u32 m0, s29, 148480
    s_add_u32 s28, s30, 747520
    buffer_load_dwordx4 v14, s[20:23], s28 offen lds
    s_add_u32 m0, s29, 155648
    s_add_u32 s28, s30, 778240
    buffer_load_dwordx4 v14, s[20:23], s28 offen lds
    s_add_u32 m0, s29, 156672
    s_add_u32 s28, s30, 788480
    buffer_load_dwordx4 v14, s[20:23], s28 offen lds
    s_waitcnt vmcnt(30)
    s_barrier
    ds_read_b64_tr_b16 a[0:1], v15 offset:0
    ds_read_b64_tr_b16 a[2:3], v15 offset:4096
    ds_read_b64_tr_b16 a[4:5], v15 offset:8
    ds_read_b64_tr_b16 a[6:7], v15 offset:4104
    ds_read_b64_tr_b16 a[8:9], v15 offset:8192
    ds_read_b64_tr_b16 a[10:11], v15 offset:12288
    ds_read_b64_tr_b16 a[12:13], v15 offset:8200
    ds_read_b64_tr_b16 a[14:15], v15 offset:12296
    ds_read_b64_tr_b16 a[16:17], v15 offset:16384
    ds_read_b64_tr_b16 a[18:19], v15 offset:20480
    ds_read_b64_tr_b16 a[20:21], v15 offset:16392
    ds_read_b64_tr_b16 a[22:23], v15 offset:20488
    ds_read_b64_tr_b16 a[24:25], v15 offset:24576
    ds_read_b64_tr_b16 a[26:27], v15 offset:28672
    ds_read_b64_tr_b16 a[28:29], v15 offset:24584
    ds_read_b64_tr_b16 a[30:31], v15 offset:28680
    ds_read_b64_tr_b16 a[32:33], v15 offset:32768
    ds_read_b64_tr_b16 a[34:35], v15 offset:36864
    ds_read_b64_tr_b16 a[36:37], v15 offset:32776
    ds_read_b64_tr_b16 a[38:39], v15 offset:36872
    s_waitcnt vmcnt(20)
    s_barrier
    ds_read_b64_tr_b16 a[40:41], v15 offset:40960
    ds_read_b64_tr_b16 a[42:43], v15 offset:45056
    ds_read_b64_tr_b16 a[44:45], v15 offset:40968
    ds_read_b64_tr_b16 a[46:47], v15 offset:45064
    ds_read_b64_tr_b16 a[48:49], v15 offset:49152
    ds_read_b64_tr_b16 a[50:51], v15 offset:53248
    ds_read_b64_tr_b16 a[52:53], v15 offset:49160
    ds_read_b64_tr_b16 a[54:55], v15 offset:53256
    ds_read_b64_tr_b16 a[56:57], v15 offset:57344
    ds_read_b64_tr_b16 a[58:59], v15 offset:61440
    ds_read_b64_tr_b16 a[60:61], v15 offset:57352
    ds_read_b64_tr_b16 a[62:63], v15 offset:61448
    ds_read_b64_tr_b16 a[64:65], v16 offset:0
    ds_read_b64_tr_b16 a[66:67], v16 offset:4096
    ds_read_b64_tr_b16 a[68:69], v16 offset:8
    ds_read_b64_tr_b16 a[70:71], v16 offset:4104
    ds_read_b64_tr_b16 a[72:73], v16 offset:8192
    ds_read_b64_tr_b16 a[74:75], v16 offset:12288
    ds_read_b64_tr_b16 a[76:77], v16 offset:8200
    ds_read_b64_tr_b16 a[78:79], v16 offset:12296
    s_waitcnt vmcnt(10)
    s_barrier
    ds_read_b64_tr_b16 a[80:81], v16 offset:16384
    ds_read_b64_tr_b16 a[82:83], v16 offset:20480
    ds_read_b64_tr_b16 a[84:85], v16 offset:16392
    ds_read_b64_tr_b16 a[86:87], v16 offset:20488
    ds_read_b64_tr_b16 a[88:89], v16 offset:24576
    ds_read_b64_tr_b16 a[90:91], v16 offset:28672
    ds_read_b64_tr_b16 a[92:93], v16 offset:24584
    ds_read_b64_tr_b16 a[94:95], v16 offset:28680
    ds_read_b64_tr_b16 a[96:97], v16 offset:32768
    ds_read_b64_tr_b16 a[98:99], v16 offset:36864
    ds_read_b64_tr_b16 a[100:101], v16 offset:32776
    ds_read_b64_tr_b16 a[102:103], v16 offset:36872
    ds_read_b64_tr_b16 a[104:105], v16 offset:40960
    ds_read_b64_tr_b16 a[106:107], v16 offset:45056
    ds_read_b64_tr_b16 a[108:109], v16 offset:40968
    ds_read_b64_tr_b16 a[110:111], v16 offset:45064
    ds_read_b64_tr_b16 a[112:113], v16 offset:49152
    ds_read_b64_tr_b16 a[114:115], v16 offset:53248
    ds_read_b64_tr_b16 a[116:117], v16 offset:49160
    ds_read_b64_tr_b16 a[118:119], v16 offset:53256
    s_waitcnt vmcnt(0)
    s_barrier
    ds_read_b64_tr_b16 a[120:121], v16 offset:57344
    ds_read_b64_tr_b16 a[122:123], v16 offset:61440
    ds_read_b64_tr_b16 a[124:125], v16 offset:57352
    ds_read_b64_tr_b16 a[126:127], v16 offset:61448
    ds_read_b64_tr_b16 a[128:129], v17 offset:0
    ds_read_b64_tr_b16 a[130:131], v17 offset:4096
    ds_read_b64_tr_b16 a[132:133], v17 offset:8
    ds_read_b64_tr_b16 a[134:135], v17 offset:4104
    ds_read_b64_tr_b16 a[136:137], v17 offset:8192
    ds_read_b64_tr_b16 a[138:139], v17 offset:12288
    ds_read_b64_tr_b16 a[140:141], v17 offset:8200
    ds_read_b64_tr_b16 a[142:143], v17 offset:12296
    ds_read_b64_tr_b16 a[144:145], v17 offset:16384
    ds_read_b64_tr_b16 a[146:147], v17 offset:20480
    ds_read_b64_tr_b16 a[148:149], v17 offset:16392
    ds_read_b64_tr_b16 a[150:151], v17 offset:20488
    ds_read_b64_tr_b16 a[152:153], v17 offset:24576
    ds_read_b64_tr_b16 a[154:155], v17 offset:28672
    ds_read_b64_tr_b16 a[156:157], v17 offset:24584
    ds_read_b64_tr_b16 a[158:159], v17 offset:28680
    s_waitcnt lgkmcnt(0)
    s_barrier
    s_mul_i32 s36, s40, 20
    s_lshl_b32 s28, s41, 2
    s_add_u32 s36, s36, s28
    s_add_u32 s36, s36, s11
    s_lshl_b32 s36, s36, 10
    s_add_u32 s36, s36, 92274688
    s_add_u32 s37, s36, 4278190080
    s_mov_b32 s46, 0x3acccccd
    v_mov_b32 v10, 0x3727c5ac
    v_mul_u32_u24 v17, 640, v3
    v_lshl_add_u32 v17, v2, 3, v17
    v_lshlrev_b32 v18, 3, v2
    s_mul_i32 s53, s40, 2560
    s_lshl_b32 s28, s41, 9
    s_add_u32 s38, s53, s28
    s_lshl_b32 s28, s11, 7
    s_add_u32 s38, s38, s28
    s_add_u32 s38, s38, 96468992
    s_add_u32 s53, s53, 83886080
    s_lshr_b32 s28, s11, 1
    s_add_u32 s28, s28, 1
    s_sub_u32 s29, 0, s28
    s_bitcmp1_b32 s11, 0
    s_cselect_b32 s43, s28, s29
    s_add_u32 s28, s43, 16
    v_add_u32 v8, s28, v2
    v_lshrrev_b32 v9, 4, v8
    v_mul_u32_u24 v16, 20480, v9
    v_and_b32 v8, 15, v8
    v_lshl_add_u32 v16, v8, 4, v16
    v_lshl_add_u32 v16, v3, 8, v16
    s_mov_b32 s54, 0
    v_mul_u32_u24 v6, 4, v0
    v_add_u32 v6, s54, v6
    v_add_u32 v6, 69732352, v6
    s_mul_i32 s35, s11, 5120
    s_mul_i32 s34, s40, 20480
    s_add_u32 s34, s34, 88059904
    s_add_u32 s34, s34, s35
    s_mul_i32 s52, s41, 256
    s_lshr_b32 s52, s52, 8
    s_mul_i32 s52, s52, 1024
    v_mov_b32 v5, v1
    s_mov_b32 s12, 0
    s_mov_b32 s55, 0
    s_add_u32 s28, s12, 1
    v_mov_b32 v7, s28
    v_cmp_gt_u32 vcc, 10, v0
    s_nop 1
    v_cndmask_b32 v7, 0, v7, vcc
    s_add_u32 s28, s12, 2
    s_min_u32 s28, s28, 64
    s_mul_i32 s29, s40, 5
    v_mov_b32 v8, s28
    v_cmp_gt_u32 vcc, s29, v0
    s_nop 1
    v_cndmask_b32 v7, v7, v8, vcc
b2_53:
    s_cmp_eq_u32 s55, 1
    s_cbranch_scc1 b2h_54
bw_56:
    s_sub_u32 s88, s88, 1
    s_cbranch_scc1 k_end
    s_mov_b64 exec, 1023
    buffer_load_dword v12, v6, s[16:19], 0 offen sc1
    s_mov_b64 exec, -1
    s_waitcnt vmcnt(0)
bk_57:
    v_cmp_lt_u32 vcc, v12, v7
    s_cbranch_vccnz bw_56
    s_lshl_b32 s28, s12, 5
    s_lshl_b32 s29, s40, 4
    s_add_u32 s28, s28, s29
    s_add_u32 s28, s28, s43
    v_add_u32 v8, s28, v2
    v_cmp_gt_u32 vcc, 2048, v8
    v_mov_b32 v4, 0x7fff0000
    s_nop 0
    v_cndmask_b32 v4, v4, v16, vcc
    s_mov_b32 s29, s52
    s_add_u32 m0, s35, s29
    s_add_u32 s28, s34, s29
    buffer_load_dwordx4 v4, s[16:19], s28 offen sc1 lds
    s_add_u32 s29, s29, 1024
    s_cmp_eq_u32 s29, 5120
    s_cselect_b32 s29, 0, s29
    s_add_u32 m0, s35, s29
    s_add_u32 s28, s34, s29
    buffer_load_dwordx4 v4, s[16:19], s28 offen sc1 lds
    s_add_u32 s29, s29, 1024
    s_cmp_eq_u32 s29, 5120
    s_cselect_b32 s29, 0, s29
    s_add_u32 m0, s35, s29
    s_add_u32 s28, s34, s29
    buffer_load_dwordx4 v4, s[16:19], s28 offen sc1 lds
    s_add_u32 s29, s29, 1024
    s_cmp_eq_u32 s29, 5120
    s_cselect_b32 s29, 0, s29
    s_add_u32 m0, s35, s29
    s_add_u32 s28, s34, s29
    buffer_load_dwordx4 v4, s[16:19], s28 offen sc1 lds
    s_add_u32 s29, s29, 1024
    s_cmp_eq_u32 s29, 5120
    s_cselect_b32 s29, 0, s29
    s_add_u32 m0, s35, s29
    s_add_u32 s28, s34, s29
    buffer_load_dwordx4 v4, s[16:19], s28 offen sc1 lds
    s_add_u32 s34, s34, 40960
    s_xor_b32 s35, s35, 65536
b2h_54:
    buffer_load_dwordx4 v[78:81], v1, s[16:19], s37 offen sc1
    buffer_load_dwordx2 v[86:87], v17, s[16:19], s53 offen offset:0 sc1
    buffer_load_dwordx2 v[88:89], v17, s[16:19], s53 offen offset:128 sc1
    buffer_load_dwordx2 v[90:91], v17, s[16:19], s53 offen offset:256 sc1
    buffer_load_dwordx2 v[92:93], v17, s[16:19], s53 offen offset:384 sc1
    buffer_load_dwordx2 v[94:95], v17, s[16:19], s53 offen offset:512 sc1
    s_add_u32 s12, s12, 1
    s_add_u32 s28, s12, 1
    v_mov_b32 v7, s28
    v_cmp_gt_u32 vcc, 10, v0
    s_nop 1
    v_cndmask_b32 v7, 0, v7, vcc
    s_add_u32 s28, s12, 2
    s_min_u32 s28, s28, 64
    s_mul_i32 s29, s40, 5
    v_mov_b32 v8, s28
    v_cmp_gt_u32 vcc, s29, v0
    s_nop 1
    v_cndmask_b32 v7, v7, v8, vcc
    s_mov_b64 exec, 1023
    buffer_load_dword v12, v6, s[16:19], 0 offen sc1
    s_mov_b64 exec, -1
    s_waitcnt vmcnt(7)
    s_barrier
    ds_read_b128 v[22:25], v5 offset:0
    ds_read_b128 v[26:29], v5 offset:1024
    ds_read_b128 v[30:33], v5 offset:2048
    ds_read_b128 v[34:37], v5 offset:3072
    ds_read_b128 v[38:41], v5 offset:4096
    ds_read_b128 v[42:45], v5 offset:5120
    ds_read_b128 v[46:49], v5 offset:6144
    ds_read_b128 v[50:53], v5 offset:7168
    s_waitcnt lgkmcnt(7)
    v_mfma_f32_16x16x32_bf16 v[54:57], a[0:3], v[22:25], 0
    v_mfma_f32_16x16x32_bf16 v[58:61], a[4:7], v[22:25], 0
    ds_read_b128 v[22:25], v5 offset:8192
    s_waitcnt lgkmcnt(7)
    v_mfma_f32_16x16x32_bf16 v[54:57], a[8:11], v[26:29], v[54:57]
    v_mfma_f32_16x16x32_bf16 v[58:61], a[12:15], v[26:29], v[58:61]
    ds_read_b128 v[26:29], v5 offset:9216
    s_waitcnt lgkmcnt(7)
    v_mfma_f32_16x16x32_bf16 v[54:57], a[16:19], v[30:33], v[54:57]
    v_mfma_f32_16x16x32_bf16 v[58:61], a[20:23], v[30:33], v[58:61]
    ds_read_b128 v[30:33], v5 offset:10240
    s_waitcnt lgkmcnt(7)
    v_mfma_f32_16x16x32_bf16 v[54:57], a[24:27], v[34:37], v[54:57]
    v_mfma_f32_16x16x32_bf16 v[58:61], a[28:31], v[34:37], v[58:61]
    ds_read_b128 v[34:37], v5 offset:11264
    s_waitcnt lgkmcnt(7)
    v_mfma_f32_16x16x32_bf16 v[54:57], a[32:35], v[38:41], v[54:57]
    v_mfma_f32_16x16x32_bf16 v[58:61], a[36:39], v[38:41], v[58:61]
    ds_read_b128 v[38:41], v5 offset:12288
    s_waitcnt lgkmcnt(7)
    v_mfma_f32_16x16x32_bf16 v[54:57], a[40:43], v[42:45], v[54:57]
    v_mfma_f32_16x16x32_bf16 v[58:61], a[44:47], v[42:45], v[58:61]
    ds_read_b128 v[42:45], v5 offset:13312
    s_waitcnt lgkmcnt(7)
    v_mfma_f32_16x16x32_bf16 v[54:57], a[48:51], v[46:49], v[54:57]
    v_mfma_f32_16x16x32_bf16 v[58:61], a[52:55], v[46:49], v[58:61]
    ds_read_b128 v[46:49], v5 offset:14336
    s_waitcnt lgkmcnt(7)
    v_mfma_f32_16x16x32_bf16 v[54:57], a[56:59], v[50:53], v[54:57]
    v_mfma_f32_16x16x32_bf16 v[58:61], a[60:63], v[50:53], v[58:61]
    ds_read_b128 v[50:53], v5 offset:15360
    s_waitcnt lgkmcnt(7)
    v_mfma_f32_16x16x32_bf16 v[54:57], a[64:67], v[22:25], v[54:57]
    v_mfma_f32_16x16x32_bf16 v[58:61], a[68:71], v[22:25], v[58:61]
    ds_read_b128 v[22:25], v5 offset:16384
    s_waitcnt lgkmcnt(7)
    v_mfma_f32_16x16x32_bf16 v[54:57], a[72:75], v[26:29], v[54:57]
    v_mfma_f32_16x16x32_bf16 v[58:61], a[76:79], v[26:29], v[58:61]
    ds_read_b128 v[26:29], v5 offset:17408
    s_waitcnt lgkmcnt(7)
    v_mfma_f32_16x16x32_bf16 v[54:57], a[80:83], v[30:33], v[54:57]
    v_mfma_f32_16x16x32_bf16 v[58:61], a[84:87], v[30:33], v[58:61]
    ds_read_b128 v[30:33], v5 offset:18432
    s_waitcnt lgkmcnt(7)
    v_mfma_f32_16x16x32_bf16 v[54:57], a[88:91], v[34:37], v[54:57]
    v_mfma_f32_16x16x32_bf16 v[58:61], a[92:95], v[34:37], v[58:61]
    ds_read_b128 v[34:37], v5 offset:19456
    s_waitcnt lgkmcnt(7)
    v_mfma_f32_16x16x32_bf16 v[54:57], a[96:99], v[38:41], v[54:57]
    v_mfma_f32_16x16x32_bf16 v[58:61], a[100:103], v[38:41], v[58:61]
    s_waitcnt lgkmcnt(6)
    v_mfma_f32_16x16x32_bf16 v[54:57], a[104:107], v[42:45], v[54:57]
    v_mfma_f32_16x16x32_bf16 v[58:61], a[108:111], v[42:45], v[58:61]
    s_waitcnt lgkmcnt(5)
    v_mfma_f32_16x16x32_bf16 v[54:57], a[112:115], v[46:49], v[54:57]
    v_mfma_f32_16x16x32_bf16 v[58:61], a[116:119], v[46:49], v[58:61]
    s_waitcnt lgkmcnt(4)
    v_mfma_f32_16x16x32_bf16 v[54:57], a[120:123], v[50:53], v[54:57]
    v_mfma_f32_16x16x32_bf16 v[58:61], a[124:127], v[50:53], v[58:61]
    s_waitcnt lgkmcnt(3)
    v_mfma_f32_16x16x32_bf16 v[54:57], a[128:131], v[22:25], v[54:57]
    v_mfma_f32_16x16x32_bf16 v[58:61], a[132:135], v[22:25], v[58:61]
    s_waitcnt lgkmcnt(2)
    v_mfma_f32_16x16x32_bf16 v[54:57], a[136:139], v[26:29], v[54:57]
    v_mfma_f32_16x16x32_bf16 v[58:61], a[140:143], v[26:29], v[58:61]
    s_waitcnt lgkmcnt(1)
    v_mfma_f32_16x16x32_bf16 v[54:57], a[144:147], v[30:33], v[54:57]
    v_mfma_f32_16x16x32_bf16 v[58:61], a[148:151], v[30:33], v[58:61]
    s_waitcnt lgkmcnt(0)
    v_mfma_f32_16x16x32_bf16 v[54:57], a[152:155], v[34:37], v[54:57]
    v_mfma_f32_16x16x32_bf16 v[58:61], a[156:159], v[34:37], v[58:61]
    v_xor_b32 v5, 65536, v5
    s_waitcnt vmcnt(0)
    v_cmp_lt_u32 vcc, v12, v7
    s_mov_b32 s55, 0
    s_cbranch_vccnz b2n_55
    s_lshl_b32 s28, s12, 5
    s_lshl_b32 s29, s40, 4
    s_add_u32 s28, s28, s29
    s_add_u32 s28, s28, s43
    v_add_u32 v8, s28, v2
    v_cmp_gt_u32 vcc, 2048, v8
    v_mov_b32 v4, 0x7fff0000
    s_nop 0
    v_cndmask_b32 v4, v4, v16, vcc
    s_mov_b32 s29, s52
    s_add_u32 m0, s35, s29
    s_add_u32 s28, s34, s29
    buffer_load_dwordx4 v4, s[16:19], s28 offen sc1 lds
    s_add_u32 s29, s29, 1024
    s_cmp_eq_u32 s29, 5120
    s_cselect_b32 s29, 0, s29
    s_add_u32 m0, s35, s29
    s_add_u32 s28, s34, s29
    buffer_load_dwordx4 v4, s[16:19], s28 offen sc1 lds
    s_add_u32 s29, s29, 1024
    s_cmp_eq_u32 s29, 5120
    s_cselect_b32 s29, 0, s29
    s_add_u32 m0, s35, s29
    s_add_u32 s28, s34, s29
    buffer_load_dwordx4 v4, s[16:19], s28 offen sc1 lds
    s_add_u32 s29, s29, 1024
    s_cmp_eq_u32 s29, 5120
    s_cselect_b32 s29, 0, s29
    s_add_u32 m0, s35, s29
    s_add_u32 s28, s34, s29
    buffer_load_dwordx4 v4, s[16:19], s28 offen sc1 lds
    s_add_u32 s29, s29, 1024
    s_cmp_eq_u32 s29, 5120
    s_cselect_b32 s29, 0, s29
    s_add_u32 m0, s35, s29
    s_add_u32 s28, s34, s29
    buffer_load_dwordx4 v4, s[16:19], s28 offen sc1 lds
    s_add_u32 s34, s34, 40960
    s_xor_b32 s35, s35, 65536
    s_mov_b32 s55, 1
b2n_55:
    v_pk_add_f32 v[86:87], v[86:87], v[88:89]
    v_pk_add_f32 v[86:87], v[86:87], v[90:91]
    v_pk_add_f32 v[86:87], v[86:87], v[92:93]
    v_pk_add_f32 v[86:87], v[86:87], v[94:95]
    v_mov_b32 v88, v86
    v_mov_b32 v89, v87
    s_nop 1
    v_permlane16_swap_b32 v86, v88
    v_permlane16_swap_b32 v87, v89
    v_add_f32 v86, v86, v88
    v_add_f32 v87, v87, v89
    v_mov_b32 v88, v86
    v_mov_b32 v89, v87
    s_nop 1
    v_permlane32_swap_b32 v86, v88
    v_permlane32_swap_b32 v87, v89
    v_add_f32 v86, v86, v88
    v_add_f32 v87, v87, v89
    v_mul_f32 v86, s46, v86
    v_mul_f32 v87, s46, v87
    v_fma_f32 v87, -v86, v86, v87
    v_max_f32 v87, 0, v87
    v_add_f32 v88, v87, v10
    v_rsq_f32 v88, v88
    s_nop 0
    v_and_b32 v63, 0xffff0000, v78
    v_lshlrev_b32 v62, 16, v78
    v_and_b32 v65, 0xffff0000, v79
    v_lshlrev_b32 v64, 16, v79
    v_and_b32 v67, 0xffff0000, v80
    v_lshlrev_b32 v66, 16, v80
    v_and_b32 v69, 0xffff0000, v81
    v_lshlrev_b32 v68, 16, v81
    v_sub_f32 v62, v62, v86
    v_sub_f32 v63, v63, v86
    v_sub_f32 v64, v64, v86
    v_sub_f32 v65, v65, v86
    v_sub_f32 v66, v66, v86
    v_sub_f32 v67, v67, v86
    v_sub_f32 v68, v68, v86
    v_sub_f32 v69, v69, v86
    v_mul_f32 v62, v62, v88
    v_mul_f32 v63, v63, v88
    v_mul_f32 v64, v64, v88
    v_mul_f32 v65, v65, v88
    v_mul_f32 v66, v66, v88
    v_mul_f32 v67, v67, v88
    v_mul_f32 v68, v68, v88
    v_mul_f32 v69, v69, v88
    v_cvt_pk_bf16_f32 v78, v62, v63
    v_cvt_pk_bf16_f32 v79, v64, v65
    v_cvt_pk_bf16_f32 v80, v66, v67
    v_cvt_pk_bf16_f32 v81, v68, v69
    v_and_b32 v63, 0xffff0000, v78
    v_lshlrev_b32 v62, 16, v78
    v_and_b32 v65, 0xffff0000, v79
    v_lshlrev_b32 v64, 16, v79
    v_and_b32 v67, 0xffff0000, v80
    v_lshlrev_b32 v66, 16, v80
    v_and_b32 v69, 0xffff0000, v81
    v_lshlrev_b32 v68, 16, v81
    v_cvt_pk_bf16_f32 v78, v54, v55
    v_cvt_pk_bf16_f32 v79, v56, v57
    v_cvt_pk_bf16_f32 v80, v58, v59
    v_cvt_pk_bf16_f32 v81, v60, v61
    v_and_b32 v55, 0xffff0000, v78
    v_lshlrev_b32 v54, 16, v78
    v_and_b32 v57, 0xffff0000, v79
    v_lshlrev_b32 v56, 16, v79
    v_and_b32 v59, 0xffff0000, v80
    v_lshlrev_b32 v58, 16, v80
    v_and_b32 v61, 0xffff0000, v81
    v_lshlrev_b32 v60, 16, v81
    v_pk_add_f32 v[54:55], v[54:55], v[62:63]
    v_pk_add_f32 v[56:57], v[56:57], v[64:65]
    v_pk_add_f32 v[58:59], v[58:59], v[66:67]
    v_pk_add_f32 v[60:61], v[60:61], v[68:69]
    v_cvt_pk_bf16_f32 v62, v54, v55
    v_cvt_pk_bf16_f32 v63, v56, v57
    v_cvt_pk_bf16_f32 v64, v58, v59
    v_cvt_pk_bf16_f32 v65, v60, v61
    buffer_store_dwordx4 v[62:65], v1, s[16:19], s36 offen sc1
    v_and_b32 v55, 0xffff0000, v62
    v_lshlrev_b32 v54, 16, v62
    v_and_b32 v57, 0xffff0000, v63
    v_lshlrev_b32 v56, 16, v63
    v_and_b32 v59, 0xffff0000, v64
    v_lshlrev_b32 v58, 16, v64
    v_and_b32 v61, 0xffff0000, v65
    v_lshlrev_b32 v60, 16, v65
    v_add_f32 v66, v54, v55
    v_mul_f32 v67, v54, v54
    v_fmac_f32 v67, v55, v55
    v_add_f32 v66, v66, v56
    v_fmac_f32 v67, v56, v56
    v_add_f32 v66, v66, v57
    v_fmac_f32 v67, v57, v57
    v_add_f32 v66, v66, v58
    v_fmac_f32 v67, v58, v58
    v_add_f32 v66, v66, v59
    v_fmac_f32 v67, v59, v59
    v_add_f32 v66, v66, v60
    v_fmac_f32 v67, v60, v60
    v_add_f32 v66, v66, v61
    v_fmac_f32 v67, v61, v61
    v_mov_b32 v68, v66
    v_mov_b32 v69, v67
    s_nop 1
    v_permlane16_swap_b32 v66, v68
    v_permlane16_swap_b32 v67, v69
    v_add_f32 v66, v66, v68
    v_add_f32 v67, v67, v69
    v_mov_b32 v68, v66
    v_mov_b32 v69, v67
    s_nop 1
    v_permlane32_swap_b32 v66, v68
    v_permlane32_swap_b32 v67, v69
    v_add_f32 v66, v66, v68
    v_add_f32 v67, v67, v69
    s_mov_b64 exec, 0xffff
    buffer_store_dwordx2 v[66:67], v18, s[16:19], s38 offen sc1
    s_mov_b64 exec, -1
    s_add_u32 s36, s36, 40960
    s_add_u32 s37, s37, 40960
    s_add_u32 s38, s38, 5120
    s_add_u32 s53, s53, 5120
    s_waitcnt vmcnt(0)
    s_barrier
    v_mov_b32 v8, s12
    s_mov_b64 exec, s[14:15]
    buffer_store_dword v8, v0, s[16:19], s39 offen sc1
    s_mov_b64 exec, -1
    s_cmp_lt_u32 s12, 64
    s_cbranch_scc1 b2_53
    s_branch k_end
role_52:
    s_cmp_lt_u32 s10, 32
    s_cbranch_scc1 role_58
    s_cmp_ge_u32 s10, 96
    s_cbranch_scc1 role_58
    s_cmp_ge_u32 s9, 30
    s_cbranch_scc1 role_58
    s_sub_u32 s40, s8, 3
    s_sub_u32 s41, s9, 20
    s_load_dwordx2 s[20:21], s[0:1], 88
    s_waitcnt lgkmcnt(0)
    s_mov_b32 s22, 2211840
    s_mov_b32 s23, 0x20000
    s_lshl_b32 s34, s41, 7
    v_lshrrev_b32 v8, 4, v0
    v_and_b32 v9, 15, v0
    v_lshlrev_b32 v10, 2, v8
    v_xor_b32 v9, v9, v10
    s_mov_b32 s28, 1280
    v_mul_lo_u32 v14, v8, s28
    v_lshrrev_b32 v10, 3, v9
    s_mov_b32 s28, 1105920
    v_mul_lo_u32 v10, v10, s28
    v_add_u32 v14, v14, v10
    v_and_b32 v9, 7, v9
    v_lshl_add_u32 v14, v9, 4, v14
    v_lshrrev_b32 v8, 2, v0
    v_lshlrev_b32 v15, 8, v8
    v_and_b32 v8, 3, v8
    v_xor_b32 v8, s11, v8
    v_lshl_add_u32 v15, v8, 6, v15
    v_and_b32 v8, 3, v0
    v_lshl_add_u32 v15, v8, 4, v15
    v_add_u32 v16, 0x10000, v15
    v_add_u32 v17, 0x20000, v15
    s_lshl_b32 s29, s11, 11
    s_lshr_b32 s30, s11, 1
    s_and_b32 s31, s11, 1
    s_lshl_b32 s30, s30, 2
    s_lshl_b32 s31, s31, 4
    s_add_u32 s30, s30, s31
    s_mul_i32 s30, s30, 1280
    s_add_u32 s30, s30, s34
    s_barrier
    s_add_u32 m0, s29, 0
    s_add_u32 s28, s30, 0
    buffer_load_dwordx4 v14, s[20:23], s28 offen lds
    s_add_u32 m0, s29, 1024
    s_add_u32 s28, s30, 10240
    buffer_load_dwordx4 v14, s[20:23], s28 offen lds
    s_add_u32 m0, s29, 8192
    s_add_u32 s28, s30, 40960
    buffer_load_dwordx4 v14, s[20:23], s28 offen lds
    s_add_u32 m0, s29, 9216
    s_add_u32 s28, s30, 51200
    buffer_load_dwordx4 v14, s[20:23], s28 offen lds
    s_add_u32 m0, s29, 16384
    s_add_u32 s28, s30, 81920
    buffer_load_dwordx4 v14, s[20:23], s28 offen lds
    s_add_u32 m0, s29, 17408
    s_add_u32 s28, s30, 92160
    buffer_load_dwordx4 v14, s[20:23], s28 offen lds
    s_add_u32 m0, s29, 24576
    s_add_u32 s28, s30, 122880
    buffer_load_dwordx4 v14, s[20:23], s28 offen lds
    s_add_u32 m0, s29, 25600
    s_add_u32 s28, s30, 133120
    buffer_load_dwordx4 v14, s[20:23], s28 offen lds
    s_add_u32 m0, s29, 32768
    s_add_u32 s28, s30, 163840
    buffer_load_dwordx4 v14, s[20:23], s28 offen lds
    s_add_u32 m0, s29, 33792
    s_add_u32 s28, s30, 174080
    buffer_load_dwordx4 v14, s[20:23], s28 offen lds
    s_add_u32 m0, s29, 40960
    s_add_u32 s28, s30, 204800
    buffer_load_dwordx4 v14, s[20:23], s28 offen lds
    s_add_u32 m0, s29, 41984
    s_add_u32 s28, s30, 215040
    buffer_load_dwordx4 v14, s[20:23], s28 offen lds
    s_add_u32 m0, s29, 49152
    s_add_u32 s28, s30, 245760
    buffer_load_dwordx4 v14, s[20:23], s28 offen lds
    s_add_u32 m0, s29, 50176
    s_add_u32 s28, s30, 256000
    buffer_load_dwordx4 v14, s[20:23], s28 offen lds
    s_add_u32 m0, s29, 57344
    s_add_u32 s28, s30, 286720
    buffer_load_dwordx4 v14, s[20:23], s28 offen lds
    s_add_u32 m0, s29, 58368
    s_add_u32 s28, s30, 296960
    buffer_load_dwordx4 v14, s[20:23], s28 offen lds
    s_add_u32 m0, s29, 65536
    s_add_u32 s28, s30, 327680
    buffer_load_dwordx4 v14, s[20:23], s28 offen lds
    s_add_u32 m0, s29, 66560
    s_add_u32 s28, s30, 337920
    buffer_load_dwordx4 v14, s[20:23], s28 offen lds
    s_add_u32 m0, s29, 73728
    s_add_u32 s28, s30, 368640
    buffer_load_dwordx4 v14, s[20:23], s28 offen lds
    s_add_u32 m0, s29, 74752
    s_add_u32 s28, s30, 378880
    buffer_load_dwordx4 v14, s[20:23], s28 offen lds
    s_add_u32 m0, s29, 81920
    s_add_u32 s28, s30, 409600
    buffer_load_dwordx4 v14, s[20:23], s28 offen lds
    s_add_u32 m0, s29, 82944
    s_add_u32 s28, s30, 419840
    buffer_load_dwordx4 v14, s[20:23], s28 offen lds
    s_add_u32 m0, s29, 90112
    s_add_u32 s28, s30, 450560
    buffer_load_dwordx4 v14, s[20:23], s28 offen lds
    s_add_u32 m0, s29, 91136
    s_add_u32 s28, s30, 460800
    buffer_load_dwordx4 v14, s[20:23], s28 offen lds
    s_add_u32 m0, s29, 98304
    s_add_u32 s28, s30, 491520
    buffer_load_dwordx4 v14, s[20:23], s28 offen lds
    s_add_u32 m0, s29, 99328
    s_add_u32 s28, s30, 501760
    buffer_load_dwordx4 v14, s[20:23], s28 offen lds
    s_add_u32 m0, s29, 106496
    s_add_u32 s28, s30, 532480
    buffer_load_dwordx4 v14, s[20:23], s28 offen lds
    s_add_u32 m0, s29, 107520
    s_add_u32 s28, s30, 542720
    buffer_load_dwordx4 v14, s[20:23], s28 offen lds
    s_add_u32 m0, s29, 114688
    s_add_u32 s28, s30, 573440
    buffer_load_dwordx4 v14, s[20:23], s28 offen lds
    s_add_u32 m0, s29, 115712
    s_add_u32 s28, s30, 583680
    buffer_load_dwordx4 v14, s[20:23], s28 offen lds
    s_add_u32 m0, s29, 122880
    s_add_u32 s28, s30, 614400
    buffer_load_dwordx4 v14, s[20:23], s28 offen lds
    s_add_u32 m0, s29, 123904
    s_add_u32 s28, s30, 624640
    buffer_load_dwordx4 v14, s[20:23], s28 offen lds
    s_add_u32 m0, s29, 131072
    s_add_u32 s28, s30, 655360
    buffer_load_dwordx4 v14, s[20:23], s28 offen lds
    s_add_u32 m0, s29, 132096
    s_add_u32 s28, s30, 665600
    buffer_load_dwordx4 v14, s[20:23], s28 offen lds
    s_add_u32 m0, s29, 139264
    s_add_u32 s28, s30, 696320
    buffer_load_dwordx4 v14, s[20:23], s28 offen lds
    s_add_u32 m0, s29, 140288
    s_add_u32 s28, s30, 706560
    buffer_load_dwordx4 v14, s[20:23], s28 offen lds
    s_add_u32 m0, s29, 147456
    s_add_u32 s28, s30, 737280
    buffer_load_dwordx4 v14, s[20:23], s28 offen lds
    s_add_u32 m0, s29, 148480
    s_add_u32 s28, s30, 747520
    buffer_load_dwordx4 v14, s[20:23], s28 offen lds
    s_add_u32 m0, s29, 155648
    s_add_u32 s28, s30, 778240
    buffer_load_dwordx4 v14, s[20:23], s28 offen lds
    s_add_u32 m0, s29, 156672
    s_add_u32 s28, s30, 788480
    buffer_load_dwordx4 v14, s[20:23], s28 offen lds
    s_waitcnt vmcnt(30)
    s_barrier
    ds_read_b64_tr_b16 a[0:1], v15 offset:0
    ds_read_b64_tr_b16 a[2:3], v15 offset:4096
    ds_read_b64_tr_b16 a[4:5], v15 offset:8
    ds_read_b64_tr_b16 a[6:7], v15 offset:4104
    ds_read_b64_tr_b16 a[8:9], v15 offset:8192
    ds_read_b64_tr_b16 a[10:11], v15 offset:12288
    ds_read_b64_tr_b16 a[12:13], v15 offset:8200
    ds_read_b64_tr_b16 a[14:15], v15 offset:12296
    ds_read_b64_tr_b16 a[16:17], v15 offset:16384
    ds_read_b64_tr_b16 a[18:19], v15 offset:20480
    ds_read_b64_tr_b16 a[20:21], v15 offset:16392
    ds_read_b64_tr_b16 a[22:23], v15 offset:20488
    ds_read_b64_tr_b16 a[24:25], v15 offset:24576
    ds_read_b64_tr_b16 a[26:27], v15 offset:28672
    ds_read_b64_tr_b16 a[28:29], v15 offset:24584
    ds_read_b64_tr_b16 a[30:31], v15 offset:28680
    ds_read_b64_tr_b16 a[32:33], v15 offset:32768
    ds_read_b64_tr_b16 a[34:35], v15 offset:36864
    ds_read_b64_tr_b16 a[36:37], v15 offset:32776
    ds_read_b64_tr_b16 a[38:39], v15 offset:36872
    s_waitcnt vmcnt(20)
    s_barrier
    ds_read_b64_tr_b16 a[40:41], v15 offset:40960
    ds_read_b64_tr_b16 a[42:43], v15 offset:45056
    ds_read_b64_tr_b16 a[44:45], v15 offset:40968
    ds_read_b64_tr_b16 a[46:47], v15 offset:45064
    ds_read_b64_tr_b16 a[48:49], v15 offset:49152
    ds_read_b64_tr_b16 a[50:51], v15 offset:53248
    ds_read_b64_tr_b16 a[52:53], v15 offset:49160
    ds_read_b64_tr_b16 a[54:55], v15 offset:53256
    ds_read_b64_tr_b16 a[56:57], v15 offset:57344
    ds_read_b64_tr_b16 a[58:59], v15 offset:61440
    ds_read_b64_tr_b16 a[60:61], v15 offset:57352
    ds_read_b64_tr_b16 a[62:63], v15 offset:61448
    ds_read_b64_tr_b16 a[64:65], v16 offset:0
    ds_read_b64_tr_b16 a[66:67], v16 offset:4096
    ds_read_b64_tr_b16 a[68:69], v16 offset:8
    ds_read_b64_tr_b16 a[70:71], v16 offset:4104
    ds_read_b64_tr_b16 a[72:73], v16 offset:8192
    ds_read_b64_tr_b16 a[74:75], v16 offset:12288
    ds_read_b64_tr_b16 a[76:77], v16 offset:8200
    ds_read_b64_tr_b16 a[78:79], v16 offset:12296
    s_waitcnt vmcnt(10)
    s_barrier
    ds_read_b64_tr_b16 a[80:81], v16 offset:16384
    ds_read_b64_tr_b16 a[82:83], v16 offset:20480
    ds_read_b64_tr_b16 a[84:85], v16 offset:16392
    ds_read_b64_tr_b16 a[86:87], v16 offset:20488
    ds_read_b64_tr_b16 a[88:89], v16 offset:24576
    ds_read_b64_tr_b16 a[90:91], v16 offset:28672
    ds_read_b64_tr_b16 a[92:93], v16 offset:24584
    ds_read_b64_tr_b16 a[94:95], v16 offset:28680
    ds_read_b64_tr_b16 a[96:97], v16 offset:32768
    ds_read_b64_tr_b16 a[98:99], v16 offset:36864
    ds_read_b64_tr_b16 a[100:101], v16 offset:32776
    ds_read_b64_tr_b16 a[102:103], v16 offset:36872
    ds_read_b64_tr_b16 a[104:105], v16 offset:40960
    ds_read_b64_tr_b16 a[106:107], v16 offset:45056
    ds_read_b64_tr_b16 a[108:109], v16 offset:40968
    ds_read_b64_tr_b16 a[110:111], v16 offset:45064
    ds_read_b64_tr_b16 a[112:113], v16 offset:49152
    ds_read_b64_tr_b16 a[114:115], v16 offset:53248
    ds_read_b64_tr_b16 a[116:117], v16 offset:49160
    ds_read_b64_tr_b16 a[118:119], v16 offset:53256
    s_waitcnt vmcnt(0)
    s_barrier
    ds_read_b64_tr_b16 a[120:121], v16 offset:57344
    ds_read_b64_tr_b16 a[122:123], v16 offset:61440
    ds_read_b64_tr_b16 a[124:125], v16 offset:57352
    ds_read_b64_tr_b16 a[126:127], v16 offset:61448
    ds_read_b64_tr_b16 a[128:129], v17 offset:0
    ds_read_b64_tr_b16 a[130:131], v17 offset:4096
    ds_read_b64_tr_b16 a[132:133], v17 offset:8
    ds_read_b64_tr_b16 a[134:135], v17 offset:4104
    ds_read_b64_tr_b16 a[136:137], v17 offset:8192
    ds_read_b64_tr_b16 a[138:139], v17 offset:12288
    ds_read_b64_tr_b16 a[140:141], v17 offset:8200
    ds_read_b64_tr_b16 a[142:143], v17 offset:12296
    ds_read_b64_tr_b16 a[144:145], v17 offset:16384
    ds_read_b64_tr_b16 a[146:147], v17 offset:20480
    ds_read_b64_tr_b16 a[148:149], v17 offset:16392
    ds_read_b64_tr_b16 a[150:151], v17 offset:20488
    ds_read_b64_tr_b16 a[152:153], v17 offset:24576
    ds_read_b64_tr_b16 a[154:155], v17 offset:28672
    ds_read_b64_tr_b16 a[156:157], v17 offset:24584
    ds_read_b64_tr_b16 a[158:159], v17 offset:28680
    s_waitcnt lgkmcnt(0)
    s_barrier
    s_add_u32 m0, s29, 0
    s_add_u32 s28, s30, 819200
    buffer_load_dwordx4 v14, s[20:23], s28 offen lds
    s_add_u32 m0, s29, 1024
    s_add_u32 s28, s30, 829440
    buffer_load_dwordx4 v14, s[20:23], s28 offen lds
    s_add_u32 m0, s29, 8192
    s_add_u32 s28, s30, 860160
    buffer_load_dwordx4 v14, s[20:23], s28 offen lds
    s_add_u32 m0, s29, 9216
    s_add_u32 s28, s30, 870400
    buffer_load_dwordx4 v14, s[20:23], s28 offen lds
    s_add_u32 m0, s29, 16384
    s_add_u32 s28, s30, 901120
    buffer_load_dwordx4 v14, s[20:23], s28 offen lds
    s_add_u32 m0, s29, 17408
    s_add_u32 s28, s30, 911360
    buffer_load_dwordx4 v14, s[20:23], s28 offen lds
    s_add_u32 m0, s29, 24576
    s_add_u32 s28, s30, 942080
    buffer_load_dwordx4 v14, s[20:23], s28 offen lds
    s_add_u32 m0, s29, 25600
    s_add_u32 s28, s30, 952320
    buffer_load_dwordx4 v14, s[20:23], s28 offen lds
    s_add_u32 m0, s29, 32768
    s_add_u32 s28, s30, 983040
    buffer_load_dwordx4 v14, s[20:23], s28 offen lds
    s_add_u32 m0, s29, 33792
    s_add_u32 s28, s30, 993280
    buffer_load_dwordx4 v14, s[20:23], s28 offen lds
    s_add_u32 m0, s29, 40960
    s_add_u32 s28, s30, 1024000
    buffer_load_dwordx4 v14, s[20:23], s28 offen lds
    s_add_u32 m0, s29, 41984
    s_add_u32 s28, s30, 1034240
    buffer_load_dwordx4 v14, s[20:23], s28 offen lds
    s_add_u32 m0, s29, 49152
    s_add_u32 s28, s30, 1064960
    buffer_load_dwordx4 v14, s[20:23], s28 offen lds
    s_add_u32 m0, s29, 50176
    s_add_u32 s28, s30, 1075200
    buffer_load_dwordx4 v14, s[20:23], s28 offen lds
    s_waitcnt vmcnt(4)
    s_barrier
    ds_read_b64_tr_b16 a[160:161], v15 offset:0
    ds_read_b64_tr_b16 a[162:163], v15 offset:4096
    ds_read_b64_tr_b16 a[164:165], v15 offset:8
    ds_read_b64_tr_b16 a[166:167], v15 offset:4104
    ds_read_b64_tr_b16 a[168:169], v15 offset:8192
    ds_read_b64_tr_b16 a[170:171], v15 offset:12288
    ds_read_b64_tr_b16 a[172:173], v15 offset:8200
    ds_read_b64_tr_b16 a[174:175], v15 offset:12296
    ds_read_b64_tr_b16 a[176:177], v15 offset:16384
    ds_read_b64_tr_b16 a[178:179], v15 offset:20480
    ds_read_b64_tr_b16 a[180:181], v15 offset:16392
    ds_read_b64_tr_b16 a[182:183], v15 offset:20488
    ds_read_b64_tr_b16 a[184:185], v15 offset:24576
    ds_read_b64_tr_b16 a[186:187], v15 offset:28672
    ds_read_b64_tr_b16 a[188:189], v15 offset:24584
    ds_read_b64_tr_b16 a[190:191], v15 offset:28680
    ds_read_b64_tr_b16 a[192:193], v15 offset:32768
    ds_read_b64_tr_b16 a[194:195], v15 offset:36864
    ds_read_b64_tr_b16 a[196:197], v15 offset:32776
    ds_read_b64_tr_b16 a[198:199], v15 offset:36872
    s_waitcnt vmcnt(0)
    s_barrier
    ds_read_b64_tr_b16 a[200:201], v15 offset:40960
    ds_read_b64_tr_b16 a[202:203], v15 offset:45056
    ds_read_b64_tr_b16 a[204:205], v15 offset:40968
    ds_read_b64_tr_b16 a[206:207], v15 offset:45064
    ds_read_b64_tr_b16 a[208:209], v15 offset:49152
    ds_read_b64_tr_b16 a[210:211], v15 offset:53248
    ds_read_b64_tr_b16 a[212:213], v15 offset:49160
    ds_read_b64_tr_b16 a[214:215], v15 offset:53256
    s_waitcnt lgkmcnt(0)
    s_barrier
    s_load_dwordx2 s[24:25], s[0:1], 96
    s_waitcnt lgkmcnt(0)
    s_mov_b32 s26, 2621440
    s_mov_b32 s27, 0x20000
    v_mul_u32_u24 v16, 1280, v2
    v_lshl_add_u32 v16, v3, 4, v16
    s_and_b32 s29, s11, 1
    s_lshl_b32 s30, s41, 1
    s_add_u32 s30, s30, s29
    s_mul_i32 s36, s40, 20480
    s_lshl_b32 s28, s30, 6
    s_add_u32 s36, s36, s28
    s_mul_i32 s37, s40, 20
    s_add_u32 s37, s37, s30
    s_lshl_b32 s37, s37, 10
    s_add_u32 s38, s37, 75497472
    s_add_u32 s37, s37, 92274688
    s_lshl_b32 s28, s29, 11
    s_add_u32 s28, s28, 131072
    v_add_u32 v17, s28, v1
    s_mul_i32 s54, s40, 56
    v_mul_u32_u24 v6, 4, v0
    v_add_u32 v6, s54, v6
    v_add_u32 v6, 69732864, v6
    s_mul_i32 s35, s11, 1024
    s_mul_i32 s34, s40, 55296
    s_add_u32 s34, s34, 100663296
    s_add_u32 s34, s34, s35
    s_mul_i32 s52, s41, 358
    s_lshr_b32 s52, s52, 8
    s_mul_i32 s52, s52, 4096
    s_lshr_b32 s28, s11, 1
    s_mul_i32 s28, s28, 27648
    v_add_u32 v5, s28, v1
    s_mov_b32 s12, 0
    s_mov_b32 s55, 0
    s_add_u32 s28, s12, 1
    v_mov_b32 v7, s28
    v_cmp_gt_u32 vcc, 14, v0
    s_nop 1
    v_cndmask_b32 v7, 0, v7, vcc
b4_59:
    s_cmp_eq_u32 s55, 1
    s_cbranch_scc1 b4h_60
bw_62:
    s_sub_u32 s88, s88, 1
    s_cbranch_scc1 k_end
    s_mov_b64 exec, 16383
    buffer_load_dword v12, v6, s[16:19], 0 offen sc1
    s_mov_b64 exec, -1
    s_waitcnt vmcnt(0)
bk_63:
    v_cmp_lt_u32 vcc, v12, v7
    s_cbranch_vccnz bw_62
    s_mov_b32 s29, s52
    s_add_u32 m0, s35, s29
    s_add_u32 s28, s34, s29
    buffer_load_dwordx4 v1, s[16:19], s28 offen sc1 lds
    s_add_u32 s29, s29, 4096
    s_cmp_eq_u32 s29, 57344
    s_cselect_b32 s29, 0, s29
    s_add_u32 m0, s35, s29
    s_add_u32 s28, s34, s29
    buffer_load_dwordx4 v1, s[16:19], s28 offen sc1 lds
    s_add_u32 s29, s29, 4096
    s_cmp_eq_u32 s29, 57344
    s_cselect_b32 s29, 0, s29
    s_add_u32 m0, s35, s29
    s_add_u32 s28, s34, s29
    buffer_load_dwordx4 v1, s[16:19], s28 offen sc1 lds
    s_add_u32 s29, s29, 4096
    s_cmp_eq_u32 s29, 57344
    s_cselect_b32 s29, 0, s29
    s_add_u32 m0, s35, s29
    s_add_u32 s28, s34, s29
    buffer_load_dwordx4 v1, s[16:19], s28 offen sc1 lds
    s_add_u32 s29, s29, 4096
    s_cmp_eq_u32 s29, 57344
    s_cselect_b32 s29, 0, s29
    s_add_u32 m0, s35, s29
    s_add_u32 s28, s34, s29
    buffer_load_dwordx4 v1, s[16:19], s28 offen sc1 lds
    s_add_u32 s29, s29, 4096
    s_cmp_eq_u32 s29, 57344
    s_cselect_b32 s29, 0, s29
    s_add_u32 m0, s35, s29
    s_add_u32 s28, s34, s29
    buffer_load_dwordx4 v1, s[16:19], s28 offen sc1 lds
    s_add_u32 s29, s29, 4096
    s_cmp_eq_u32 s29, 57344
    s_cselect_b32 s29, 0, s29
    s_add_u32 m0, s35, s29
    s_add_u32 s28, s34, s29
    buffer_load_dwordx4 v1, s[16:19], s28 offen sc1 lds
    s_add_u32 s29, s29, 4096
    s_cmp_eq_u32 s29, 57344
    s_cselect_b32 s29, 0, s29
    s_add_u32 m0, s35, s29
    s_add_u32 s28, s34, s29
    buffer_load_dwordx4 v1, s[16:19], s28 offen sc1 lds
    s_add_u32 s29, s29, 4096
    s_cmp_eq_u32 s29, 57344
    s_cselect_b32 s29, 0, s29
    s_add_u32 m0, s35, s29
    s_add_u32 s28, s34, s29
    buffer_load_dwordx4 v1, s[16:19], s28 offen sc1 lds
    s_add_u32 s29, s29, 4096
    s_cmp_eq_u32 s29, 57344
    s_cselect_b32 s29, 0, s29
    s_add_u32 m0, s35, s29
    s_add_u32 s28, s34, s29
    buffer_load_dwordx4 v1, s[16:19], s28 offen sc1 lds
    s_add_u32 s29, s29, 4096
    s_cmp_eq_u32 s29, 57344
    s_cselect_b32 s29, 0, s29
    s_add_u32 m0, s35, s29
    s_add_u32 s28, s34, s29
    buffer_load_dwordx4 v1, s[16:19], s28 offen sc1 lds
    s_add_u32 s29, s29, 4096
    s_cmp_eq_u32 s29, 57344
    s_cselect_b32 s29, 0, s29
    s_add_u32 m0, s35, s29
    s_add_u32 s28, s34, s29
    buffer_load_dwordx4 v1, s[16:19], s28 offen sc1 lds
    s_add_u32 s29, s29, 4096
    s_cmp_eq_u32 s29, 57344
    s_cselect_b32 s29, 0, s29
    s_add_u32 m0, s35, s29
    s_add_u32 s28, s34, s29
    buffer_load_dwordx4 v1, s[16:19], s28 offen sc1 lds
    s_add_u32 s29, s29, 4096
    s_cmp_eq_u32 s29, 57344
    s_cselect_b32 s29, 0, s29
    s_add_u32 m0, s35, s29
    s_add_u32 s28, s34, s29
    buffer_load_dwordx4 v1, s[16:19], s28 offen sc1 lds
    s_add_u32 s34, s34, 110592
    s_xor_b32 s35, s35, 65536
b4h_60:
    buffer_load_dwordx4 v[78:81], v1, s[16:19], s37 offen sc1
    buffer_load_dwordx4 v[82:85], v1, s[16:19], s38 offen sc1
    s_add_u32 s12, s12, 1
    s_add_u32 s28, s12, 1
    v_mov_b32 v7, s28
    v_cmp_gt_u32 vcc, 14, v0
    s_nop 1
    v_cndmask_b32 v7, 0, v7, vcc
    s_mov_b64 exec, 16383
    buffer_load_dword v12, v6, s[16:19], 0 offen sc1
    s_mov_b64 exec, -1
    s_waitcnt vmcnt(3)
    s_barrier
    ds_read_b128 v[22:25], v5 offset:0
    ds_read_b128 v[26:29], v5 offset:1024
    ds_read_b128 v[30:33], v5 offset:2048
    ds_read_b128 v[34:37], v5 offset:3072
    ds_read_b128 v[38:41], v5 offset:4096
    ds_read_b128 v[42:45], v5 offset:5120
    ds_read_b128 v[46:49], v5 offset:6144
    ds_read_b128 v[50:53], v5 offset:7168
    s_waitcnt lgkmcnt(7)
    v_mfma_f32_16x16x32_bf16 v[54:57], a[0:3], v[22:25], 0
    v_mfma_f32_16x16x32_bf16 v[58:61], a[4:7], v[22:25], 0
    ds_read_b128 v[22:25], v5 offset:8192
    s_waitcnt lgkmcnt(7)
    v_mfma_f32_16x16x32_bf16 v[54:57], a[8:11], v[26:29], v[54:57]
    v_mfma_f32_16x16x32_bf16 v[58:61], a[12:15], v[26:29], v[58:61]
    ds_read_b128 v[26:29], v5 offset:9216
    s_waitcnt lgkmcnt(7)
    v_mfma_f32_16x16x32_bf16 v[54:57], a[16:19], v[30:33], v[54:57]
    v_mfma_f32_16x16x32_bf16 v[58:61], a[20:23], v[30:33], v[58:61]
    ds_read_b128 v[30:33], v5 offset:10240
    s_waitcnt lgkmcnt(7)
    v_mfma_f32_16x16x32_bf16 v[54:57], a[24:27], v[34:37], v[54:57]
    v_mfma_f32_16x16x32_bf16 v[58:61], a[28:31], v[34:37], v[58:61]
    ds_read_b128 v[34:37], v5 offset:11264
    s_waitcnt lgkmcnt(7)
    v_mfma_f32_16x16x32_bf16 v[54:57], a[32:35], v[38:41], v[54:57]
    v_mfma_f32_16x16x32_bf16 v[58:61], a[36:39], v[38:41], v[58:61]
    ds_read_b128 v[38:41], v5 offset:12288
    s_waitcnt lgkmcnt(7)
    v_mfma_f32_16x16x32_bf16 v[54:57], a[40:43], v[42:45], v[54:57]
    v_mfma_f32_16x16x32_bf16 v[58:61], a[44:47], v[42:45], v[58:61]
    ds_read_b128 v[42:45], v5 offset:13312
    s_waitcnt lgkmcnt(7)
    v_mfma_f32_16x16x32_bf16 v[54:57], a[48:51], v[46:49], v[54:57]
    v_mfma_f32_16x16x32_bf16 v[58:61], a[52:55], v[46:49], v[58:61]
    ds_read_b128 v[46:49], v5 offset:14336
    s_waitcnt lgkmcnt(7)
    v_mfma_f32_16x16x32_bf16 v[54:57], a[56:59], v[50:53], v[54:57]
    v_mfma_f32_16x16x32_bf16 v[58:61], a[60:63], v[50:53], v[58:61]
    ds_read_b128 v[50:53], v5 offset:15360
    s_waitcnt lgkmcnt(7)
    v_mfma_f32_16x16x32_bf16 v[54:57], a[64:67], v[22:25], v[54:57]
    v_mfma_f32_16x16x32_bf16 v[58:61], a[68:71], v[22:25], v[58:61]
    ds_read_b128 v[22:25], v5 offset:16384
    s_waitcnt lgkmcnt(7)
    v_mfma_f32_16x16x32_bf16 v[54:57], a[72:75], v[26:29], v[54:57]
    v_mfma_f32_16x16x32_bf16 v[58:61], a[76:79], v[26:29], v[58:61]
    ds_read_b128 v[26:29], v5 offset:17408
    s_waitcnt lgkmcnt(7)
    v_mfma_f32_16x16x32_bf16 v[54:57], a[80:83], v[30:33], v[54:57]
    v_mfma_f32_16x16x32_bf16 v[58:61], a[84:87], v[30:33], v[58:61]
    ds_read_b128 v[30:33], v5 offset:18432
    s_waitcnt lgkmcnt(7)
    v_mfma_f32_16x16x32_bf16 v[54:57], a[88:91], v[34:37], v[54:57]
    v_mfma_f32_16x16x32_bf16 v[58:61], a[92:95], v[34:37], v[58:61]
    ds_read_b128 v[34:37], v5 offset:19456
    s_waitcnt lgkmcnt(7)
    v_mfma_f32_16x16x32_bf16 v[54:57], a[96:99], v[38:41], v[54:57]
    v_mfma_f32_16x16x32_bf16 v[58:61], a[100:103], v[38:41], v[58:61]
    ds_read_b128 v[38:41], v5 offset:20480
    s_waitcnt lgkmcnt(7)
    v_mfma_f32_16x16x32_bf16 v[54:57], a[104:107], v[42:45], v[54:57]
    v_mfma_f32_16x16x32_bf16 v[58:61], a[108:111], v[42:45], v[58:61]
    ds_read_b128 v[42:45], v5 offset:21504
    s_waitcnt lgkmcnt(7)
    v_mfma_f32_16x16x32_bf16 v[54:57], a[112:115], v[46:49], v[54:57]
    v_mfma_f32_16x16x32_bf16 v[58:61], a[116:119], v[46:49], v[58:61]
    ds_read_b128 v[46:49], v5 offset:22528
    s_waitcnt lgkmcnt(7)
    v_mfma_f32_16x16x32_bf16 v[54:57], a[120:123], v[50:53], v[54:57]
    v_mfma_f32_16x16x32_bf16 v[58:61], a[124:127], v[50:53], v[58:61]
    ds_read_b128 v[50:53], v5 offset:23552
    s_waitcnt lgkmcnt(7)
    v_mfma_f32_16x16x32_bf16 v[54:57], a[128:131], v[22:25], v[54:57]
    v_mfma_f32_16x16x32_bf16 v[58:61], a[132:135], v[22:25], v[58:61]
    ds_read_b128 v[22:25], v5 offset:24576
    s_waitcnt lgkmcnt(7)
    v_mfma_f32_16x16x32_bf16 v[54:57], a[136:139], v[26:29], v[54:57]
    v_mfma_f32_16x16x32_bf16 v[58:61], a[140:143], v[26:29], v[58:61]
    ds_read_b128 v[26:29], v5 offset:25600
    s_waitcnt lgkmcnt(7)
    v_mfma_f32_16x16x32_bf16 v[54:57], a[144:147], v[30:33], v[54:57]
    v_mfma_f32_16x16x32_bf16 v[58:61], a[148:151], v[30:33], v[58:61]
    ds_read_b128 v[30:33], v5 offset:26624
    s_waitcnt lgkmcnt(7)
    v_mfma_f32_16x16x32_bf16 v[54:57], a[152:155], v[34:37], v[54:57]
    v_mfma_f32_16x16x32_bf16 v[58:61], a[156:159], v[34:37], v[58:61]
    s_waitcnt lgkmcnt(6)
    v_mfma_f32_16x16x32_bf16 v[54:57], a[160:163], v[38:41], v[54:57]
    v_mfma_f32_16x16x32_bf16 v[58:61], a[164:167], v[38:41], v[58:61]
    s_waitcnt lgkmcnt(5)
    v_mfma_f32_16x16x32_bf16 v[54:57], a[168:171], v[42:45], v[54:57]
    v_mfma_f32_16x16x32_bf16 v[58:61], a[172:175], v[42:45], v[58:61]
    s_waitcnt lgkmcnt(4)
    v_mfma_f32_16x16x32_bf16 v[54:57], a[176:179], v[46:49], v[54:57]
    v_mfma_f32_16x16x32_bf16 v[58:61], a[180:183], v[46:49], v[58:61]
    s_waitcnt lgkmcnt(3)
    v_mfma_f32_16x16x32_bf16 v[54:57], a[184:187], v[50:53], v[54:57]
    v_mfma_f32_16x16x32_bf16 v[58:61], a[188:191], v[50:53], v[58:61]
    s_waitcnt lgkmcnt(2)
    v_mfma_f32_16x16x32_bf16 v[54:57], a[192:195], v[22:25], v[54:57]
    v_mfma_f32_16x16x32_bf16 v[58:61], a[196:199], v[22:25], v[58:61]
    s_waitcnt lgkmcnt(1)
    v_mfma_f32_16x16x32_bf16 v[54:57], a[200:203], v[26:29], v[54:57]
    v_mfma_f32_16x16x32_bf16 v[58:61], a[204:207], v[26:29], v[58:61]
    s_waitcnt lgkmcnt(0)
    v_mfma_f32_16x16x32_bf16 v[54:57], a[208:211], v[30:33], v[54:57]
    v_mfma_f32_16x16x32_bf16 v[58:61], a[212:215], v[30:33], v[58:61]
    v_xor_b32 v5, 65536, v5
    s_waitcnt vmcnt(0)
    v_cmp_lt_u32 vcc, v12, v7
    s_mov_b32 s55, 0
    s_cbranch_vccnz b4n_61
    s_mov_b32 s29, s52
    s_add_u32 m0, s35, s29
    s_add_u32 s28, s34, s29
    buffer_load_dwordx4 v1, s[16:19], s28 offen sc1 lds
    s_add_u32 s29, s29, 4096
    s_cmp_eq_u32 s29, 57344
    s_cselect_b32 s29, 0, s29
    s_add_u32 m0, s35, s29
    s_add_u32 s28, s34, s29
    buffer_load_dwordx4 v1, s[16:19], s28 offen sc1 lds
    s_add_u32 s29, s29, 4096
    s_cmp_eq_u32 s29, 57344
    s_cselect_b32 s29, 0, s29
    s_add_u32 m0, s35, s29
    s_add_u32 s28, s34, s29
    buffer_load_dwordx4 v1, s[16:19], s28 offen sc1 lds
    s_add_u32 s29, s29, 4096
    s_cmp_eq_u32 s29, 57344
    s_cselect_b32 s29, 0, s29
    s_add_u32 m0, s35, s29
    s_add_u32 s28, s34, s29
    buffer_load_dwordx4 v1, s[16:19], s28 offen sc1 lds
    s_add_u32 s29, s29, 4096
    s_cmp_eq_u32 s29, 57344
    s_cselect_b32 s29, 0, s29
    s_add_u32 m0, s35, s29
    s_add_u32 s28, s34, s29
    buffer_load_dwordx4 v1, s[16:19], s28 offen sc1 lds
    s_add_u32 s29, s29, 4096
    s_cmp_eq_u32 s29, 57344
    s_cselect_b32 s29, 0, s29
    s_add_u32 m0, s35, s29
    s_add_u32 s28, s34, s29
    buffer_load_dwordx4 v1, s[16:19], s28 offen sc1 lds
    s_add_u32 s29, s29, 4096
    s_cmp_eq_u32 s29, 57344
    s_cselect_b32 s29, 0, s29
    s_add_u32 m0, s35, s29
    s_add_u32 s28, s34, s29
    buffer_load_dwordx4 v1, s[16:19], s28 offen sc1 lds
    s_add_u32 s29, s29, 4096
    s_cmp_eq_u32 s29, 57344
    s_cselect_b32 s29, 0, s29
    s_add_u32 m0, s35, s29
    s_add_u32 s28, s34, s29
    buffer_load_dwordx4 v1, s[16:19], s28 offen sc1 lds
    s_add_u32 s29, s29, 4096
    s_cmp_eq_u32 s29, 57344
    s_cselect_b32 s29, 0, s29
    s_add_u32 m0, s35, s29
    s_add_u32 s28, s34, s29
    buffer_load_dwordx4 v1, s[16:19], s28 offen sc1 lds
    s_add_u32 s29, s29, 4096
    s_cmp_eq_u32 s29, 57344
    s_cselect_b32 s29, 0, s29
    s_add_u32 m0, s35, s29
    s_add_u32 s28, s34, s29
    buffer_load_dwordx4 v1, s[16:19], s28 offen sc1 lds
    s_add_u32 s29, s29, 4096
    s_cmp_eq_u32 s29, 57344
    s_cselect_b32 s29, 0, s29
    s_add_u32 m0, s35, s29
    s_add_u32 s28, s34, s29
    buffer_load_dwordx4 v1, s[16:19], s28 offen sc1 lds
    s_add_u32 s29, s29, 4096
    s_cmp_eq_u32 s29, 57344
    s_cselect_b32 s29, 0, s29
    s_add_u32 m0, s35, s29
    s_add_u32 s28, s34, s29
    buffer_load_dwordx4 v1, s[16:19], s28 offen sc1 lds
    s_add_u32 s29, s29, 4096
    s_cmp_eq_u32 s29, 57344
    s_cselect_b32 s29, 0, s29
    s_add_u32 m0, s35, s29
    s_add_u32 s28, s34, s29
    buffer_load_dwordx4 v1, s[16:19], s28 offen sc1 lds
    s_add_u32 s29, s29, 4096
    s_cmp_eq_u32 s29, 57344
    s_cselect_b32 s29, 0, s29
    s_add_u32 m0, s35, s29
    s_add_u32 s28, s34, s29
    buffer_load_dwordx4 v1, s[16:19], s28 offen sc1 lds
    s_add_u32 s34, s34, 110592
    s_xor_b32 s35, s35, 65536
    s_mov_b32 s55, 1
b4n_61:
    s_cmp_lt_u32 s11, 2
    s_cbranch_scc1 b4l_64
    s_nop 5
    ds_write_b128 v17, v[54:57]
    ds_write_b128 v17, v[58:61] offset:1024
    s_waitcnt lgkmcnt(0)
    s_barrier
    s_branch b4j_65
b4l_64:
    s_barrier
    ds_read_b128 v[62:65], v17
    ds_read_b128 v[66:69], v17 offset:1024
    s_nop 3
    s_waitcnt lgkmcnt(0)
    v_pk_add_f32 v[54:55], v[54:55], v[62:63]
    v_pk_add_f32 v[56:57], v[56:57], v[64:65]
    v_pk_add_f32 v[58:59], v[58:59], v[66:67]
    v_pk_add_f32 v[60:61], v[60:61], v[68:69]
    v_cvt_pk_bf16_f32 v62, v54, v55
    v_cvt_pk_bf16_f32 v63, v56, v57
    v_cvt_pk_bf16_f32 v64, v58, v59
    v_cvt_pk_bf16_f32 v65, v60, v61
    v_and_b32 v55, 0xffff0000, v62
    v_lshlrev_b32 v54, 16, v62
    v_and_b32 v57, 0xffff0000, v63
    v_lshlrev_b32 v56, 16, v63
    v_and_b32 v59, 0xffff0000, v64
    v_lshlrev_b32 v58, 16, v64
    v_and_b32 v61, 0xffff0000, v65
    v_lshlrev_b32 v60, 16, v65
    v_and_b32 v63, 0xffff0000, v78
    v_lshlrev_b32 v62, 16, v78
    v_and_b32 v65, 0xffff0000, v79
    v_lshlrev_b32 v64, 16, v79
    v_and_b32 v67, 0xffff0000, v80
    v_lshlrev_b32 v66, 16, v80
    v_and_b32 v69, 0xffff0000, v81
    v_lshlrev_b32 v68, 16, v81
    v_pk_add_f32 v[54:55], v[54:55], v[62:63]
    v_pk_add_f32 v[56:57], v[56:57], v[64:65]
    v_pk_add_f32 v[58:59], v[58:59], v[66:67]
    v_pk_add_f32 v[60:61], v[60:61], v[68:69]
    v_cvt_pk_bf16_f32 v62, v54, v55
    v_cvt_pk_bf16_f32 v63, v56, v57
    v_cvt_pk_bf16_f32 v64, v58, v59
    v_cvt_pk_bf16_f32 v65, v60, v61
    v_and_b32 v55, 0xffff0000, v62
    v_lshlrev_b32 v54, 16, v62
    v_and_b32 v57, 0xffff0000, v63
    v_lshlrev_b32 v56, 16, v63
    v_and_b32 v59, 0xffff0000, v64
    v_lshlrev_b32 v58, 16, v64
    v_and_b32 v61, 0xffff0000, v65
    v_lshlrev_b32 v60, 16, v65
    v_and_b32 v63, 0xffff0000, v82
    v_lshlrev_b32 v62, 16, v82
    v_and_b32 v65, 0xffff0000, v83
    v_lshlrev_b32 v64, 16, v83
    v_and_b32 v67, 0xffff0000, v84
    v_lshlrev_b32 v66, 16, v84
    v_and_b32 v69, 0xffff0000, v85
    v_lshlrev_b32 v68, 16, v85
    v_pk_add_f32 v[54:55], v[54:55], v[62:63]
    v_pk_add_f32 v[56:57], v[56:57], v[64:65]
    v_pk_add_f32 v[58:59], v[58:59], v[66:67]
    v_pk_add_f32 v[60:61], v[60:61], v[68:69]
    v_cvt_pk_bf16_f32 v62, v54, v55
    v_cvt_pk_bf16_f32 v63, v56, v57
    v_cvt_pk_bf16_f32 v64, v58, v59
    v_cvt_pk_bf16_f32 v65, v60, v61
    buffer_store_dwordx4 v[62:65], v16, s[24:27], s36 offen
b4j_65:
    s_add_u32 s36, s36, 40960
    s_add_u32 s37, s37, 40960
    s_add_u32 s38, s38, 40960
    s_barrier
    s_cmp_lt_u32 s12, 64
    s_cbranch_scc1 b4_59
    s_branch k_end
role_58:
k_end:
k_exit:
    s_endpgm
.section .rodata,"a"
.p2align 6
.amdhsa_kernel sequential_preLN__memory_aug_recurrent_mem_tr__mixer_s_mlp__prompt_kernel
  .amdhsa_next_free_vgpr 512
  .amdhsa_next_free_sgpr 102
  .amdhsa_accum_offset 256
  .amdhsa_group_segment_fixed_size 0
  .amdhsa_kernarg_size 120
  .amdhsa_user_sgpr_count 2
  .amdhsa_user_sgpr_kernarg_segment_ptr 1
  .amdhsa_system_sgpr_workgroup_id_x 1
.end_amdhsa_kernel
```
